```python
import torch

def _softmax(x, axis=-1):
    return torch.softmax(x, dim=axis)
def _gelu(x):
    return torch.nn.functional.gelu(x, approximate="tanh")
def _silu(x):
    return torch.nn.functional.silu(x)
def _sigmoid(x):
    return torch.sigmoid(x)
def _layernorm(x, axis=-1, eps=1e-5):
    m = x.mean(dim=axis, keepdim=True)
    v = x.var(dim=axis, keepdim=True, unbiased=False)
    return (x - m) / torch.sqrt(v + eps)
def _scatter_add(tgt, idx, src, axis=0):
    return tgt.clone().index_add_(axis, idx, src)
def _segment_sum(src, seg, n):
    out = torch.zeros((n,) + src.shape[1:], dtype=src.dtype)
    return out.index_add_(0, seg, src)
def _pad(x, pw):
    flat = tuple(v for pair in reversed(pw) for v in pair)
    return torch.nn.functional.pad(x, flat)

kernel_name = 'parallel_sum__linear_kernel_hedgehog__swiglu_ffn__prompt'

def setup_inputs():

    _w = (lambda a: (lambda t: t.to(torch.bfloat16) if t.is_floating_point() else t)(torch.as_tensor(a)))
    def _A_setup():
        B, S, D, H = 1, 2048, 512, 32
        Dh = D // H
        return {
            "x": _w((lambda *s: torch.randn(*s, dtype=torch.bfloat16) * 0.05)(B, S, D)),
            "wqkv": _w((lambda *s: torch.randn(*s, dtype=torch.bfloat16) * 0.4)(D, 3 * D)),
            "w_phi": _w((lambda *s: torch.randn(*s, dtype=torch.bfloat16) * 0.4)(H, Dh, Dh) * (Dh ** -0.5)),
            "wo": _w((lambda *s: torch.randn(*s, dtype=torch.bfloat16) * 0.1)(D, D)),
        }
    _A_in = _A_setup()

    def _B_setup():
        B, S, D, F = 1, 2048, 512, 1792
        return {
            "x": _w((lambda *s: torch.randn(*s, dtype=torch.bfloat16) * 0.05)(B, S, D)),
            "w_gate": _w((lambda *s: torch.randn(*s, dtype=torch.bfloat16) * 0.05)(D, F)),
            "w_up": _w((lambda *s: torch.randn(*s, dtype=torch.bfloat16) * 0.05)(D, F)),
            "w_down": _w((lambda *s: torch.randn(*s, dtype=torch.bfloat16) * 0.05)(F, D)),
        }
    _B_in = _B_setup()

    return {
        "A_x": _A_in["x"],
        "A_wqkv": _A_in["wqkv"],
        "A_w_phi": _A_in["w_phi"],
        "A_wo": _A_in["wo"],
        "B_x": _B_in["x"],
        "B_w_gate": _B_in["w_gate"],
        "B_w_up": _B_in["w_up"],
        "B_w_down": _B_in["w_down"],
    }

def reference(A_x, A_wqkv, A_w_phi, A_wo, B_x, B_w_gate, B_w_up, B_w_down):
    def _A_ref(x, wqkv, w_phi, wo):
        B, S, D = x.shape
        H = 32; Dh = D // H
        qkv = (lambda x, *d: x.permute(*d))((x @ wqkv).reshape(B, S, 3, H, Dh), 2, 0, 3, 1, 4)
        q, k, v = qkv[0], qkv[1], qkv[2]
        pq = torch.einsum("bhsd,hdf->bhsf", q, w_phi)
        pk = torch.einsum("bhsd,hdf->bhsf", k, w_phi)
        phi_q = torch.concatenate([_softmax(pq, axis=-1), _softmax(-pq, axis=-1)], axis=-1)
        phi_k = torch.concatenate([_softmax(pk, axis=-1), _softmax(-pk, axis=-1)], axis=-1)
        kv = torch.einsum("bhsf,bhsd->bhfd", phi_k, v)
        z  = torch.einsum("bhsf->bhf", phi_k)
        num = torch.einsum("bhqf,bhfd->bhqd", phi_q, kv)
        den = torch.einsum("bhqf,bhf->bhq", phi_q, z)[..., None] + 1e-6
        o = num / den
        return (lambda x, *d: x.permute(*d))(o, 0, 2, 1, 3).reshape(B, S, D) @ wo

    def _B_ref(x, w_gate, w_up, w_down):
        g = _silu(x @ w_gate)
        u = x @ w_up
        return (g * u) @ w_down

    x = A_x
    xn = _layernorm(x, axis=-1)
    return x + _A_ref(xn, A_wqkv, A_w_phi, A_wo) + _B_ref(xn, B_w_gate, B_w_up, B_w_down)
```

```asm
; @launch grid=(256,1,1) block=(512,1,1) lds=163840
.amdgcn_target "amdgcn-amd-amdhsa--gfx950"
.text
.globl parallel_sum__linear_kernel_hedgehog__swiglu_ffn__prompt_kernel
.p2align 8
.type parallel_sum__linear_kernel_hedgehog__swiglu_ffn__prompt_kernel,@function
parallel_sum__linear_kernel_hedgehog__swiglu_ffn__prompt_kernel:
L_code:
s_cmp_ge_u32 s2, 256
s_cbranch_scc1 L_end
s_load_dwordx16 s[40:55], s[0:1], 0
s_load_dwordx4 s[56:59], s[0:1], 64
s_load_dwordx2 s[60:61], s[0:1], 80
v_lshrrev_b32 v2, 6, v0
v_and_b32 v1, 63, v0
v_readfirstlane_b32 s3, v2
s_and_b32 s62, s2, 7
s_lshr_b32 s63, s2, 3
s_and_b32 s4, s3, 3
s_lshr_b32 s5, s62, 2
s_lshl_b32 s5, s5, 3
s_lshr_b32 s36, s63, 2
s_add_u32 s5, s5, s36
s_and_b32 s37, s63, 3
s_lshl_b32 s7, s37, 1
s_and_b32 s6, s62, 3
s_lshl_b32 s6, s6, 1
s_lshr_b32 s38, s37, 1
s_add_u32 s6, s6, s38
s_and_b32 s39, s37, 1
s_waitcnt lgkmcnt(0)
s_mov_b32 s20, s60
s_mov_b32 s21, s61
s_mov_b32 s22, 0x1000000
s_mov_b32 s23, 0x20000
s_mov_b32 s8, s40
s_mov_b32 s9, s41
s_mov_b32 s10, 0x200000
s_mov_b32 s11, 0x20000
s_mov_b32 s64, s54
s_mov_b32 s65, s55
s_mov_b32 s66, 0x1c0000
s_mov_b32 s67, 0x20000
s_mov_b32 s68, s46
s_mov_b32 s69, s47
s_mov_b32 s70, 0x80000
s_mov_b32 s71, 0x20000
s_mov_b64 s[100:101], s[56:57]
s_cmp_ge_u32 s3, 4
s_cbranch_scc1 L_helper
s_cmp_eq_u32 s39, 1
s_cbranch_scc1 L_cQ
s_branch L_cD
L_helper:
s_cmp_eq_u32 s39, 1
s_cbranch_scc1 L_hQ
s_branch L_hD
L_end:
s_endpgm
.p2align 6
L_cD:
s_setprio 1
v_lshrrev_b32 v18, 3, v1
v_lshlrev_b32 v18, 10, v18
v_lshrrev_b32 v19, 4, v1
v_and_b32 v20, 7, v1
v_xor_b32 v21, v20, v19
v_lshl_add_u32 v16, v21, 4, v18
v_xor_b32 v17, 64, v16
s_lshl_b32 s40, s5, 17
s_lshl_b32 s41, s4, 15
s_add_u32 s40, s40, s41
s_lshr_b32 s42, s4, 1
s_lshl_b32 s42, s42, 15
s_add_u32 s41, s41, s42
s_add_u32 s42, s7, 0
s_and_b32 s42, s42, 7
s_lshl_b32 s42, s42, 7
s_add_u32 s42, s42, s40
s_add_u32 m0, s41, 0
s_add_u32 s43, s42, 0
buffer_load_dwordx4 v16, s[8:11], s43 offen lds
s_add_u32 m0, s41, 1024
s_add_u32 s43, s42, 8192
buffer_load_dwordx4 v17, s[8:11], s43 offen lds
s_add_u32 m0, s41, 2048
s_add_u32 s43, s42, 16384
buffer_load_dwordx4 v16, s[8:11], s43 offen lds
s_add_u32 m0, s41, 3072
s_add_u32 s43, s42, 24576
buffer_load_dwordx4 v17, s[8:11], s43 offen lds
s_add_u32 s42, s7, 1
s_and_b32 s42, s42, 7
s_lshl_b32 s42, s42, 7
s_add_u32 s42, s42, s40
s_add_u32 m0, s41, 4096
s_add_u32 s43, s42, 0
buffer_load_dwordx4 v16, s[8:11], s43 offen lds
s_add_u32 m0, s41, 5120
s_add_u32 s43, s42, 8192
buffer_load_dwordx4 v17, s[8:11], s43 offen lds
s_add_u32 m0, s41, 6144
s_add_u32 s43, s42, 16384
buffer_load_dwordx4 v16, s[8:11], s43 offen lds
s_add_u32 m0, s41, 7168
s_add_u32 s43, s42, 24576
buffer_load_dwordx4 v17, s[8:11], s43 offen lds
s_add_u32 s42, s7, 2
s_and_b32 s42, s42, 7
s_lshl_b32 s42, s42, 7
s_add_u32 s42, s42, s40
s_add_u32 m0, s41, 8192
s_add_u32 s43, s42, 0
buffer_load_dwordx4 v16, s[8:11], s43 offen lds
s_add_u32 m0, s41, 9216
s_add_u32 s43, s42, 8192
buffer_load_dwordx4 v17, s[8:11], s43 offen lds
s_add_u32 m0, s41, 10240
s_add_u32 s43, s42, 16384
buffer_load_dwordx4 v16, s[8:11], s43 offen lds
s_add_u32 m0, s41, 11264
s_add_u32 s43, s42, 24576
buffer_load_dwordx4 v17, s[8:11], s43 offen lds
v_and_b32 v18, 31, v1
v_lshrrev_b32 v19, 5, v1
v_bfe_u32 v20, v1, 1, 3
v_xor_b32 v20, v20, v19
v_lshlrev_b32 v20, 4, v20
v_lshl_add_u32 v20, v18, 7, v20
v_add_u32 v2, s41, v20
v_xor_b32 v3, 32, v2
v_xor_b32 v4, 64, v2
v_xor_b32 v5, 0x60, v2
s_lshl_b32 s44, s4, 8
s_add_u32 s44, s44, 61440
v_lshl_add_u32 v13, v18, 3, s44
v_bfe_u32 v22, v1, 4, 1
v_bfe_u32 v23, v1, 2, 2
v_and_b32 v24, 3, v1
v_bfe_u32 v25, v1, 3, 1
v_lshlrev_b32 v26, 10, v19
v_lshl_add_u32 v26, v23, 7, v26
v_lshl_add_u32 v27, v25, 1, v22
v_lshl_add_u32 v26, v27, 5, v26
v_lshl_add_u32 v14, v24, 3, v26
v_lshlrev_b32 v26, 11, v22
v_lshl_add_u32 v26, v19, 10, v26
v_lshl_add_u32 v26, v23, 7, v26
v_lshl_add_u32 v27, v22, 1, v25
v_lshl_add_u32 v26, v27, 5, v26
v_lshl_add_u32 v6, v24, 3, v26
v_lshlrev_b32 v26, 10, v22
v_lshl_add_u32 v26, v19, 9, v26
v_lshl_add_u32 v26, v23, 6, v26
v_lshl_add_u32 v26, v22, 5, v26
v_lshl_add_u32 v7, v24, 3, v26
s_mov_b32 s45, 0x3f803f80
v_mov_b32 v28, 0
v_mov_b32 v29, 0
v_mov_b32 v30, 0
v_mov_b32 v31, 0
s_waitcnt vmcnt(8)
ds_read_b128 v[128:131], v2 offset:0
ds_read_b128 v[132:135], v3 offset:0
ds_read_b128 v[136:139], v4 offset:0
ds_read_b128 v[140:143], v5 offset:0
s_add_u32 s42, s7, 3
s_and_b32 s42, s42, 7
s_lshl_b32 s42, s42, 7
s_add_u32 s42, s42, s40
s_add_u32 m0, s41, 12288
s_add_u32 s43, s42, 0
buffer_load_dwordx4 v16, s[8:11], s43 offen lds
s_add_u32 m0, s41, 13312
s_add_u32 s43, s42, 8192
buffer_load_dwordx4 v17, s[8:11], s43 offen lds
s_add_u32 m0, s41, 14336
s_add_u32 s43, s42, 16384
buffer_load_dwordx4 v16, s[8:11], s43 offen lds
s_add_u32 m0, s41, 15360
s_add_u32 s43, s42, 24576
buffer_load_dwordx4 v17, s[8:11], s43 offen lds
s_waitcnt vmcnt(8)
ds_read_b128 v[144:147], v2 offset:4096
ds_read_b128 v[148:151], v3 offset:4096
ds_read_b128 v[152:155], v4 offset:4096
ds_read_b128 v[156:159], v5 offset:4096
s_add_u32 s42, s7, 4
s_and_b32 s42, s42, 7
s_lshl_b32 s42, s42, 7
s_add_u32 s42, s42, s40
s_add_u32 m0, s41, 16384
s_add_u32 s43, s42, 0
buffer_load_dwordx4 v16, s[8:11], s43 offen lds
s_add_u32 m0, s41, 17408
s_add_u32 s43, s42, 8192
buffer_load_dwordx4 v17, s[8:11], s43 offen lds
s_add_u32 m0, s41, 18432
s_add_u32 s43, s42, 16384
buffer_load_dwordx4 v16, s[8:11], s43 offen lds
s_add_u32 m0, s41, 19456
s_add_u32 s43, s42, 24576
buffer_load_dwordx4 v17, s[8:11], s43 offen lds
s_waitcnt lgkmcnt(4)
v_dot2_f32_bf16 v28, v128, s45, v28
v_dot2_f32_bf16 v30, v128, v128, v30
v_dot2_f32_bf16 v29, v129, s45, v29
v_dot2_f32_bf16 v31, v129, v129, v31
v_dot2_f32_bf16 v28, v130, s45, v28
v_dot2_f32_bf16 v30, v130, v130, v30
v_dot2_f32_bf16 v29, v131, s45, v29
v_dot2_f32_bf16 v31, v131, v131, v31
v_dot2_f32_bf16 v28, v132, s45, v28
v_dot2_f32_bf16 v30, v132, v132, v30
v_dot2_f32_bf16 v29, v133, s45, v29
v_dot2_f32_bf16 v31, v133, v133, v31
v_dot2_f32_bf16 v28, v134, s45, v28
v_dot2_f32_bf16 v30, v134, v134, v30
v_dot2_f32_bf16 v29, v135, s45, v29
v_dot2_f32_bf16 v31, v135, v135, v31
v_dot2_f32_bf16 v28, v136, s45, v28
v_dot2_f32_bf16 v30, v136, v136, v30
v_dot2_f32_bf16 v29, v137, s45, v29
v_dot2_f32_bf16 v31, v137, v137, v31
v_dot2_f32_bf16 v28, v138, s45, v28
v_dot2_f32_bf16 v30, v138, v138, v30
v_dot2_f32_bf16 v29, v139, s45, v29
v_dot2_f32_bf16 v31, v139, v139, v31
v_dot2_f32_bf16 v28, v140, s45, v28
v_dot2_f32_bf16 v30, v140, v140, v30
v_dot2_f32_bf16 v29, v141, s45, v29
v_dot2_f32_bf16 v31, v141, v141, v31
v_dot2_f32_bf16 v28, v142, s45, v28
v_dot2_f32_bf16 v30, v142, v142, v30
v_dot2_f32_bf16 v29, v143, s45, v29
v_dot2_f32_bf16 v31, v143, v143, v31
s_waitcnt vmcnt(8)
ds_read_b128 v[160:163], v2 offset:8192
ds_read_b128 v[164:167], v3 offset:8192
ds_read_b128 v[168:171], v4 offset:8192
ds_read_b128 v[172:175], v5 offset:8192
s_add_u32 s42, s7, 5
s_and_b32 s42, s42, 7
s_lshl_b32 s42, s42, 7
s_add_u32 s42, s42, s40
s_add_u32 m0, s41, 20480
s_add_u32 s43, s42, 0
buffer_load_dwordx4 v16, s[8:11], s43 offen lds
s_add_u32 m0, s41, 21504
s_add_u32 s43, s42, 8192
buffer_load_dwordx4 v17, s[8:11], s43 offen lds
s_add_u32 m0, s41, 22528
s_add_u32 s43, s42, 16384
buffer_load_dwordx4 v16, s[8:11], s43 offen lds
s_add_u32 m0, s41, 23552
s_add_u32 s43, s42, 24576
buffer_load_dwordx4 v17, s[8:11], s43 offen lds
s_waitcnt lgkmcnt(4)
v_dot2_f32_bf16 v28, v144, s45, v28
v_dot2_f32_bf16 v30, v144, v144, v30
v_dot2_f32_bf16 v29, v145, s45, v29
v_dot2_f32_bf16 v31, v145, v145, v31
v_dot2_f32_bf16 v28, v146, s45, v28
v_dot2_f32_bf16 v30, v146, v146, v30
v_dot2_f32_bf16 v29, v147, s45, v29
v_dot2_f32_bf16 v31, v147, v147, v31
v_dot2_f32_bf16 v28, v148, s45, v28
v_dot2_f32_bf16 v30, v148, v148, v30
v_dot2_f32_bf16 v29, v149, s45, v29
v_dot2_f32_bf16 v31, v149, v149, v31
v_dot2_f32_bf16 v28, v150, s45, v28
v_dot2_f32_bf16 v30, v150, v150, v30
v_dot2_f32_bf16 v29, v151, s45, v29
v_dot2_f32_bf16 v31, v151, v151, v31
v_dot2_f32_bf16 v28, v152, s45, v28
v_dot2_f32_bf16 v30, v152, v152, v30
v_dot2_f32_bf16 v29, v153, s45, v29
v_dot2_f32_bf16 v31, v153, v153, v31
v_dot2_f32_bf16 v28, v154, s45, v28
v_dot2_f32_bf16 v30, v154, v154, v30
v_dot2_f32_bf16 v29, v155, s45, v29
v_dot2_f32_bf16 v31, v155, v155, v31
v_dot2_f32_bf16 v28, v156, s45, v28
v_dot2_f32_bf16 v30, v156, v156, v30
v_dot2_f32_bf16 v29, v157, s45, v29
v_dot2_f32_bf16 v31, v157, v157, v31
v_dot2_f32_bf16 v28, v158, s45, v28
v_dot2_f32_bf16 v30, v158, v158, v30
v_dot2_f32_bf16 v29, v159, s45, v29
v_dot2_f32_bf16 v31, v159, v159, v31
s_waitcnt vmcnt(8)
ds_read_b128 v[176:179], v2 offset:12288
ds_read_b128 v[180:183], v3 offset:12288
ds_read_b128 v[184:187], v4 offset:12288
ds_read_b128 v[188:191], v5 offset:12288
s_add_u32 s42, s7, 6
s_and_b32 s42, s42, 7
s_lshl_b32 s42, s42, 7
s_add_u32 s42, s42, s40
s_add_u32 m0, s41, 24576
s_add_u32 s43, s42, 0
buffer_load_dwordx4 v16, s[8:11], s43 offen lds
s_add_u32 m0, s41, 25600
s_add_u32 s43, s42, 8192
buffer_load_dwordx4 v17, s[8:11], s43 offen lds
s_add_u32 m0, s41, 26624
s_add_u32 s43, s42, 16384
buffer_load_dwordx4 v16, s[8:11], s43 offen lds
s_add_u32 m0, s41, 27648
s_add_u32 s43, s42, 24576
buffer_load_dwordx4 v17, s[8:11], s43 offen lds
s_waitcnt lgkmcnt(4)
v_dot2_f32_bf16 v28, v160, s45, v28
v_dot2_f32_bf16 v30, v160, v160, v30
v_dot2_f32_bf16 v29, v161, s45, v29
v_dot2_f32_bf16 v31, v161, v161, v31
v_dot2_f32_bf16 v28, v162, s45, v28
v_dot2_f32_bf16 v30, v162, v162, v30
v_dot2_f32_bf16 v29, v163, s45, v29
v_dot2_f32_bf16 v31, v163, v163, v31
v_dot2_f32_bf16 v28, v164, s45, v28
v_dot2_f32_bf16 v30, v164, v164, v30
v_dot2_f32_bf16 v29, v165, s45, v29
v_dot2_f32_bf16 v31, v165, v165, v31
v_dot2_f32_bf16 v28, v166, s45, v28
v_dot2_f32_bf16 v30, v166, v166, v30
v_dot2_f32_bf16 v29, v167, s45, v29
v_dot2_f32_bf16 v31, v167, v167, v31
v_dot2_f32_bf16 v28, v168, s45, v28
v_dot2_f32_bf16 v30, v168, v168, v30
v_dot2_f32_bf16 v29, v169, s45, v29
v_dot2_f32_bf16 v31, v169, v169, v31
v_dot2_f32_bf16 v28, v170, s45, v28
v_dot2_f32_bf16 v30, v170, v170, v30
v_dot2_f32_bf16 v29, v171, s45, v29
v_dot2_f32_bf16 v31, v171, v171, v31
v_dot2_f32_bf16 v28, v172, s45, v28
v_dot2_f32_bf16 v30, v172, v172, v30
v_dot2_f32_bf16 v29, v173, s45, v29
v_dot2_f32_bf16 v31, v173, v173, v31
v_dot2_f32_bf16 v28, v174, s45, v28
v_dot2_f32_bf16 v30, v174, v174, v30
v_dot2_f32_bf16 v29, v175, s45, v29
v_dot2_f32_bf16 v31, v175, v175, v31
s_waitcnt vmcnt(8)
ds_read_b128 v[192:195], v2 offset:16384
ds_read_b128 v[196:199], v3 offset:16384
ds_read_b128 v[200:203], v4 offset:16384
ds_read_b128 v[204:207], v5 offset:16384
s_add_u32 s42, s7, 7
s_and_b32 s42, s42, 7
s_lshl_b32 s42, s42, 7
s_add_u32 s42, s42, s40
s_add_u32 m0, s41, 28672
s_add_u32 s43, s42, 0
buffer_load_dwordx4 v16, s[8:11], s43 offen lds
s_add_u32 m0, s41, 29696
s_add_u32 s43, s42, 8192
buffer_load_dwordx4 v17, s[8:11], s43 offen lds
s_add_u32 m0, s41, 30720
s_add_u32 s43, s42, 16384
buffer_load_dwordx4 v16, s[8:11], s43 offen lds
s_add_u32 m0, s41, 31744
s_add_u32 s43, s42, 24576
buffer_load_dwordx4 v17, s[8:11], s43 offen lds
s_barrier
s_waitcnt lgkmcnt(4)
v_dot2_f32_bf16 v28, v176, s45, v28
v_dot2_f32_bf16 v30, v176, v176, v30
v_dot2_f32_bf16 v29, v177, s45, v29
v_dot2_f32_bf16 v31, v177, v177, v31
v_dot2_f32_bf16 v28, v178, s45, v28
v_dot2_f32_bf16 v30, v178, v178, v30
v_dot2_f32_bf16 v29, v179, s45, v29
v_dot2_f32_bf16 v31, v179, v179, v31
v_dot2_f32_bf16 v28, v180, s45, v28
v_dot2_f32_bf16 v30, v180, v180, v30
v_dot2_f32_bf16 v29, v181, s45, v29
v_dot2_f32_bf16 v31, v181, v181, v31
v_dot2_f32_bf16 v28, v182, s45, v28
v_dot2_f32_bf16 v30, v182, v182, v30
v_dot2_f32_bf16 v29, v183, s45, v29
v_dot2_f32_bf16 v31, v183, v183, v31
v_dot2_f32_bf16 v28, v184, s45, v28
v_dot2_f32_bf16 v30, v184, v184, v30
v_dot2_f32_bf16 v29, v185, s45, v29
v_dot2_f32_bf16 v31, v185, v185, v31
v_dot2_f32_bf16 v28, v186, s45, v28
v_dot2_f32_bf16 v30, v186, v186, v30
v_dot2_f32_bf16 v29, v187, s45, v29
v_dot2_f32_bf16 v31, v187, v187, v31
v_dot2_f32_bf16 v28, v188, s45, v28
v_dot2_f32_bf16 v30, v188, v188, v30
v_dot2_f32_bf16 v29, v189, s45, v29
v_dot2_f32_bf16 v31, v189, v189, v31
v_dot2_f32_bf16 v28, v190, s45, v28
v_dot2_f32_bf16 v30, v190, v190, v30
v_dot2_f32_bf16 v29, v191, s45, v29
v_dot2_f32_bf16 v31, v191, v191, v31
s_waitcnt vmcnt(8)
ds_read_b128 v[208:211], v2 offset:20480
ds_read_b128 v[212:215], v3 offset:20480
ds_read_b128 v[216:219], v4 offset:20480
ds_read_b128 v[220:223], v5 offset:20480
s_waitcnt lgkmcnt(4)
v_dot2_f32_bf16 v28, v192, s45, v28
v_dot2_f32_bf16 v30, v192, v192, v30
v_dot2_f32_bf16 v29, v193, s45, v29
v_dot2_f32_bf16 v31, v193, v193, v31
v_dot2_f32_bf16 v28, v194, s45, v28
v_dot2_f32_bf16 v30, v194, v194, v30
v_dot2_f32_bf16 v29, v195, s45, v29
v_dot2_f32_bf16 v31, v195, v195, v31
v_dot2_f32_bf16 v28, v196, s45, v28
v_dot2_f32_bf16 v30, v196, v196, v30
v_dot2_f32_bf16 v29, v197, s45, v29
v_dot2_f32_bf16 v31, v197, v197, v31
v_dot2_f32_bf16 v28, v198, s45, v28
v_dot2_f32_bf16 v30, v198, v198, v30
v_dot2_f32_bf16 v29, v199, s45, v29
v_dot2_f32_bf16 v31, v199, v199, v31
v_dot2_f32_bf16 v28, v200, s45, v28
v_dot2_f32_bf16 v30, v200, v200, v30
v_dot2_f32_bf16 v29, v201, s45, v29
v_dot2_f32_bf16 v31, v201, v201, v31
v_dot2_f32_bf16 v28, v202, s45, v28
v_dot2_f32_bf16 v30, v202, v202, v30
v_dot2_f32_bf16 v29, v203, s45, v29
v_dot2_f32_bf16 v31, v203, v203, v31
v_dot2_f32_bf16 v28, v204, s45, v28
v_dot2_f32_bf16 v30, v204, v204, v30
v_dot2_f32_bf16 v29, v205, s45, v29
v_dot2_f32_bf16 v31, v205, v205, v31
v_dot2_f32_bf16 v28, v206, s45, v28
v_dot2_f32_bf16 v30, v206, v206, v30
v_dot2_f32_bf16 v29, v207, s45, v29
v_dot2_f32_bf16 v31, v207, v207, v31
s_waitcnt vmcnt(4)
ds_read_b128 v[224:227], v2 offset:24576
ds_read_b128 v[228:231], v3 offset:24576
ds_read_b128 v[232:235], v4 offset:24576
ds_read_b128 v[236:239], v5 offset:24576
s_waitcnt lgkmcnt(4)
v_dot2_f32_bf16 v28, v208, s45, v28
v_dot2_f32_bf16 v30, v208, v208, v30
v_dot2_f32_bf16 v29, v209, s45, v29
v_dot2_f32_bf16 v31, v209, v209, v31
v_dot2_f32_bf16 v28, v210, s45, v28
v_dot2_f32_bf16 v30, v210, v210, v30
v_dot2_f32_bf16 v29, v211, s45, v29
v_dot2_f32_bf16 v31, v211, v211, v31
v_dot2_f32_bf16 v28, v212, s45, v28
v_dot2_f32_bf16 v30, v212, v212, v30
v_dot2_f32_bf16 v29, v213, s45, v29
v_dot2_f32_bf16 v31, v213, v213, v31
v_dot2_f32_bf16 v28, v214, s45, v28
v_dot2_f32_bf16 v30, v214, v214, v30
v_dot2_f32_bf16 v29, v215, s45, v29
v_dot2_f32_bf16 v31, v215, v215, v31
v_dot2_f32_bf16 v28, v216, s45, v28
v_dot2_f32_bf16 v30, v216, v216, v30
v_dot2_f32_bf16 v29, v217, s45, v29
v_dot2_f32_bf16 v31, v217, v217, v31
v_dot2_f32_bf16 v28, v218, s45, v28
v_dot2_f32_bf16 v30, v218, v218, v30
v_dot2_f32_bf16 v29, v219, s45, v29
v_dot2_f32_bf16 v31, v219, v219, v31
v_dot2_f32_bf16 v28, v220, s45, v28
v_dot2_f32_bf16 v30, v220, v220, v30
v_dot2_f32_bf16 v29, v221, s45, v29
v_dot2_f32_bf16 v31, v221, v221, v31
v_dot2_f32_bf16 v28, v222, s45, v28
v_dot2_f32_bf16 v30, v222, v222, v30
v_dot2_f32_bf16 v29, v223, s45, v29
v_dot2_f32_bf16 v31, v223, v223, v31
s_waitcnt vmcnt(0)
ds_read_b128 v[240:243], v2 offset:28672
ds_read_b128 v[244:247], v3 offset:28672
ds_read_b128 v[248:251], v4 offset:28672
ds_read_b128 v[252:255], v5 offset:28672
s_waitcnt lgkmcnt(4)
v_dot2_f32_bf16 v28, v224, s45, v28
v_dot2_f32_bf16 v30, v224, v224, v30
v_dot2_f32_bf16 v29, v225, s45, v29
v_dot2_f32_bf16 v31, v225, v225, v31
v_dot2_f32_bf16 v28, v226, s45, v28
v_dot2_f32_bf16 v30, v226, v226, v30
v_dot2_f32_bf16 v29, v227, s45, v29
v_dot2_f32_bf16 v31, v227, v227, v31
v_dot2_f32_bf16 v28, v228, s45, v28
v_dot2_f32_bf16 v30, v228, v228, v30
v_dot2_f32_bf16 v29, v229, s45, v29
v_dot2_f32_bf16 v31, v229, v229, v31
v_dot2_f32_bf16 v28, v230, s45, v28
v_dot2_f32_bf16 v30, v230, v230, v30
v_dot2_f32_bf16 v29, v231, s45, v29
v_dot2_f32_bf16 v31, v231, v231, v31
v_dot2_f32_bf16 v28, v232, s45, v28
v_dot2_f32_bf16 v30, v232, v232, v30
v_dot2_f32_bf16 v29, v233, s45, v29
v_dot2_f32_bf16 v31, v233, v233, v31
v_dot2_f32_bf16 v28, v234, s45, v28
v_dot2_f32_bf16 v30, v234, v234, v30
v_dot2_f32_bf16 v29, v235, s45, v29
v_dot2_f32_bf16 v31, v235, v235, v31
v_dot2_f32_bf16 v28, v236, s45, v28
v_dot2_f32_bf16 v30, v236, v236, v30
v_dot2_f32_bf16 v29, v237, s45, v29
v_dot2_f32_bf16 v31, v237, v237, v31
v_dot2_f32_bf16 v28, v238, s45, v28
v_dot2_f32_bf16 v30, v238, v238, v30
v_dot2_f32_bf16 v29, v239, s45, v29
v_dot2_f32_bf16 v31, v239, v239, v31
s_waitcnt lgkmcnt(0)
s_barrier
s_mul_i32 s44, s4, 15360
s_mov_b32 m0, s44
v_xor_b32 v2, 0x10000, v14
v_xor_b32 v3, 0x10040, v14
ds_read_b64_tr_b16 v[32:33], v2 offset:0
ds_read_b64_tr_b16 v[34:35], v2 offset:512
ds_read_b64_tr_b16 v[36:37], v3 offset:0
ds_read_b64_tr_b16 v[38:39], v3 offset:512
ds_read_b64_tr_b16 v[40:41], v2 offset:2048
ds_read_b64_tr_b16 v[42:43], v2 offset:2560
ds_read_b64_tr_b16 v[44:45], v3 offset:2048
ds_read_b64_tr_b16 v[46:47], v3 offset:2560
ds_read_b64_tr_b16 v[48:49], v2 offset:4096
ds_read_b64_tr_b16 v[50:51], v2 offset:4608
ds_read_b64_tr_b16 v[52:53], v3 offset:4096
ds_read_b64_tr_b16 v[54:55], v3 offset:4608
ds_read_b64_tr_b16 v[56:57], v2 offset:6144
ds_read_b64_tr_b16 v[58:59], v2 offset:6656
ds_read_b64_tr_b16 v[60:61], v3 offset:6144
ds_read_b64_tr_b16 v[62:63], v3 offset:6656
v_dot2_f32_bf16 v28, v240, s45, v28
v_dot2_f32_bf16 v30, v240, v240, v30
v_dot2_f32_bf16 v29, v241, s45, v29
v_dot2_f32_bf16 v31, v241, v241, v31
v_dot2_f32_bf16 v28, v242, s45, v28
v_dot2_f32_bf16 v30, v242, v242, v30
v_dot2_f32_bf16 v29, v243, s45, v29
v_dot2_f32_bf16 v31, v243, v243, v31
v_dot2_f32_bf16 v28, v244, s45, v28
v_dot2_f32_bf16 v30, v244, v244, v30
v_dot2_f32_bf16 v29, v245, s45, v29
v_dot2_f32_bf16 v31, v245, v245, v31
v_dot2_f32_bf16 v28, v246, s45, v28
v_dot2_f32_bf16 v30, v246, v246, v30
v_dot2_f32_bf16 v29, v247, s45, v29
v_dot2_f32_bf16 v31, v247, v247, v31
v_dot2_f32_bf16 v28, v248, s45, v28
v_dot2_f32_bf16 v30, v248, v248, v30
v_dot2_f32_bf16 v29, v249, s45, v29
v_dot2_f32_bf16 v31, v249, v249, v31
v_dot2_f32_bf16 v28, v250, s45, v28
v_dot2_f32_bf16 v30, v250, v250, v30
v_dot2_f32_bf16 v29, v251, s45, v29
v_dot2_f32_bf16 v31, v251, v251, v31
v_dot2_f32_bf16 v28, v252, s45, v28
v_dot2_f32_bf16 v30, v252, v252, v30
v_dot2_f32_bf16 v29, v253, s45, v29
v_dot2_f32_bf16 v31, v253, v253, v31
v_dot2_f32_bf16 v28, v254, s45, v28
v_dot2_f32_bf16 v30, v254, v254, v30
v_dot2_f32_bf16 v29, v255, s45, v29
v_dot2_f32_bf16 v31, v255, v255, v31
s_nop 1
v_add_f32 v28, v28, v29
v_add_f32 v30, v30, v31
s_nop 1
v_permlane32_swap_b32 v28, v30
v_add_f32 v28, v28, v30
v_mov_b32 v30, v28
s_nop 1
v_permlane32_swap_b32 v28, v30
v_mul_f32 v10, 0x3b000000, v28
v_mul_f32 v11, 0x3b000000, v30
v_cvt_pk_bf16_f32 v29, -v10, -v10
v_lshlrev_b32 v8, 16, v29
ds_write_b64 v13, v[10:11]
s_mov_b32 s46, 0xffff0000
s_mov_b32 s44, 0x3f80
s_mov_b32 s45, 0x3f800000
v_dot2_f32_bf16 v16, v128, s44, v8
v_dot2_f32_bf16 v17, v128, s45, v8
v_dot2_f32_bf16 v18, v129, s44, v8
v_dot2_f32_bf16 v19, v129, s45, v8
v_dot2_f32_bf16 v20, v130, s44, v8
v_dot2_f32_bf16 v21, v130, s45, v8
v_dot2_f32_bf16 v22, v131, s44, v8
v_dot2_f32_bf16 v23, v131, s45, v8
v_cvt_pk_bf16_f32 v128, v16, v17
v_cvt_pk_bf16_f32 v129, v18, v19
v_cvt_pk_bf16_f32 v130, v20, v21
v_cvt_pk_bf16_f32 v131, v22, v23
v_dot2_f32_bf16 v16, v132, s44, v8
v_dot2_f32_bf16 v17, v132, s45, v8
v_dot2_f32_bf16 v18, v133, s44, v8
v_dot2_f32_bf16 v19, v133, s45, v8
v_dot2_f32_bf16 v20, v134, s44, v8
v_dot2_f32_bf16 v21, v134, s45, v8
v_dot2_f32_bf16 v22, v135, s44, v8
v_dot2_f32_bf16 v23, v135, s45, v8
v_cvt_pk_bf16_f32 v132, v16, v17
v_cvt_pk_bf16_f32 v133, v18, v19
v_cvt_pk_bf16_f32 v134, v20, v21
v_cvt_pk_bf16_f32 v135, v22, v23
v_dot2_f32_bf16 v16, v136, s44, v8
v_dot2_f32_bf16 v17, v136, s45, v8
v_dot2_f32_bf16 v18, v137, s44, v8
v_dot2_f32_bf16 v19, v137, s45, v8
v_dot2_f32_bf16 v20, v138, s44, v8
v_dot2_f32_bf16 v21, v138, s45, v8
v_dot2_f32_bf16 v22, v139, s44, v8
v_dot2_f32_bf16 v23, v139, s45, v8
v_cvt_pk_bf16_f32 v136, v16, v17
v_cvt_pk_bf16_f32 v137, v18, v19
v_cvt_pk_bf16_f32 v138, v20, v21
v_cvt_pk_bf16_f32 v139, v22, v23
v_dot2_f32_bf16 v16, v140, s44, v8
v_dot2_f32_bf16 v17, v140, s45, v8
v_dot2_f32_bf16 v18, v141, s44, v8
v_dot2_f32_bf16 v19, v141, s45, v8
v_dot2_f32_bf16 v20, v142, s44, v8
v_dot2_f32_bf16 v21, v142, s45, v8
v_dot2_f32_bf16 v22, v143, s44, v8
v_dot2_f32_bf16 v23, v143, s45, v8
v_cvt_pk_bf16_f32 v140, v16, v17
v_cvt_pk_bf16_f32 v141, v18, v19
v_cvt_pk_bf16_f32 v142, v20, v21
v_cvt_pk_bf16_f32 v143, v22, v23
v_dot2_f32_bf16 v16, v144, s44, v8
v_dot2_f32_bf16 v17, v144, s45, v8
v_dot2_f32_bf16 v18, v145, s44, v8
v_dot2_f32_bf16 v19, v145, s45, v8
v_dot2_f32_bf16 v20, v146, s44, v8
v_dot2_f32_bf16 v21, v146, s45, v8
v_dot2_f32_bf16 v22, v147, s44, v8
v_dot2_f32_bf16 v23, v147, s45, v8
v_cvt_pk_bf16_f32 v144, v16, v17
v_cvt_pk_bf16_f32 v145, v18, v19
v_cvt_pk_bf16_f32 v146, v20, v21
v_cvt_pk_bf16_f32 v147, v22, v23
v_dot2_f32_bf16 v16, v148, s44, v8
v_dot2_f32_bf16 v17, v148, s45, v8
v_dot2_f32_bf16 v18, v149, s44, v8
v_dot2_f32_bf16 v19, v149, s45, v8
v_dot2_f32_bf16 v20, v150, s44, v8
v_dot2_f32_bf16 v21, v150, s45, v8
v_dot2_f32_bf16 v22, v151, s44, v8
v_dot2_f32_bf16 v23, v151, s45, v8
v_cvt_pk_bf16_f32 v148, v16, v17
v_cvt_pk_bf16_f32 v149, v18, v19
v_cvt_pk_bf16_f32 v150, v20, v21
v_cvt_pk_bf16_f32 v151, v22, v23
v_dot2_f32_bf16 v16, v152, s44, v8
v_dot2_f32_bf16 v17, v152, s45, v8
v_dot2_f32_bf16 v18, v153, s44, v8
v_dot2_f32_bf16 v19, v153, s45, v8
v_dot2_f32_bf16 v20, v154, s44, v8
v_dot2_f32_bf16 v21, v154, s45, v8
v_dot2_f32_bf16 v22, v155, s44, v8
v_dot2_f32_bf16 v23, v155, s45, v8
v_cvt_pk_bf16_f32 v152, v16, v17
v_cvt_pk_bf16_f32 v153, v18, v19
v_cvt_pk_bf16_f32 v154, v20, v21
v_cvt_pk_bf16_f32 v155, v22, v23
v_dot2_f32_bf16 v16, v156, s44, v8
v_dot2_f32_bf16 v17, v156, s45, v8
v_dot2_f32_bf16 v18, v157, s44, v8
v_dot2_f32_bf16 v19, v157, s45, v8
v_dot2_f32_bf16 v20, v158, s44, v8
v_dot2_f32_bf16 v21, v158, s45, v8
v_dot2_f32_bf16 v22, v159, s44, v8
v_dot2_f32_bf16 v23, v159, s45, v8
v_cvt_pk_bf16_f32 v156, v16, v17
v_cvt_pk_bf16_f32 v157, v18, v19
v_cvt_pk_bf16_f32 v158, v20, v21
v_cvt_pk_bf16_f32 v159, v22, v23
v_dot2_f32_bf16 v16, v160, s44, v8
v_dot2_f32_bf16 v17, v160, s45, v8
v_dot2_f32_bf16 v18, v161, s44, v8
v_dot2_f32_bf16 v19, v161, s45, v8
v_dot2_f32_bf16 v20, v162, s44, v8
v_dot2_f32_bf16 v21, v162, s45, v8
v_dot2_f32_bf16 v22, v163, s44, v8
v_dot2_f32_bf16 v23, v163, s45, v8
v_cvt_pk_bf16_f32 v160, v16, v17
v_cvt_pk_bf16_f32 v161, v18, v19
v_cvt_pk_bf16_f32 v162, v20, v21
v_cvt_pk_bf16_f32 v163, v22, v23
v_dot2_f32_bf16 v16, v164, s44, v8
v_dot2_f32_bf16 v17, v164, s45, v8
v_dot2_f32_bf16 v18, v165, s44, v8
v_dot2_f32_bf16 v19, v165, s45, v8
v_dot2_f32_bf16 v20, v166, s44, v8
v_dot2_f32_bf16 v21, v166, s45, v8
v_dot2_f32_bf16 v22, v167, s44, v8
v_dot2_f32_bf16 v23, v167, s45, v8
v_cvt_pk_bf16_f32 v164, v16, v17
v_cvt_pk_bf16_f32 v165, v18, v19
v_cvt_pk_bf16_f32 v166, v20, v21
v_cvt_pk_bf16_f32 v167, v22, v23
v_dot2_f32_bf16 v16, v168, s44, v8
v_dot2_f32_bf16 v17, v168, s45, v8
v_dot2_f32_bf16 v18, v169, s44, v8
v_dot2_f32_bf16 v19, v169, s45, v8
v_dot2_f32_bf16 v20, v170, s44, v8
v_dot2_f32_bf16 v21, v170, s45, v8
v_dot2_f32_bf16 v22, v171, s44, v8
v_dot2_f32_bf16 v23, v171, s45, v8
v_cvt_pk_bf16_f32 v168, v16, v17
v_cvt_pk_bf16_f32 v169, v18, v19
v_cvt_pk_bf16_f32 v170, v20, v21
v_cvt_pk_bf16_f32 v171, v22, v23
v_dot2_f32_bf16 v16, v172, s44, v8
v_dot2_f32_bf16 v17, v172, s45, v8
v_dot2_f32_bf16 v18, v173, s44, v8
v_dot2_f32_bf16 v19, v173, s45, v8
v_dot2_f32_bf16 v20, v174, s44, v8
v_dot2_f32_bf16 v21, v174, s45, v8
v_dot2_f32_bf16 v22, v175, s44, v8
v_dot2_f32_bf16 v23, v175, s45, v8
v_cvt_pk_bf16_f32 v172, v16, v17
v_cvt_pk_bf16_f32 v173, v18, v19
v_cvt_pk_bf16_f32 v174, v20, v21
v_cvt_pk_bf16_f32 v175, v22, v23
v_dot2_f32_bf16 v16, v176, s44, v8
v_dot2_f32_bf16 v17, v176, s45, v8
v_dot2_f32_bf16 v18, v177, s44, v8
v_dot2_f32_bf16 v19, v177, s45, v8
v_dot2_f32_bf16 v20, v178, s44, v8
v_dot2_f32_bf16 v21, v178, s45, v8
v_dot2_f32_bf16 v22, v179, s44, v8
v_dot2_f32_bf16 v23, v179, s45, v8
v_cvt_pk_bf16_f32 v176, v16, v17
v_cvt_pk_bf16_f32 v177, v18, v19
v_cvt_pk_bf16_f32 v178, v20, v21
v_cvt_pk_bf16_f32 v179, v22, v23
v_dot2_f32_bf16 v16, v180, s44, v8
v_dot2_f32_bf16 v17, v180, s45, v8
v_dot2_f32_bf16 v18, v181, s44, v8
v_dot2_f32_bf16 v19, v181, s45, v8
v_dot2_f32_bf16 v20, v182, s44, v8
v_dot2_f32_bf16 v21, v182, s45, v8
v_dot2_f32_bf16 v22, v183, s44, v8
v_dot2_f32_bf16 v23, v183, s45, v8
v_cvt_pk_bf16_f32 v180, v16, v17
v_cvt_pk_bf16_f32 v181, v18, v19
v_cvt_pk_bf16_f32 v182, v20, v21
v_cvt_pk_bf16_f32 v183, v22, v23
v_dot2_f32_bf16 v16, v184, s44, v8
v_dot2_f32_bf16 v17, v184, s45, v8
v_dot2_f32_bf16 v18, v185, s44, v8
v_dot2_f32_bf16 v19, v185, s45, v8
v_dot2_f32_bf16 v20, v186, s44, v8
v_dot2_f32_bf16 v21, v186, s45, v8
v_dot2_f32_bf16 v22, v187, s44, v8
v_dot2_f32_bf16 v23, v187, s45, v8
v_cvt_pk_bf16_f32 v184, v16, v17
v_cvt_pk_bf16_f32 v185, v18, v19
v_cvt_pk_bf16_f32 v186, v20, v21
v_cvt_pk_bf16_f32 v187, v22, v23
v_dot2_f32_bf16 v16, v188, s44, v8
v_dot2_f32_bf16 v17, v188, s45, v8
v_dot2_f32_bf16 v18, v189, s44, v8
v_dot2_f32_bf16 v19, v189, s45, v8
v_dot2_f32_bf16 v20, v190, s44, v8
v_dot2_f32_bf16 v21, v190, s45, v8
v_dot2_f32_bf16 v22, v191, s44, v8
v_dot2_f32_bf16 v23, v191, s45, v8
v_cvt_pk_bf16_f32 v188, v16, v17
v_cvt_pk_bf16_f32 v189, v18, v19
v_cvt_pk_bf16_f32 v190, v20, v21
v_cvt_pk_bf16_f32 v191, v22, v23
v_dot2_f32_bf16 v16, v192, s44, v8
v_dot2_f32_bf16 v17, v192, s45, v8
v_dot2_f32_bf16 v18, v193, s44, v8
v_dot2_f32_bf16 v19, v193, s45, v8
v_dot2_f32_bf16 v20, v194, s44, v8
v_dot2_f32_bf16 v21, v194, s45, v8
v_dot2_f32_bf16 v22, v195, s44, v8
v_dot2_f32_bf16 v23, v195, s45, v8
v_cvt_pk_bf16_f32 v192, v16, v17
v_cvt_pk_bf16_f32 v193, v18, v19
v_cvt_pk_bf16_f32 v194, v20, v21
v_cvt_pk_bf16_f32 v195, v22, v23
v_dot2_f32_bf16 v16, v196, s44, v8
v_dot2_f32_bf16 v17, v196, s45, v8
v_dot2_f32_bf16 v18, v197, s44, v8
v_dot2_f32_bf16 v19, v197, s45, v8
v_dot2_f32_bf16 v20, v198, s44, v8
v_dot2_f32_bf16 v21, v198, s45, v8
v_dot2_f32_bf16 v22, v199, s44, v8
v_dot2_f32_bf16 v23, v199, s45, v8
v_cvt_pk_bf16_f32 v196, v16, v17
v_cvt_pk_bf16_f32 v197, v18, v19
v_cvt_pk_bf16_f32 v198, v20, v21
v_cvt_pk_bf16_f32 v199, v22, v23
v_dot2_f32_bf16 v16, v200, s44, v8
v_dot2_f32_bf16 v17, v200, s45, v8
v_dot2_f32_bf16 v18, v201, s44, v8
v_dot2_f32_bf16 v19, v201, s45, v8
v_dot2_f32_bf16 v20, v202, s44, v8
v_dot2_f32_bf16 v21, v202, s45, v8
v_dot2_f32_bf16 v22, v203, s44, v8
v_dot2_f32_bf16 v23, v203, s45, v8
v_cvt_pk_bf16_f32 v200, v16, v17
v_cvt_pk_bf16_f32 v201, v18, v19
v_cvt_pk_bf16_f32 v202, v20, v21
v_cvt_pk_bf16_f32 v203, v22, v23
v_dot2_f32_bf16 v16, v204, s44, v8
v_dot2_f32_bf16 v17, v204, s45, v8
v_dot2_f32_bf16 v18, v205, s44, v8
v_dot2_f32_bf16 v19, v205, s45, v8
v_dot2_f32_bf16 v20, v206, s44, v8
v_dot2_f32_bf16 v21, v206, s45, v8
v_dot2_f32_bf16 v22, v207, s44, v8
v_dot2_f32_bf16 v23, v207, s45, v8
v_cvt_pk_bf16_f32 v204, v16, v17
v_cvt_pk_bf16_f32 v205, v18, v19
v_cvt_pk_bf16_f32 v206, v20, v21
v_cvt_pk_bf16_f32 v207, v22, v23
v_dot2_f32_bf16 v16, v208, s44, v8
v_dot2_f32_bf16 v17, v208, s45, v8
v_dot2_f32_bf16 v18, v209, s44, v8
v_dot2_f32_bf16 v19, v209, s45, v8
v_dot2_f32_bf16 v20, v210, s44, v8
v_dot2_f32_bf16 v21, v210, s45, v8
v_dot2_f32_bf16 v22, v211, s44, v8
v_dot2_f32_bf16 v23, v211, s45, v8
v_cvt_pk_bf16_f32 v208, v16, v17
v_cvt_pk_bf16_f32 v209, v18, v19
v_cvt_pk_bf16_f32 v210, v20, v21
v_cvt_pk_bf16_f32 v211, v22, v23
v_dot2_f32_bf16 v16, v212, s44, v8
v_dot2_f32_bf16 v17, v212, s45, v8
v_dot2_f32_bf16 v18, v213, s44, v8
v_dot2_f32_bf16 v19, v213, s45, v8
v_dot2_f32_bf16 v20, v214, s44, v8
v_dot2_f32_bf16 v21, v214, s45, v8
v_dot2_f32_bf16 v22, v215, s44, v8
v_dot2_f32_bf16 v23, v215, s45, v8
v_cvt_pk_bf16_f32 v212, v16, v17
v_cvt_pk_bf16_f32 v213, v18, v19
v_cvt_pk_bf16_f32 v214, v20, v21
v_cvt_pk_bf16_f32 v215, v22, v23
s_waitcnt lgkmcnt(9)
v_mfma_f32_32x32x16_bf16 v[64:79], v[32:35], v[128:131], 0
ds_read_b64_tr_b16 v[32:33], v2 offset:8192
ds_read_b64_tr_b16 v[34:35], v2 offset:8704
v_lshlrev_b32 v16, 16, v216
v_and_b32 v17, s46, v216
v_lshlrev_b32 v18, 16, v217
v_and_b32 v19, s46, v217
v_mfma_f32_32x32x16_bf16 v[80:95], v[36:39], v[128:131], 0
ds_read_b64_tr_b16 v[36:37], v3 offset:8192
ds_read_b64_tr_b16 v[38:39], v3 offset:8704
v_add_f32 v16, v16, v8
v_add_f32 v17, v17, v8
v_add_f32 v18, v18, v8
v_add_f32 v19, v19, v8
v_mfma_f32_32x32x16_bf16 v[64:79], v[40:43], v[132:135], v[64:79]
ds_read_b64_tr_b16 v[40:41], v2 offset:10240
ds_read_b64_tr_b16 v[42:43], v2 offset:10752
v_cvt_pk_bf16_f32 v216, v16, v17
v_cvt_pk_bf16_f32 v217, v18, v19
v_lshlrev_b32 v20, 16, v218
v_and_b32 v21, s46, v218
v_mfma_f32_32x32x16_bf16 v[80:95], v[44:47], v[132:135], v[80:95]
ds_read_b64_tr_b16 v[44:45], v3 offset:10240
ds_read_b64_tr_b16 v[46:47], v3 offset:10752
v_lshlrev_b32 v22, 16, v219
v_and_b32 v23, s46, v219
v_add_f32 v20, v20, v8
s_waitcnt lgkmcnt(9)
v_mfma_f32_32x32x16_bf16 v[64:79], v[48:51], v[136:139], v[64:79]
ds_read_b64_tr_b16 v[48:49], v2 offset:12288
ds_read_b64_tr_b16 v[50:51], v2 offset:12800
v_add_f32 v21, v21, v8
v_add_f32 v22, v22, v8
v_add_f32 v23, v23, v8
v_cvt_pk_bf16_f32 v218, v20, v21
v_mfma_f32_32x32x16_bf16 v[80:95], v[52:55], v[136:139], v[80:95]
ds_read_b64_tr_b16 v[52:53], v3 offset:12288
ds_read_b64_tr_b16 v[54:55], v3 offset:12800
v_cvt_pk_bf16_f32 v219, v22, v23
v_lshlrev_b32 v16, 16, v220
v_and_b32 v17, s46, v220
v_lshlrev_b32 v18, 16, v221
v_mfma_f32_32x32x16_bf16 v[64:79], v[56:59], v[140:143], v[64:79]
ds_read_b64_tr_b16 v[56:57], v2 offset:14336
ds_read_b64_tr_b16 v[58:59], v2 offset:14848
v_and_b32 v19, s46, v221
v_add_f32 v16, v16, v8
v_add_f32 v17, v17, v8
v_add_f32 v18, v18, v8
v_mfma_f32_32x32x16_bf16 v[80:95], v[60:63], v[140:143], v[80:95]
ds_read_b64_tr_b16 v[60:61], v3 offset:14336
ds_read_b64_tr_b16 v[62:63], v3 offset:14848
v_add_f32 v19, v19, v8
v_cvt_pk_bf16_f32 v220, v16, v17
v_cvt_pk_bf16_f32 v221, v18, v19
s_waitcnt lgkmcnt(8)
v_mfma_f32_32x32x16_bf16 v[64:79], v[32:35], v[144:147], v[64:79]
s_barrier
ds_read_b64_tr_b16 v[32:33], v2 offset:16384
ds_read_b64_tr_b16 v[34:35], v2 offset:16896
v_lshlrev_b32 v20, 16, v222
v_and_b32 v21, s46, v222
v_lshlrev_b32 v22, 16, v223
v_mfma_f32_32x32x16_bf16 v[80:95], v[36:39], v[144:147], v[80:95]
ds_read_b64_tr_b16 v[36:37], v3 offset:16384
ds_read_b64_tr_b16 v[38:39], v3 offset:16896
v_and_b32 v23, s46, v223
v_add_f32 v20, v20, v8
v_add_f32 v21, v21, v8
v_add_f32 v22, v22, v8
v_mfma_f32_32x32x16_bf16 v[64:79], v[40:43], v[148:151], v[64:79]
ds_read_b64_tr_b16 v[40:41], v2 offset:18432
ds_read_b64_tr_b16 v[42:43], v2 offset:18944
v_add_f32 v23, v23, v8
v_cvt_pk_bf16_f32 v222, v20, v21
v_cvt_pk_bf16_f32 v223, v22, v23
v_lshlrev_b32 v16, 16, v224
v_mfma_f32_32x32x16_bf16 v[80:95], v[44:47], v[148:151], v[80:95]
ds_read_b64_tr_b16 v[44:45], v3 offset:18432
ds_read_b64_tr_b16 v[46:47], v3 offset:18944
v_and_b32 v17, s46, v224
v_lshlrev_b32 v18, 16, v225
v_and_b32 v19, s46, v225
s_waitcnt lgkmcnt(8)
v_mfma_f32_32x32x16_bf16 v[64:79], v[48:51], v[152:155], v[64:79]
ds_read_b64_tr_b16 v[48:49], v2 offset:20480
ds_read_b64_tr_b16 v[50:51], v2 offset:20992
v_add_f32 v16, v16, v8
v_add_f32 v17, v17, v8
v_add_f32 v18, v18, v8
v_add_f32 v19, v19, v8
v_mfma_f32_32x32x16_bf16 v[80:95], v[52:55], v[152:155], v[80:95]
ds_read_b64_tr_b16 v[52:53], v3 offset:20480
ds_read_b64_tr_b16 v[54:55], v3 offset:20992
v_cvt_pk_bf16_f32 v224, v16, v17
v_cvt_pk_bf16_f32 v225, v18, v19
v_lshlrev_b32 v20, 16, v226
v_and_b32 v21, s46, v226
v_mfma_f32_32x32x16_bf16 v[64:79], v[56:59], v[156:159], v[64:79]
ds_read_b64_tr_b16 v[56:57], v2 offset:22528
ds_read_b64_tr_b16 v[58:59], v2 offset:23040
v_lshlrev_b32 v22, 16, v227
v_and_b32 v23, s46, v227
v_add_f32 v20, v20, v8
v_add_f32 v21, v21, v8
v_mfma_f32_32x32x16_bf16 v[80:95], v[60:63], v[156:159], v[80:95]
ds_read_b64_tr_b16 v[60:61], v3 offset:22528
ds_read_b64_tr_b16 v[62:63], v3 offset:23040
v_add_f32 v22, v22, v8
v_add_f32 v23, v23, v8
v_cvt_pk_bf16_f32 v226, v20, v21
s_waitcnt lgkmcnt(8)
v_mfma_f32_32x32x16_bf16 v[64:79], v[32:35], v[160:163], v[64:79]
ds_read_b64_tr_b16 v[32:33], v2 offset:24576
ds_read_b64_tr_b16 v[34:35], v2 offset:25088
v_cvt_pk_bf16_f32 v227, v22, v23
v_lshlrev_b32 v16, 16, v228
v_and_b32 v17, s46, v228
v_lshlrev_b32 v18, 16, v229
v_mfma_f32_32x32x16_bf16 v[80:95], v[36:39], v[160:163], v[80:95]
ds_read_b64_tr_b16 v[36:37], v3 offset:24576
ds_read_b64_tr_b16 v[38:39], v3 offset:25088
v_and_b32 v19, s46, v229
v_add_f32 v16, v16, v8
v_add_f32 v17, v17, v8
v_add_f32 v18, v18, v8
v_mfma_f32_32x32x16_bf16 v[64:79], v[40:43], v[164:167], v[64:79]
ds_read_b64_tr_b16 v[40:41], v2 offset:26624
ds_read_b64_tr_b16 v[42:43], v2 offset:27136
v_add_f32 v19, v19, v8
v_cvt_pk_bf16_f32 v228, v16, v17
v_cvt_pk_bf16_f32 v229, v18, v19
v_lshlrev_b32 v20, 16, v230
v_mfma_f32_32x32x16_bf16 v[80:95], v[44:47], v[164:167], v[80:95]
ds_read_b64_tr_b16 v[44:45], v3 offset:26624
ds_read_b64_tr_b16 v[46:47], v3 offset:27136
v_and_b32 v21, s46, v230
v_lshlrev_b32 v22, 16, v231
v_and_b32 v23, s46, v231
s_waitcnt lgkmcnt(8)
v_mfma_f32_32x32x16_bf16 v[64:79], v[48:51], v[168:171], v[64:79]
ds_read_b64_tr_b16 v[48:49], v2 offset:28672
ds_read_b64_tr_b16 v[50:51], v2 offset:29184
v_add_f32 v20, v20, v8
v_add_f32 v21, v21, v8
v_add_f32 v22, v22, v8
v_add_f32 v23, v23, v8
v_mfma_f32_32x32x16_bf16 v[80:95], v[52:55], v[168:171], v[80:95]
ds_read_b64_tr_b16 v[52:53], v3 offset:28672
ds_read_b64_tr_b16 v[54:55], v3 offset:29184
v_cvt_pk_bf16_f32 v230, v20, v21
v_cvt_pk_bf16_f32 v231, v22, v23
v_lshlrev_b32 v16, 16, v232
v_and_b32 v17, s46, v232
v_mfma_f32_32x32x16_bf16 v[64:79], v[56:59], v[172:175], v[64:79]
ds_read_b64_tr_b16 v[56:57], v2 offset:30720
ds_read_b64_tr_b16 v[58:59], v2 offset:31232
v_lshlrev_b32 v18, 16, v233
v_and_b32 v19, s46, v233
v_add_f32 v16, v16, v8
v_add_f32 v17, v17, v8
v_mfma_f32_32x32x16_bf16 v[80:95], v[60:63], v[172:175], v[80:95]
ds_read_b64_tr_b16 v[60:61], v3 offset:30720
ds_read_b64_tr_b16 v[62:63], v3 offset:31232
v_add_f32 v18, v18, v8
v_add_f32 v19, v19, v8
v_cvt_pk_bf16_f32 v232, v16, v17
s_waitcnt lgkmcnt(8)
v_mfma_f32_32x32x16_bf16 v[64:79], v[32:35], v[176:179], v[64:79]
s_barrier
ds_read_b64_tr_b16 v[32:33], v2 offset:32768
ds_read_b64_tr_b16 v[34:35], v2 offset:33280
v_cvt_pk_bf16_f32 v233, v18, v19
v_lshlrev_b32 v20, 16, v234
v_and_b32 v21, s46, v234
v_mfma_f32_32x32x16_bf16 v[80:95], v[36:39], v[176:179], v[80:95]
ds_read_b64_tr_b16 v[36:37], v3 offset:32768
ds_read_b64_tr_b16 v[38:39], v3 offset:33280
v_lshlrev_b32 v22, 16, v235
v_and_b32 v23, s46, v235
v_add_f32 v20, v20, v8
v_add_f32 v21, v21, v8
v_mfma_f32_32x32x16_bf16 v[64:79], v[40:43], v[180:183], v[64:79]
ds_read_b64_tr_b16 v[40:41], v2 offset:34816
ds_read_b64_tr_b16 v[42:43], v2 offset:35328
v_add_f32 v22, v22, v8
v_add_f32 v23, v23, v8
v_cvt_pk_bf16_f32 v234, v20, v21
v_cvt_pk_bf16_f32 v235, v22, v23
v_mfma_f32_32x32x16_bf16 v[80:95], v[44:47], v[180:183], v[80:95]
ds_read_b64_tr_b16 v[44:45], v3 offset:34816
ds_read_b64_tr_b16 v[46:47], v3 offset:35328
v_lshlrev_b32 v16, 16, v236
v_and_b32 v17, s46, v236
v_lshlrev_b32 v18, 16, v237
s_waitcnt lgkmcnt(8)
v_mfma_f32_32x32x16_bf16 v[64:79], v[48:51], v[184:187], v[64:79]
ds_read_b64_tr_b16 v[48:49], v2 offset:36864
ds_read_b64_tr_b16 v[50:51], v2 offset:37376
v_and_b32 v19, s46, v237
v_add_f32 v16, v16, v8
v_add_f32 v17, v17, v8
v_add_f32 v18, v18, v8
v_mfma_f32_32x32x16_bf16 v[80:95], v[52:55], v[184:187], v[80:95]
ds_read_b64_tr_b16 v[52:53], v3 offset:36864
ds_read_b64_tr_b16 v[54:55], v3 offset:37376
v_add_f32 v19, v19, v8
v_cvt_pk_bf16_f32 v236, v16, v17
v_cvt_pk_bf16_f32 v237, v18, v19
v_lshlrev_b32 v20, 16, v238
v_mfma_f32_32x32x16_bf16 v[64:79], v[56:59], v[188:191], v[64:79]
ds_read_b64_tr_b16 v[56:57], v2 offset:38912
ds_read_b64_tr_b16 v[58:59], v2 offset:39424
v_and_b32 v21, s46, v238
v_lshlrev_b32 v22, 16, v239
v_and_b32 v23, s46, v239
v_add_f32 v20, v20, v8
v_mfma_f32_32x32x16_bf16 v[80:95], v[60:63], v[188:191], v[80:95]
ds_read_b64_tr_b16 v[60:61], v3 offset:38912
ds_read_b64_tr_b16 v[62:63], v3 offset:39424
v_add_f32 v21, v21, v8
v_add_f32 v22, v22, v8
v_add_f32 v23, v23, v8
s_waitcnt lgkmcnt(8)
v_mfma_f32_32x32x16_bf16 v[64:79], v[32:35], v[192:195], v[64:79]
ds_read_b64_tr_b16 v[32:33], v2 offset:40960
ds_read_b64_tr_b16 v[34:35], v2 offset:41472
v_cvt_pk_bf16_f32 v238, v20, v21
v_cvt_pk_bf16_f32 v239, v22, v23
v_lshlrev_b32 v16, 16, v240
v_and_b32 v17, s46, v240
v_mfma_f32_32x32x16_bf16 v[80:95], v[36:39], v[192:195], v[80:95]
ds_read_b64_tr_b16 v[36:37], v3 offset:40960
ds_read_b64_tr_b16 v[38:39], v3 offset:41472
v_lshlrev_b32 v18, 16, v241
v_and_b32 v19, s46, v241
v_add_f32 v16, v16, v8
v_add_f32 v17, v17, v8
v_mfma_f32_32x32x16_bf16 v[64:79], v[40:43], v[196:199], v[64:79]
ds_read_b64_tr_b16 v[40:41], v2 offset:43008
ds_read_b64_tr_b16 v[42:43], v2 offset:43520
v_add_f32 v18, v18, v8
v_add_f32 v19, v19, v8
v_cvt_pk_bf16_f32 v240, v16, v17
v_cvt_pk_bf16_f32 v241, v18, v19
v_mfma_f32_32x32x16_bf16 v[80:95], v[44:47], v[196:199], v[80:95]
ds_read_b64_tr_b16 v[44:45], v3 offset:43008
ds_read_b64_tr_b16 v[46:47], v3 offset:43520
v_lshlrev_b32 v20, 16, v242
v_and_b32 v21, s46, v242
v_lshlrev_b32 v22, 16, v243
s_waitcnt lgkmcnt(8)
v_mfma_f32_32x32x16_bf16 v[64:79], v[48:51], v[200:203], v[64:79]
ds_read_b64_tr_b16 v[48:49], v2 offset:45056
ds_read_b64_tr_b16 v[50:51], v2 offset:45568
v_and_b32 v23, s46, v243
v_add_f32 v20, v20, v8
v_add_f32 v21, v21, v8
v_add_f32 v22, v22, v8
v_mfma_f32_32x32x16_bf16 v[80:95], v[52:55], v[200:203], v[80:95]
ds_read_b64_tr_b16 v[52:53], v3 offset:45056
ds_read_b64_tr_b16 v[54:55], v3 offset:45568
v_add_f32 v23, v23, v8
v_cvt_pk_bf16_f32 v242, v20, v21
v_cvt_pk_bf16_f32 v243, v22, v23
v_lshlrev_b32 v16, 16, v244
v_mfma_f32_32x32x16_bf16 v[64:79], v[56:59], v[204:207], v[64:79]
ds_read_b64_tr_b16 v[56:57], v2 offset:47104
ds_read_b64_tr_b16 v[58:59], v2 offset:47616
v_and_b32 v17, s46, v244
v_lshlrev_b32 v18, 16, v245
v_and_b32 v19, s46, v245
v_add_f32 v16, v16, v8
v_mfma_f32_32x32x16_bf16 v[80:95], v[60:63], v[204:207], v[80:95]
ds_read_b64_tr_b16 v[60:61], v3 offset:47104
ds_read_b64_tr_b16 v[62:63], v3 offset:47616
v_add_f32 v17, v17, v8
v_add_f32 v18, v18, v8
v_add_f32 v19, v19, v8
s_waitcnt lgkmcnt(8)
v_mfma_f32_32x32x16_bf16 v[64:79], v[32:35], v[208:211], v[64:79]
s_barrier
ds_read_b64_tr_b16 v[32:33], v2 offset:49152
ds_read_b64_tr_b16 v[34:35], v2 offset:49664
v_cvt_pk_bf16_f32 v244, v16, v17
v_cvt_pk_bf16_f32 v245, v18, v19
v_lshlrev_b32 v20, 16, v246
v_mfma_f32_32x32x16_bf16 v[80:95], v[36:39], v[208:211], v[80:95]
ds_read_b64_tr_b16 v[36:37], v3 offset:49152
ds_read_b64_tr_b16 v[38:39], v3 offset:49664
v_and_b32 v21, s46, v246
v_lshlrev_b32 v22, 16, v247
v_and_b32 v23, s46, v247
v_add_f32 v20, v20, v8
v_mfma_f32_32x32x16_bf16 v[64:79], v[40:43], v[212:215], v[64:79]
ds_read_b64_tr_b16 v[40:41], v2 offset:51200
ds_read_b64_tr_b16 v[42:43], v2 offset:51712
v_add_f32 v21, v21, v8
v_add_f32 v22, v22, v8
v_add_f32 v23, v23, v8
v_cvt_pk_bf16_f32 v246, v20, v21
v_mfma_f32_32x32x16_bf16 v[80:95], v[44:47], v[212:215], v[80:95]
ds_read_b64_tr_b16 v[44:45], v3 offset:51200
ds_read_b64_tr_b16 v[46:47], v3 offset:51712
v_cvt_pk_bf16_f32 v247, v22, v23
v_lshlrev_b32 v16, 16, v248
v_and_b32 v17, s46, v248
s_waitcnt lgkmcnt(8)
v_mfma_f32_32x32x16_bf16 v[64:79], v[48:51], v[216:219], v[64:79]
ds_read_b64_tr_b16 v[48:49], v2 offset:53248
ds_read_b64_tr_b16 v[50:51], v2 offset:53760
v_lshlrev_b32 v18, 16, v249
v_and_b32 v19, s46, v249
v_add_f32 v16, v16, v8
v_add_f32 v17, v17, v8
v_mfma_f32_32x32x16_bf16 v[80:95], v[52:55], v[216:219], v[80:95]
ds_read_b64_tr_b16 v[52:53], v3 offset:53248
ds_read_b64_tr_b16 v[54:55], v3 offset:53760
v_add_f32 v18, v18, v8
v_add_f32 v19, v19, v8
v_cvt_pk_bf16_f32 v248, v16, v17
v_cvt_pk_bf16_f32 v249, v18, v19
v_mfma_f32_32x32x16_bf16 v[64:79], v[56:59], v[220:223], v[64:79]
ds_read_b64_tr_b16 v[56:57], v2 offset:55296
ds_read_b64_tr_b16 v[58:59], v2 offset:55808
v_lshlrev_b32 v20, 16, v250
v_and_b32 v21, s46, v250
v_lshlrev_b32 v22, 16, v251
v_and_b32 v23, s46, v251
v_mfma_f32_32x32x16_bf16 v[80:95], v[60:63], v[220:223], v[80:95]
ds_read_b64_tr_b16 v[60:61], v3 offset:55296
ds_read_b64_tr_b16 v[62:63], v3 offset:55808
v_add_f32 v20, v20, v8
v_add_f32 v21, v21, v8
v_add_f32 v22, v22, v8
s_waitcnt lgkmcnt(8)
v_mfma_f32_32x32x16_bf16 v[64:79], v[32:35], v[224:227], v[64:79]
ds_read_b64_tr_b16 v[32:33], v2 offset:57344
ds_read_b64_tr_b16 v[34:35], v2 offset:57856
v_add_f32 v23, v23, v8
v_cvt_pk_bf16_f32 v250, v20, v21
v_cvt_pk_bf16_f32 v251, v22, v23
v_lshlrev_b32 v16, 16, v252
v_mfma_f32_32x32x16_bf16 v[80:95], v[36:39], v[224:227], v[80:95]
ds_read_b64_tr_b16 v[36:37], v2 offset:59392
ds_read_b64_tr_b16 v[38:39], v2 offset:59904
v_and_b32 v17, s46, v252
v_lshlrev_b32 v18, 16, v253
v_and_b32 v19, s46, v253
v_add_f32 v16, v16, v8
v_mfma_f32_32x32x16_bf16 v[64:79], v[40:43], v[228:231], v[64:79]
ds_read_b64_tr_b16 v[40:41], v2 offset:61440
ds_read_b64_tr_b16 v[42:43], v2 offset:61952
v_add_f32 v17, v17, v8
v_add_f32 v18, v18, v8
v_add_f32 v19, v19, v8
v_cvt_pk_bf16_f32 v252, v16, v17
v_mfma_f32_32x32x16_bf16 v[80:95], v[44:47], v[228:231], v[80:95]
ds_read_b64_tr_b16 v[44:45], v2 offset:63488
ds_read_b64_tr_b16 v[46:47], v2 offset:64000
v_cvt_pk_bf16_f32 v253, v18, v19
v_lshlrev_b32 v20, 16, v254
v_and_b32 v21, s46, v254
s_waitcnt lgkmcnt(8)
v_mfma_f32_32x32x16_bf16 v[64:79], v[48:51], v[232:235], v[64:79]
ds_read_b64_tr_b16 v[48:49], v3 offset:57344
ds_read_b64_tr_b16 v[50:51], v3 offset:57856
v_lshlrev_b32 v22, 16, v255
v_and_b32 v23, s46, v255
v_add_f32 v20, v20, v8
v_add_f32 v21, v21, v8
v_mfma_f32_32x32x16_bf16 v[80:95], v[52:55], v[232:235], v[80:95]
ds_read_b64_tr_b16 v[52:53], v3 offset:59392
ds_read_b64_tr_b16 v[54:55], v3 offset:59904
v_add_f32 v22, v22, v8
v_add_f32 v23, v23, v8
v_cvt_pk_bf16_f32 v254, v20, v21
v_cvt_pk_bf16_f32 v255, v22, v23
v_mfma_f32_32x32x16_bf16 v[64:79], v[56:59], v[236:239], v[64:79]
ds_read_b64_tr_b16 v[56:57], v3 offset:61440
ds_read_b64_tr_b16 v[58:59], v3 offset:61952
v_mfma_f32_32x32x16_bf16 v[80:95], v[60:63], v[236:239], v[80:95]
ds_read_b64_tr_b16 v[60:61], v3 offset:63488
ds_read_b64_tr_b16 v[62:63], v3 offset:64000
s_waitcnt lgkmcnt(8)
v_mfma_f32_32x32x16_bf16 v[64:79], v[32:35], v[240:243], v[64:79]
s_barrier
v_xor_b32 v2, 0x20000, v14
v_xor_b32 v3, 0x20040, v14
ds_read_b64_tr_b16 v[32:33], v2 offset:0
ds_read_b64_tr_b16 v[34:35], v2 offset:512
v_mfma_f32_32x32x16_bf16 v[64:79], v[36:39], v[244:247], v[64:79]
ds_read_b64_tr_b16 v[36:37], v3 offset:0
ds_read_b64_tr_b16 v[38:39], v3 offset:512
v_mfma_f32_32x32x16_bf16 v[64:79], v[40:43], v[248:251], v[64:79]
ds_read_b64_tr_b16 v[40:41], v2 offset:2048
ds_read_b64_tr_b16 v[42:43], v2 offset:2560
v_mfma_f32_32x32x16_bf16 v[64:79], v[44:47], v[252:255], v[64:79]
ds_read_b64_tr_b16 v[44:45], v3 offset:2048
ds_read_b64_tr_b16 v[46:47], v3 offset:2560
s_waitcnt lgkmcnt(8)
v_mfma_f32_32x32x16_bf16 v[80:95], v[48:51], v[240:243], v[80:95]
ds_read_b64_tr_b16 v[48:49], v2 offset:4096
ds_read_b64_tr_b16 v[50:51], v2 offset:4608
v_mfma_f32_32x32x16_bf16 v[80:95], v[52:55], v[244:247], v[80:95]
ds_read_b64_tr_b16 v[52:53], v3 offset:4096
ds_read_b64_tr_b16 v[54:55], v3 offset:4608
v_mfma_f32_32x32x16_bf16 v[80:95], v[56:59], v[248:251], v[80:95]
ds_read_b64_tr_b16 v[56:57], v2 offset:6144
ds_read_b64_tr_b16 v[58:59], v2 offset:6656
v_cvt_pk_bf16_f32 v16, v64, v65
v_cvt_pk_bf16_f32 v17, v66, v67
v_mfma_f32_32x32x16_bf16 v[80:95], v[60:63], v[252:255], v[80:95]
ds_write_addtid_b32 v16 offset:6144
ds_write_addtid_b32 v17 offset:6400
ds_read_b64_tr_b16 v[60:61], v3 offset:6144
ds_read_b64_tr_b16 v[62:63], v3 offset:6656
v_cvt_pk_bf16_f32 v18, v68, v69
v_cvt_pk_bf16_f32 v19, v70, v71
s_waitcnt lgkmcnt(10)
v_mfma_f32_32x32x16_bf16 v[96:111], v[128:131], v[32:35], 0
ds_write_addtid_b32 v18 offset:6656
ds_write_addtid_b32 v19 offset:6912
ds_read_b64_tr_b16 v[32:33], v2 offset:8192
ds_read_b64_tr_b16 v[34:35], v2 offset:8704
v_cvt_pk_bf16_f32 v20, v72, v73
v_cvt_pk_bf16_f32 v21, v74, v75
v_mfma_f32_32x32x16_bf16 v[112:127], v[128:131], v[36:39], 0
ds_write_addtid_b32 v20 offset:7168
ds_write_addtid_b32 v21 offset:7424
ds_read_b64_tr_b16 v[36:37], v3 offset:8192
ds_read_b64_tr_b16 v[38:39], v3 offset:8704
v_cvt_pk_bf16_f32 v22, v76, v77
v_cvt_pk_bf16_f32 v23, v78, v79
v_mfma_f32_32x32x16_bf16 v[96:111], v[132:135], v[40:43], v[96:111]
ds_write_addtid_b32 v22 offset:7680
ds_write_addtid_b32 v23 offset:7936
ds_read_b64_tr_b16 v[40:41], v2 offset:10240
ds_read_b64_tr_b16 v[42:43], v2 offset:10752
v_cvt_pk_bf16_f32 v24, v80, v81
v_cvt_pk_bf16_f32 v25, v82, v83
v_mfma_f32_32x32x16_bf16 v[112:127], v[132:135], v[44:47], v[112:127]
ds_write_addtid_b32 v24 offset:8192
ds_write_addtid_b32 v25 offset:8448
ds_read_b64_tr_b16 v[44:45], v3 offset:10240
ds_read_b64_tr_b16 v[46:47], v3 offset:10752
v_cvt_pk_bf16_f32 v26, v84, v85
v_cvt_pk_bf16_f32 v27, v86, v87
s_waitcnt lgkmcnt(15)
v_mfma_f32_32x32x16_bf16 v[96:111], v[136:139], v[48:51], v[96:111]
ds_write_addtid_b32 v26 offset:8704
ds_write_addtid_b32 v27 offset:8960
ds_read_b64_tr_b16 v[48:49], v2 offset:12288
ds_read_b64_tr_b16 v[50:51], v2 offset:12800
v_cvt_pk_bf16_f32 v28, v88, v89
v_cvt_pk_bf16_f32 v29, v90, v91
v_mfma_f32_32x32x16_bf16 v[112:127], v[136:139], v[52:55], v[112:127]
ds_write_addtid_b32 v28 offset:9216
ds_write_addtid_b32 v29 offset:9472
ds_read_b64_tr_b16 v[52:53], v3 offset:12288
ds_read_b64_tr_b16 v[54:55], v3 offset:12800
v_cvt_pk_bf16_f32 v30, v92, v93
v_cvt_pk_bf16_f32 v31, v94, v95
v_mfma_f32_32x32x16_bf16 v[96:111], v[140:143], v[56:59], v[96:111]
ds_write_addtid_b32 v30 offset:9728
ds_write_addtid_b32 v31 offset:9984
ds_read_b64_tr_b16 v[56:57], v2 offset:14336
ds_read_b64_tr_b16 v[58:59], v2 offset:14848
v_mfma_f32_32x32x16_bf16 v[112:127], v[140:143], v[60:63], v[112:127]
ds_read_b64_tr_b16 v[60:61], v3 offset:14336
ds_read_b64_tr_b16 v[62:63], v3 offset:14848
s_waitcnt lgkmcnt(14)
v_mfma_f32_32x32x16_bf16 v[96:111], v[144:147], v[32:35], v[96:111]
s_waitcnt lgkmcnt(4)
s_barrier
ds_read_b64_tr_b16 v[32:33], v2 offset:16384
ds_read_b64_tr_b16 v[34:35], v2 offset:16896
v_mfma_f32_32x32x16_bf16 v[112:127], v[144:147], v[36:39], v[112:127]
ds_read_b64_tr_b16 v[36:37], v3 offset:16384
ds_read_b64_tr_b16 v[38:39], v3 offset:16896
v_mfma_f32_32x32x16_bf16 v[96:111], v[148:151], v[40:43], v[96:111]
ds_read_b64_tr_b16 v[40:41], v2 offset:18432
ds_read_b64_tr_b16 v[42:43], v2 offset:18944
v_mfma_f32_32x32x16_bf16 v[112:127], v[148:151], v[44:47], v[112:127]
ds_read_b64_tr_b16 v[44:45], v3 offset:18432
ds_read_b64_tr_b16 v[46:47], v3 offset:18944
s_waitcnt lgkmcnt(8)
v_mfma_f32_32x32x16_bf16 v[96:111], v[152:155], v[48:51], v[96:111]
ds_read_b64_tr_b16 v[48:49], v2 offset:20480
ds_read_b64_tr_b16 v[50:51], v2 offset:20992
v_mfma_f32_32x32x16_bf16 v[112:127], v[152:155], v[52:55], v[112:127]
ds_read_b64_tr_b16 v[52:53], v3 offset:20480
ds_read_b64_tr_b16 v[54:55], v3 offset:20992
v_mfma_f32_32x32x16_bf16 v[96:111], v[156:159], v[56:59], v[96:111]
ds_read_b64_tr_b16 v[56:57], v2 offset:22528
ds_read_b64_tr_b16 v[58:59], v2 offset:23040
v_mfma_f32_32x32x16_bf16 v[112:127], v[156:159], v[60:63], v[112:127]
ds_read_b64_tr_b16 v[60:61], v3 offset:22528
ds_read_b64_tr_b16 v[62:63], v3 offset:23040
s_waitcnt lgkmcnt(8)
v_mfma_f32_32x32x16_bf16 v[96:111], v[160:163], v[32:35], v[96:111]
ds_read_b64_tr_b16 v[32:33], v2 offset:24576
ds_read_b64_tr_b16 v[34:35], v2 offset:25088
v_mfma_f32_32x32x16_bf16 v[112:127], v[160:163], v[36:39], v[112:127]
ds_read_b64_tr_b16 v[36:37], v3 offset:24576
ds_read_b64_tr_b16 v[38:39], v3 offset:25088
v_mfma_f32_32x32x16_bf16 v[96:111], v[164:167], v[40:43], v[96:111]
ds_read_b64_tr_b16 v[40:41], v2 offset:26624
ds_read_b64_tr_b16 v[42:43], v2 offset:27136
v_mfma_f32_32x32x16_bf16 v[112:127], v[164:167], v[44:47], v[112:127]
ds_read_b64_tr_b16 v[44:45], v3 offset:26624
ds_read_b64_tr_b16 v[46:47], v3 offset:27136
s_waitcnt lgkmcnt(8)
v_mfma_f32_32x32x16_bf16 v[96:111], v[168:171], v[48:51], v[96:111]
ds_read_b64_tr_b16 v[48:49], v2 offset:28672
ds_read_b64_tr_b16 v[50:51], v2 offset:29184
v_mfma_f32_32x32x16_bf16 v[112:127], v[168:171], v[52:55], v[112:127]
ds_read_b64_tr_b16 v[52:53], v3 offset:28672
ds_read_b64_tr_b16 v[54:55], v3 offset:29184
v_mfma_f32_32x32x16_bf16 v[96:111], v[172:175], v[56:59], v[96:111]
ds_read_b64_tr_b16 v[56:57], v2 offset:30720
ds_read_b64_tr_b16 v[58:59], v2 offset:31232
v_mfma_f32_32x32x16_bf16 v[112:127], v[172:175], v[60:63], v[112:127]
ds_read_b64_tr_b16 v[60:61], v3 offset:30720
ds_read_b64_tr_b16 v[62:63], v3 offset:31232
s_waitcnt lgkmcnt(8)
v_mfma_f32_32x32x16_bf16 v[96:111], v[176:179], v[32:35], v[96:111]
s_barrier
v_xor_b32 v2, 0x10000, v14
v_xor_b32 v3, 0x10040, v14
ds_read_b64_tr_b16 v[32:33], v2 offset:0
ds_read_b64_tr_b16 v[34:35], v2 offset:512
v_mfma_f32_32x32x16_bf16 v[112:127], v[176:179], v[36:39], v[112:127]
ds_read_b64_tr_b16 v[36:37], v3 offset:0
ds_read_b64_tr_b16 v[38:39], v3 offset:512
v_mfma_f32_32x32x16_bf16 v[96:111], v[180:183], v[40:43], v[96:111]
ds_read_b64_tr_b16 v[40:41], v2 offset:2048
ds_read_b64_tr_b16 v[42:43], v2 offset:2560
v_mfma_f32_32x32x16_bf16 v[112:127], v[180:183], v[44:47], v[112:127]
ds_read_b64_tr_b16 v[44:45], v3 offset:2048
ds_read_b64_tr_b16 v[46:47], v3 offset:2560
s_waitcnt lgkmcnt(8)
v_mfma_f32_32x32x16_bf16 v[96:111], v[184:187], v[48:51], v[96:111]
ds_read_b64_tr_b16 v[48:49], v2 offset:4096
ds_read_b64_tr_b16 v[50:51], v2 offset:4608
v_mfma_f32_32x32x16_bf16 v[112:127], v[184:187], v[52:55], v[112:127]
ds_read_b64_tr_b16 v[52:53], v3 offset:4096
ds_read_b64_tr_b16 v[54:55], v3 offset:4608
v_mfma_f32_32x32x16_bf16 v[96:111], v[188:191], v[56:59], v[96:111]
ds_read_b64_tr_b16 v[56:57], v2 offset:6144
ds_read_b64_tr_b16 v[58:59], v2 offset:6656
v_mfma_f32_32x32x16_bf16 v[112:127], v[188:191], v[60:63], v[112:127]
ds_read_b64_tr_b16 v[60:61], v3 offset:6144
ds_read_b64_tr_b16 v[62:63], v3 offset:6656
s_waitcnt lgkmcnt(8)
v_mfma_f32_32x32x16_bf16 v[96:111], v[192:195], v[32:35], v[96:111]
ds_read_b64_tr_b16 v[32:33], v2 offset:8192
ds_read_b64_tr_b16 v[34:35], v2 offset:8704
v_mfma_f32_32x32x16_bf16 v[112:127], v[192:195], v[36:39], v[112:127]
ds_read_b64_tr_b16 v[36:37], v3 offset:8192
ds_read_b64_tr_b16 v[38:39], v3 offset:8704
v_mfma_f32_32x32x16_bf16 v[96:111], v[196:199], v[40:43], v[96:111]
ds_read_b64_tr_b16 v[40:41], v2 offset:10240
ds_read_b64_tr_b16 v[42:43], v2 offset:10752
v_mfma_f32_32x32x16_bf16 v[112:127], v[196:199], v[44:47], v[112:127]
ds_read_b64_tr_b16 v[44:45], v3 offset:10240
ds_read_b64_tr_b16 v[46:47], v3 offset:10752
s_waitcnt lgkmcnt(8)
v_mfma_f32_32x32x16_bf16 v[96:111], v[200:203], v[48:51], v[96:111]
ds_read_b64_tr_b16 v[48:49], v2 offset:12288
ds_read_b64_tr_b16 v[50:51], v2 offset:12800
v_mfma_f32_32x32x16_bf16 v[112:127], v[200:203], v[52:55], v[112:127]
ds_read_b64_tr_b16 v[52:53], v3 offset:12288
ds_read_b64_tr_b16 v[54:55], v3 offset:12800
v_mfma_f32_32x32x16_bf16 v[96:111], v[204:207], v[56:59], v[96:111]
ds_read_b64_tr_b16 v[56:57], v2 offset:14336
ds_read_b64_tr_b16 v[58:59], v2 offset:14848
v_mfma_f32_32x32x16_bf16 v[112:127], v[204:207], v[60:63], v[112:127]
ds_read_b64_tr_b16 v[60:61], v3 offset:14336
ds_read_b64_tr_b16 v[62:63], v3 offset:14848
s_waitcnt lgkmcnt(8)
v_mfma_f32_32x32x16_bf16 v[96:111], v[208:211], v[32:35], v[96:111]
s_barrier
ds_read_b64_tr_b16 v[32:33], v2 offset:16384
ds_read_b64_tr_b16 v[34:35], v2 offset:16896
v_mfma_f32_32x32x16_bf16 v[112:127], v[208:211], v[36:39], v[112:127]
ds_read_b64_tr_b16 v[36:37], v3 offset:16384
ds_read_b64_tr_b16 v[38:39], v3 offset:16896
v_mfma_f32_32x32x16_bf16 v[96:111], v[212:215], v[40:43], v[96:111]
ds_read_b64_tr_b16 v[40:41], v2 offset:18432
ds_read_b64_tr_b16 v[42:43], v2 offset:18944
v_mfma_f32_32x32x16_bf16 v[112:127], v[212:215], v[44:47], v[112:127]
ds_read_b64_tr_b16 v[44:45], v3 offset:18432
ds_read_b64_tr_b16 v[46:47], v3 offset:18944
s_waitcnt lgkmcnt(8)
v_mfma_f32_32x32x16_bf16 v[96:111], v[216:219], v[48:51], v[96:111]
ds_read_b64_tr_b16 v[48:49], v2 offset:20480
ds_read_b64_tr_b16 v[50:51], v2 offset:20992
v_mfma_f32_32x32x16_bf16 v[112:127], v[216:219], v[52:55], v[112:127]
ds_read_b64_tr_b16 v[52:53], v3 offset:20480
ds_read_b64_tr_b16 v[54:55], v3 offset:20992
v_mfma_f32_32x32x16_bf16 v[96:111], v[220:223], v[56:59], v[96:111]
ds_read_b64_tr_b16 v[56:57], v2 offset:22528
ds_read_b64_tr_b16 v[58:59], v2 offset:23040
v_mfma_f32_32x32x16_bf16 v[112:127], v[220:223], v[60:63], v[112:127]
ds_read_b64_tr_b16 v[60:61], v3 offset:22528
ds_read_b64_tr_b16 v[62:63], v3 offset:23040
s_waitcnt lgkmcnt(8)
v_mfma_f32_32x32x16_bf16 v[96:111], v[224:227], v[32:35], v[96:111]
ds_read_b64_tr_b16 v[32:33], v2 offset:24576
ds_read_b64_tr_b16 v[34:35], v2 offset:25088
v_mfma_f32_32x32x16_bf16 v[112:127], v[224:227], v[36:39], v[112:127]
ds_read_b64_tr_b16 v[36:37], v3 offset:24576
ds_read_b64_tr_b16 v[38:39], v3 offset:25088
v_mfma_f32_32x32x16_bf16 v[96:111], v[228:231], v[40:43], v[96:111]
ds_read_b64_tr_b16 v[40:41], v2 offset:26624
ds_read_b64_tr_b16 v[42:43], v2 offset:27136
v_mfma_f32_32x32x16_bf16 v[112:127], v[228:231], v[44:47], v[112:127]
ds_read_b64_tr_b16 v[44:45], v3 offset:26624
ds_read_b64_tr_b16 v[46:47], v3 offset:27136
s_waitcnt lgkmcnt(8)
v_mfma_f32_32x32x16_bf16 v[96:111], v[232:235], v[48:51], v[96:111]
ds_read_b64_tr_b16 v[48:49], v2 offset:28672
ds_read_b64_tr_b16 v[50:51], v2 offset:29184
v_mfma_f32_32x32x16_bf16 v[112:127], v[232:235], v[52:55], v[112:127]
ds_read_b64_tr_b16 v[52:53], v3 offset:28672
ds_read_b64_tr_b16 v[54:55], v3 offset:29184
v_mfma_f32_32x32x16_bf16 v[96:111], v[236:239], v[56:59], v[96:111]
ds_read_b64_tr_b16 v[56:57], v2 offset:30720
ds_read_b64_tr_b16 v[58:59], v2 offset:31232
v_mfma_f32_32x32x16_bf16 v[112:127], v[236:239], v[60:63], v[112:127]
ds_read_b64_tr_b16 v[60:61], v3 offset:30720
ds_read_b64_tr_b16 v[62:63], v3 offset:31232
s_waitcnt lgkmcnt(8)
v_mfma_f32_32x32x16_bf16 v[96:111], v[240:243], v[32:35], v[96:111]
s_barrier
v_xor_b32 v2, 0x10000, v6
v_xor_b32 v3, 0x10020, v6
v_xor_b32 v4, 0x10040, v6
v_xor_b32 v5, 0x10060, v6
ds_read_b64_tr_b16 v[32:33], v2 offset:32768
ds_read_b64_tr_b16 v[34:35], v2 offset:33280
v_mfma_f32_32x32x16_bf16 v[112:127], v[240:243], v[36:39], v[112:127]
ds_read_b64_tr_b16 v[36:37], v2 offset:36864
ds_read_b64_tr_b16 v[38:39], v2 offset:37376
v_mfma_f32_32x32x16_bf16 v[96:111], v[244:247], v[40:43], v[96:111]
ds_read_b64_tr_b16 v[40:41], v2 offset:40960
ds_read_b64_tr_b16 v[42:43], v2 offset:41472
v_mfma_f32_32x32x16_bf16 v[112:127], v[244:247], v[44:47], v[112:127]
ds_read_b64_tr_b16 v[44:45], v2 offset:45056
ds_read_b64_tr_b16 v[46:47], v2 offset:45568
s_waitcnt lgkmcnt(8)
v_mfma_f32_32x32x16_bf16 v[96:111], v[248:251], v[48:51], v[96:111]
ds_read_b64_tr_b16 v[48:49], v3 offset:32768
ds_read_b64_tr_b16 v[50:51], v3 offset:33280
v_mfma_f32_32x32x16_bf16 v[112:127], v[248:251], v[52:55], v[112:127]
ds_read_b64_tr_b16 v[52:53], v3 offset:36864
ds_read_b64_tr_b16 v[54:55], v3 offset:37376
v_mfma_f32_32x32x16_bf16 v[96:111], v[252:255], v[56:59], v[96:111]
ds_read_b64_tr_b16 v[56:57], v3 offset:40960
ds_read_b64_tr_b16 v[58:59], v3 offset:41472
v_mfma_f32_32x32x16_bf16 v[112:127], v[252:255], v[60:63], v[112:127]
ds_read_b64_tr_b16 v[60:61], v3 offset:45056
ds_read_b64_tr_b16 v[62:63], v3 offset:45568
s_waitcnt lgkmcnt(8)
v_mfma_f32_32x32x16_bf16 v[64:79], v[32:35], v[128:131], 0
ds_read_b64_tr_b16 v[32:33], v4 offset:32768
ds_read_b64_tr_b16 v[34:35], v4 offset:33280
v_mfma_f32_32x32x16_bf16 v[64:79], v[36:39], v[132:135], v[64:79]
ds_read_b64_tr_b16 v[36:37], v4 offset:36864
ds_read_b64_tr_b16 v[38:39], v4 offset:37376
v_cvt_pk_bf16_f32 v16, v96, v97
v_cvt_pk_bf16_f32 v17, v98, v99
v_mfma_f32_32x32x16_bf16 v[64:79], v[40:43], v[136:139], v[64:79]
ds_write_addtid_b32 v16 offset:0
ds_write_addtid_b32 v17 offset:256
ds_read_b64_tr_b16 v[40:41], v4 offset:40960
ds_read_b64_tr_b16 v[42:43], v4 offset:41472
v_cvt_pk_bf16_f32 v18, v100, v101
v_cvt_pk_bf16_f32 v19, v102, v103
v_mfma_f32_32x32x16_bf16 v[64:79], v[44:47], v[140:143], v[64:79]
ds_write_addtid_b32 v18 offset:512
ds_write_addtid_b32 v19 offset:768
ds_read_b64_tr_b16 v[44:45], v4 offset:45056
ds_read_b64_tr_b16 v[46:47], v4 offset:45568
v_cvt_pk_bf16_f32 v20, v104, v105
v_cvt_pk_bf16_f32 v21, v106, v107
s_waitcnt lgkmcnt(12)
v_mfma_f32_32x32x16_bf16 v[80:95], v[48:51], v[128:131], 0
ds_write_addtid_b32 v20 offset:1024
ds_write_addtid_b32 v21 offset:1280
ds_read_b64_tr_b16 v[48:49], v5 offset:32768
ds_read_b64_tr_b16 v[50:51], v5 offset:33280
v_cvt_pk_bf16_f32 v22, v108, v109
v_cvt_pk_bf16_f32 v23, v110, v111
v_mfma_f32_32x32x16_bf16 v[80:95], v[52:55], v[132:135], v[80:95]
ds_write_addtid_b32 v22 offset:1536
ds_write_addtid_b32 v23 offset:1792
ds_read_b64_tr_b16 v[52:53], v5 offset:36864
ds_read_b64_tr_b16 v[54:55], v5 offset:37376
v_cvt_pk_bf16_f32 v24, v112, v113
v_cvt_pk_bf16_f32 v25, v114, v115
v_mfma_f32_32x32x16_bf16 v[80:95], v[56:59], v[136:139], v[80:95]
ds_write_addtid_b32 v24 offset:2048
ds_write_addtid_b32 v25 offset:2304
ds_read_b64_tr_b16 v[56:57], v5 offset:40960
ds_read_b64_tr_b16 v[58:59], v5 offset:41472
v_cvt_pk_bf16_f32 v26, v116, v117
v_cvt_pk_bf16_f32 v27, v118, v119
v_mfma_f32_32x32x16_bf16 v[80:95], v[60:63], v[140:143], v[80:95]
ds_write_addtid_b32 v26 offset:2560
ds_write_addtid_b32 v27 offset:2816
ds_read_b64_tr_b16 v[60:61], v5 offset:45056
ds_read_b64_tr_b16 v[62:63], v5 offset:45568
v_cvt_pk_bf16_f32 v28, v120, v121
v_cvt_pk_bf16_f32 v29, v122, v123
s_waitcnt lgkmcnt(15)
v_mfma_f32_32x32x16_bf16 v[96:111], v[32:35], v[128:131], 0
ds_write_addtid_b32 v28 offset:3072
ds_write_addtid_b32 v29 offset:3328
s_waitcnt lgkmcnt(0)
s_barrier
ds_read_b64_tr_b16 v[32:33], v2 offset:49152
ds_read_b64_tr_b16 v[34:35], v2 offset:49664
v_cvt_pk_bf16_f32 v30, v124, v125
v_cvt_pk_bf16_f32 v31, v126, v127
v_mfma_f32_32x32x16_bf16 v[96:111], v[36:39], v[132:135], v[96:111]
ds_write_addtid_b32 v30 offset:3584
ds_write_addtid_b32 v31 offset:3840
ds_read_b64_tr_b16 v[36:37], v3 offset:49152
ds_read_b64_tr_b16 v[38:39], v3 offset:49664
v_mfma_f32_32x32x16_bf16 v[96:111], v[40:43], v[136:139], v[96:111]
ds_read_b64_tr_b16 v[40:41], v4 offset:49152
ds_read_b64_tr_b16 v[42:43], v4 offset:49664
v_mfma_f32_32x32x16_bf16 v[96:111], v[44:47], v[140:143], v[96:111]
ds_read_b64_tr_b16 v[44:45], v5 offset:49152
ds_read_b64_tr_b16 v[46:47], v5 offset:49664
v_mfma_f32_32x32x16_bf16 v[112:127], v[48:51], v[128:131], 0
ds_read_b64_tr_b16 v[48:49], v2 offset:53248
ds_read_b64_tr_b16 v[50:51], v2 offset:53760
v_mfma_f32_32x32x16_bf16 v[112:127], v[52:55], v[132:135], v[112:127]
ds_read_b64_tr_b16 v[52:53], v3 offset:53248
ds_read_b64_tr_b16 v[54:55], v3 offset:53760
v_mfma_f32_32x32x16_bf16 v[112:127], v[56:59], v[136:139], v[112:127]
ds_read_b64_tr_b16 v[56:57], v4 offset:53248
ds_read_b64_tr_b16 v[58:59], v4 offset:53760
v_mfma_f32_32x32x16_bf16 v[112:127], v[60:63], v[140:143], v[112:127]
ds_read_b64_tr_b16 v[60:61], v5 offset:53248
ds_read_b64_tr_b16 v[62:63], v5 offset:53760
s_waitcnt lgkmcnt(8)
v_mfma_f32_32x32x16_bf16 v[64:79], v[32:35], v[144:147], v[64:79]
ds_read_b64_tr_b16 v[32:33], v2 offset:57344
ds_read_b64_tr_b16 v[34:35], v2 offset:57856
v_mfma_f32_32x32x16_bf16 v[80:95], v[36:39], v[144:147], v[80:95]
ds_read_b64_tr_b16 v[36:37], v3 offset:57344
ds_read_b64_tr_b16 v[38:39], v3 offset:57856
v_mfma_f32_32x32x16_bf16 v[96:111], v[40:43], v[144:147], v[96:111]
ds_read_b64_tr_b16 v[40:41], v4 offset:57344
ds_read_b64_tr_b16 v[42:43], v4 offset:57856
v_mfma_f32_32x32x16_bf16 v[112:127], v[44:47], v[144:147], v[112:127]
ds_read_b64_tr_b16 v[44:45], v5 offset:57344
ds_read_b64_tr_b16 v[46:47], v5 offset:57856
s_waitcnt lgkmcnt(8)
v_mfma_f32_32x32x16_bf16 v[64:79], v[48:51], v[148:151], v[64:79]
ds_read_b64_tr_b16 v[48:49], v2 offset:61440
ds_read_b64_tr_b16 v[50:51], v2 offset:61952
v_mfma_f32_32x32x16_bf16 v[80:95], v[52:55], v[148:151], v[80:95]
ds_read_b64_tr_b16 v[52:53], v3 offset:61440
ds_read_b64_tr_b16 v[54:55], v3 offset:61952
v_mfma_f32_32x32x16_bf16 v[96:111], v[56:59], v[148:151], v[96:111]
ds_read_b64_tr_b16 v[56:57], v4 offset:61440
ds_read_b64_tr_b16 v[58:59], v4 offset:61952
v_mfma_f32_32x32x16_bf16 v[112:127], v[60:63], v[148:151], v[112:127]
ds_read_b64_tr_b16 v[60:61], v5 offset:61440
ds_read_b64_tr_b16 v[62:63], v5 offset:61952
s_waitcnt lgkmcnt(8)
v_mfma_f32_32x32x16_bf16 v[64:79], v[32:35], v[152:155], v[64:79]
s_barrier
v_xor_b32 v2, 0x20000, v6
v_xor_b32 v3, 0x20020, v6
v_xor_b32 v4, 0x20040, v6
v_xor_b32 v5, 0x20060, v6
ds_read_b64_tr_b16 v[32:33], v2 offset:0
ds_read_b64_tr_b16 v[34:35], v2 offset:512
v_mfma_f32_32x32x16_bf16 v[80:95], v[36:39], v[152:155], v[80:95]
ds_read_b64_tr_b16 v[36:37], v3 offset:0
ds_read_b64_tr_b16 v[38:39], v3 offset:512
v_mfma_f32_32x32x16_bf16 v[96:111], v[40:43], v[152:155], v[96:111]
ds_read_b64_tr_b16 v[40:41], v4 offset:0
ds_read_b64_tr_b16 v[42:43], v4 offset:512
v_mfma_f32_32x32x16_bf16 v[112:127], v[44:47], v[152:155], v[112:127]
ds_read_b64_tr_b16 v[44:45], v5 offset:0
ds_read_b64_tr_b16 v[46:47], v5 offset:512
s_waitcnt lgkmcnt(8)
v_mfma_f32_32x32x16_bf16 v[64:79], v[48:51], v[156:159], v[64:79]
ds_read_b64_tr_b16 v[48:49], v2 offset:4096
ds_read_b64_tr_b16 v[50:51], v2 offset:4608
v_mfma_f32_32x32x16_bf16 v[80:95], v[52:55], v[156:159], v[80:95]
ds_read_b64_tr_b16 v[52:53], v3 offset:4096
ds_read_b64_tr_b16 v[54:55], v3 offset:4608
v_mfma_f32_32x32x16_bf16 v[96:111], v[56:59], v[156:159], v[96:111]
ds_read_b64_tr_b16 v[56:57], v4 offset:4096
ds_read_b64_tr_b16 v[58:59], v4 offset:4608
v_mfma_f32_32x32x16_bf16 v[112:127], v[60:63], v[156:159], v[112:127]
ds_read_b64_tr_b16 v[60:61], v5 offset:4096
ds_read_b64_tr_b16 v[62:63], v5 offset:4608
s_waitcnt lgkmcnt(8)
v_mfma_f32_32x32x16_bf16 v[64:79], v[32:35], v[160:163], v[64:79]
ds_read_b64_tr_b16 v[32:33], v2 offset:8192
ds_read_b64_tr_b16 v[34:35], v2 offset:8704
v_mfma_f32_32x32x16_bf16 v[80:95], v[36:39], v[160:163], v[80:95]
ds_read_b64_tr_b16 v[36:37], v3 offset:8192
ds_read_b64_tr_b16 v[38:39], v3 offset:8704
v_mfma_f32_32x32x16_bf16 v[96:111], v[40:43], v[160:163], v[96:111]
ds_read_b64_tr_b16 v[40:41], v4 offset:8192
ds_read_b64_tr_b16 v[42:43], v4 offset:8704
v_mfma_f32_32x32x16_bf16 v[112:127], v[44:47], v[160:163], v[112:127]
ds_read_b64_tr_b16 v[44:45], v5 offset:8192
ds_read_b64_tr_b16 v[46:47], v5 offset:8704
s_waitcnt lgkmcnt(8)
v_mfma_f32_32x32x16_bf16 v[64:79], v[48:51], v[164:167], v[64:79]
ds_read_b64_tr_b16 v[48:49], v2 offset:12288
ds_read_b64_tr_b16 v[50:51], v2 offset:12800
v_mfma_f32_32x32x16_bf16 v[80:95], v[52:55], v[164:167], v[80:95]
ds_read_b64_tr_b16 v[52:53], v3 offset:12288
ds_read_b64_tr_b16 v[54:55], v3 offset:12800
v_mfma_f32_32x32x16_bf16 v[96:111], v[56:59], v[164:167], v[96:111]
ds_read_b64_tr_b16 v[56:57], v4 offset:12288
ds_read_b64_tr_b16 v[58:59], v4 offset:12800
v_mfma_f32_32x32x16_bf16 v[112:127], v[60:63], v[164:167], v[112:127]
ds_read_b64_tr_b16 v[60:61], v5 offset:12288
ds_read_b64_tr_b16 v[62:63], v5 offset:12800
s_waitcnt lgkmcnt(8)
v_mfma_f32_32x32x16_bf16 v[64:79], v[32:35], v[168:171], v[64:79]
s_barrier
ds_read_b64_tr_b16 v[32:33], v2 offset:16384
ds_read_b64_tr_b16 v[34:35], v2 offset:16896
v_mfma_f32_32x32x16_bf16 v[80:95], v[36:39], v[168:171], v[80:95]
ds_read_b64_tr_b16 v[36:37], v3 offset:16384
ds_read_b64_tr_b16 v[38:39], v3 offset:16896
v_mfma_f32_32x32x16_bf16 v[96:111], v[40:43], v[168:171], v[96:111]
ds_read_b64_tr_b16 v[40:41], v4 offset:16384
ds_read_b64_tr_b16 v[42:43], v4 offset:16896
v_mfma_f32_32x32x16_bf16 v[112:127], v[44:47], v[168:171], v[112:127]
ds_read_b64_tr_b16 v[44:45], v5 offset:16384
ds_read_b64_tr_b16 v[46:47], v5 offset:16896
s_waitcnt lgkmcnt(8)
v_mfma_f32_32x32x16_bf16 v[64:79], v[48:51], v[172:175], v[64:79]
ds_read_b64_tr_b16 v[48:49], v2 offset:20480
ds_read_b64_tr_b16 v[50:51], v2 offset:20992
v_mfma_f32_32x32x16_bf16 v[80:95], v[52:55], v[172:175], v[80:95]
ds_read_b64_tr_b16 v[52:53], v3 offset:20480
ds_read_b64_tr_b16 v[54:55], v3 offset:20992
v_mfma_f32_32x32x16_bf16 v[96:111], v[56:59], v[172:175], v[96:111]
ds_read_b64_tr_b16 v[56:57], v4 offset:20480
ds_read_b64_tr_b16 v[58:59], v4 offset:20992
v_mfma_f32_32x32x16_bf16 v[112:127], v[60:63], v[172:175], v[112:127]
ds_read_b64_tr_b16 v[60:61], v5 offset:20480
ds_read_b64_tr_b16 v[62:63], v5 offset:20992
s_waitcnt lgkmcnt(8)
v_mfma_f32_32x32x16_bf16 v[64:79], v[32:35], v[176:179], v[64:79]
ds_read_b64_tr_b16 v[32:33], v2 offset:24576
ds_read_b64_tr_b16 v[34:35], v2 offset:25088
v_mfma_f32_32x32x16_bf16 v[80:95], v[36:39], v[176:179], v[80:95]
ds_read_b64_tr_b16 v[36:37], v3 offset:24576
ds_read_b64_tr_b16 v[38:39], v3 offset:25088
v_mfma_f32_32x32x16_bf16 v[96:111], v[40:43], v[176:179], v[96:111]
ds_read_b64_tr_b16 v[40:41], v4 offset:24576
ds_read_b64_tr_b16 v[42:43], v4 offset:25088
v_mfma_f32_32x32x16_bf16 v[112:127], v[44:47], v[176:179], v[112:127]
ds_read_b64_tr_b16 v[44:45], v5 offset:24576
ds_read_b64_tr_b16 v[46:47], v5 offset:25088
s_waitcnt lgkmcnt(8)
v_mfma_f32_32x32x16_bf16 v[64:79], v[48:51], v[180:183], v[64:79]
ds_read_b64_tr_b16 v[48:49], v2 offset:28672
ds_read_b64_tr_b16 v[50:51], v2 offset:29184
v_mfma_f32_32x32x16_bf16 v[80:95], v[52:55], v[180:183], v[80:95]
ds_read_b64_tr_b16 v[52:53], v3 offset:28672
ds_read_b64_tr_b16 v[54:55], v3 offset:29184
v_mfma_f32_32x32x16_bf16 v[96:111], v[56:59], v[180:183], v[96:111]
ds_read_b64_tr_b16 v[56:57], v4 offset:28672
ds_read_b64_tr_b16 v[58:59], v4 offset:29184
v_mfma_f32_32x32x16_bf16 v[112:127], v[60:63], v[180:183], v[112:127]
ds_read_b64_tr_b16 v[60:61], v5 offset:28672
ds_read_b64_tr_b16 v[62:63], v5 offset:29184
s_waitcnt lgkmcnt(8)
v_mfma_f32_32x32x16_bf16 v[64:79], v[32:35], v[184:187], v[64:79]
s_barrier
v_xor_b32 v2, 0x10000, v6
v_xor_b32 v3, 0x10020, v6
v_xor_b32 v4, 0x10040, v6
v_xor_b32 v5, 0x10060, v6
ds_read_b64_tr_b16 v[32:33], v2 offset:0
ds_read_b64_tr_b16 v[34:35], v2 offset:512
v_fma_f32 v10, -v10, v10, v11
v_max_f32 v10, 0, v10
v_mfma_f32_32x32x16_bf16 v[80:95], v[36:39], v[184:187], v[80:95]
ds_read_b64_tr_b16 v[36:37], v3 offset:0
ds_read_b64_tr_b16 v[38:39], v3 offset:512
v_cvt_pk_bf16_f32 v10, v10, v10
v_lshlrev_b32 v10, 16, v10
v_mfma_f32_32x32x16_bf16 v[96:111], v[40:43], v[184:187], v[96:111]
ds_read_b64_tr_b16 v[40:41], v4 offset:0
ds_read_b64_tr_b16 v[42:43], v4 offset:512
v_add_f32 v10, 0x3727c5ac, v10
v_cvt_pk_bf16_f32 v10, v10, v10
v_mfma_f32_32x32x16_bf16 v[112:127], v[44:47], v[184:187], v[112:127]
ds_read_b64_tr_b16 v[44:45], v5 offset:0
ds_read_b64_tr_b16 v[46:47], v5 offset:512
v_lshlrev_b32 v10, 16, v10
v_sqrt_f32 v10, v10
s_waitcnt lgkmcnt(8)
v_mfma_f32_32x32x16_bf16 v[64:79], v[48:51], v[188:191], v[64:79]
ds_read_b64_tr_b16 v[48:49], v2 offset:4096
ds_read_b64_tr_b16 v[50:51], v2 offset:4608
v_cvt_pk_bf16_f32 v10, v10, v10
v_lshlrev_b32 v10, 16, v10
v_mfma_f32_32x32x16_bf16 v[80:95], v[52:55], v[188:191], v[80:95]
ds_read_b64_tr_b16 v[52:53], v3 offset:4096
ds_read_b64_tr_b16 v[54:55], v3 offset:4608
v_rcp_f32 v11, v10
v_mul_f32 v15, v10, v10
v_mfma_f32_32x32x16_bf16 v[96:111], v[56:59], v[188:191], v[96:111]
ds_read_b64_tr_b16 v[56:57], v4 offset:4096
ds_read_b64_tr_b16 v[58:59], v4 offset:4608
v_mul_f32 v13, 0xbfb8aa3b, v11
v_mul_f32 v0, 0x3fb8aa3b, v11
v_mfma_f32_32x32x16_bf16 v[112:127], v[60:63], v[188:191], v[112:127]
ds_read_b64_tr_b16 v[60:61], v5 offset:4096
ds_read_b64_tr_b16 v[62:63], v5 offset:4608
v_lshlrev_b32 v9, 4, v1
v_lshrrev_b32 v12, 3, v1
s_waitcnt lgkmcnt(8)
v_mfma_f32_32x32x16_bf16 v[64:79], v[32:35], v[192:195], v[64:79]
ds_read_b64_tr_b16 v[32:33], v2 offset:8192
ds_read_b64_tr_b16 v[34:35], v2 offset:8704
v_lshlrev_b32 v12, 18, v12
v_add_u32 v12, v12, v1
v_mfma_f32_32x32x16_bf16 v[80:95], v[36:39], v[192:195], v[80:95]
ds_read_b64_tr_b16 v[36:37], v3 offset:8192
ds_read_b64_tr_b16 v[38:39], v3 offset:8704
v_lshlrev_b32 v12, 8, v12
s_lshl_b32 s55, s5, 2
v_mfma_f32_32x32x16_bf16 v[96:111], v[40:43], v[192:195], v[96:111]
ds_read_b64_tr_b16 v[40:41], v4 offset:8192
ds_read_b64_tr_b16 v[42:43], v4 offset:8704
s_add_u32 s55, s55, s4
s_mul_i32 s55, s55, 147456
v_mfma_f32_32x32x16_bf16 v[112:127], v[44:47], v[192:195], v[112:127]
ds_read_b64_tr_b16 v[44:45], v5 offset:8192
ds_read_b64_tr_b16 v[46:47], v5 offset:8704
s_lshl_b32 s57, s6, 12
s_add_u32 s57, s57, s55
s_waitcnt lgkmcnt(8)
v_mfma_f32_32x32x16_bf16 v[64:79], v[48:51], v[196:199], v[64:79]
ds_read_b64_tr_b16 v[48:49], v2 offset:12288
ds_read_b64_tr_b16 v[50:51], v2 offset:12800
s_lshl_b32 s56, s5, 1
s_lshr_b32 s44, s4, 1
v_mfma_f32_32x32x16_bf16 v[80:95], v[52:55], v[196:199], v[80:95]
ds_read_b64_tr_b16 v[52:53], v3 offset:12288
ds_read_b64_tr_b16 v[54:55], v3 offset:12800
s_add_u32 s56, s56, s44
s_lshl_b32 s56, s56, 6
v_mfma_f32_32x32x16_bf16 v[96:111], v[56:59], v[196:199], v[96:111]
ds_read_b64_tr_b16 v[56:57], v4 offset:12288
ds_read_b64_tr_b16 v[58:59], v4 offset:12800
s_add_u32 s56, s56, s6
s_lshl_b32 s56, s56, 3
v_mfma_f32_32x32x16_bf16 v[112:127], v[60:63], v[196:199], v[112:127]
ds_read_b64_tr_b16 v[60:61], v5 offset:12288
ds_read_b64_tr_b16 v[62:63], v5 offset:12800
s_and_b32 s44, s4, 1
s_add_u32 s56, s56, s44
s_waitcnt lgkmcnt(8)
v_mfma_f32_32x32x16_bf16 v[64:79], v[32:35], v[200:203], v[64:79]
s_barrier
ds_read_b64_tr_b16 v[32:33], v2 offset:16384
ds_read_b64_tr_b16 v[34:35], v2 offset:16896
s_lshl_b32 s56, s56, 2
s_add_u32 s56, s56, 10092552
v_mfma_f32_32x32x16_bf16 v[80:95], v[36:39], v[200:203], v[80:95]
ds_read_b64_tr_b16 v[36:37], v3 offset:16384
ds_read_b64_tr_b16 v[38:39], v3 offset:16896
s_and_b32 s37, s2, 7
s_lshr_b32 s38, s2, 3
v_mfma_f32_32x32x16_bf16 v[96:111], v[40:43], v[200:203], v[96:111]
ds_read_b64_tr_b16 v[40:41], v4 offset:16384
ds_read_b64_tr_b16 v[42:43], v4 offset:16896
s_lshl_b32 s48, s5, 1
s_bfe_u32 s39, s37, 0x10001
v_mfma_f32_32x32x16_bf16 v[112:127], v[44:47], v[200:203], v[112:127]
ds_read_b64_tr_b16 v[44:45], v5 offset:16384
ds_read_b64_tr_b16 v[46:47], v5 offset:16896
s_add_u32 s48, s48, s39
s_lshr_b32 s39, s38, 2
s_waitcnt lgkmcnt(8)
v_mfma_f32_32x32x16_bf16 v[64:79], v[48:51], v[204:207], v[64:79]
ds_read_b64_tr_b16 v[48:49], v2 offset:20480
ds_read_b64_tr_b16 v[50:51], v2 offset:20992
s_and_b32 s49, s37, 1
s_lshl_b32 s49, s49, 2
v_mfma_f32_32x32x16_bf16 v[80:95], v[52:55], v[204:207], v[80:95]
ds_read_b64_tr_b16 v[52:53], v3 offset:20480
ds_read_b64_tr_b16 v[54:55], v3 offset:20992
s_and_b32 s38, s38, 3
s_add_u32 s49, s49, s38
v_mfma_f32_32x32x16_bf16 v[96:111], v[56:59], v[204:207], v[96:111]
ds_read_b64_tr_b16 v[56:57], v4 offset:20480
ds_read_b64_tr_b16 v[58:59], v4 offset:20992
s_add_u32 s39, s4, s39
s_and_b32 s39, s39, 3
v_mfma_f32_32x32x16_bf16 v[112:127], v[60:63], v[204:207], v[112:127]
ds_read_b64_tr_b16 v[60:61], v5 offset:20480
ds_read_b64_tr_b16 v[62:63], v5 offset:20992
v_and_b32 v16, 7, v1
v_bfe_u32 v17, v1, 4, 1
s_waitcnt lgkmcnt(8)
v_mfma_f32_32x32x16_bf16 v[64:79], v[32:35], v[208:211], v[64:79]
ds_read_b64_tr_b16 v[32:33], v2 offset:24576
ds_read_b64_tr_b16 v[34:35], v2 offset:25088
v_lshlrev_b32 v17, 2, v17
v_xor_b32 v16, v16, v17
v_mfma_f32_32x32x16_bf16 v[80:95], v[36:39], v[208:211], v[80:95]
ds_read_b64_tr_b16 v[36:37], v3 offset:24576
ds_read_b64_tr_b16 v[38:39], v3 offset:25088
v_lshrrev_b32 v17, 3, v1
v_lshlrev_b32 v17, 10, v17
v_mfma_f32_32x32x16_bf16 v[96:111], v[40:43], v[208:211], v[96:111]
ds_read_b64_tr_b16 v[40:41], v4 offset:24576
ds_read_b64_tr_b16 v[42:43], v4 offset:25088
v_lshl_add_u32 v16, v16, 4, v17
s_lshl_b32 s37, s49, 7
v_mfma_f32_32x32x16_bf16 v[112:127], v[44:47], v[208:211], v[112:127]
ds_read_b64_tr_b16 v[44:45], v5 offset:24576
ds_read_b64_tr_b16 v[46:47], v5 offset:25088
v_add_u32 v8, s37, v16
v_lshlrev_b32 v9, 4, v1
s_waitcnt lgkmcnt(8)
v_mfma_f32_32x32x16_bf16 v[64:79], v[48:51], v[212:215], v[64:79]
ds_read_b64_tr_b16 v[48:49], v2 offset:28672
ds_read_b64_tr_b16 v[50:51], v2 offset:29184
s_lshl_b32 s52, s4, 14
s_add_u32 s52, s52, 65536
v_mfma_f32_32x32x16_bf16 v[80:95], v[52:55], v[212:215], v[80:95]
ds_read_b64_tr_b16 v[52:53], v3 offset:28672
ds_read_b64_tr_b16 v[54:55], v3 offset:29184
s_cmp_eq_u32 s4, 0
s_cselect_b32 s52, 147456, s52
v_mfma_f32_32x32x16_bf16 v[96:111], v[56:59], v[212:215], v[96:111]
ds_read_b64_tr_b16 v[56:57], v4 offset:28672
ds_read_b64_tr_b16 v[58:59], v4 offset:29184
v_bfe_u32 v16, v1, 4, 1
v_bfe_u32 v17, v1, 3, 1
v_mfma_f32_32x32x16_bf16 v[112:127], v[60:63], v[212:215], v[112:127]
ds_read_b64_tr_b16 v[60:61], v5 offset:28672
ds_read_b64_tr_b16 v[62:63], v5 offset:29184
v_lshl_add_u32 v16, v17, 1, v16
v_lshlrev_b32 v16, 5, v16
s_waitcnt lgkmcnt(8)
v_mfma_f32_32x32x16_bf16 v[64:79], v[32:35], v[216:219], v[64:79]
s_barrier
ds_read_b64_tr_b16 v[32:33], v2 offset:32768
ds_read_b64_tr_b16 v[34:35], v2 offset:33280
v_and_b32 v17, 3, v1
v_lshl_add_u32 v16, v17, 3, v16
v_mfma_f32_32x32x16_bf16 v[80:95], v[36:39], v[216:219], v[80:95]
ds_read_b64_tr_b16 v[36:37], v3 offset:32768
ds_read_b64_tr_b16 v[38:39], v3 offset:33280
v_bfe_u32 v17, v1, 2, 2
v_lshl_add_u32 v16, v17, 7, v16
v_mfma_f32_32x32x16_bf16 v[96:111], v[40:43], v[216:219], v[96:111]
ds_read_b64_tr_b16 v[40:41], v4 offset:32768
ds_read_b64_tr_b16 v[42:43], v4 offset:33280
v_lshrrev_b32 v17, 5, v1
v_lshl_add_u32 v16, v17, 9, v16
v_mfma_f32_32x32x16_bf16 v[112:127], v[44:47], v[216:219], v[112:127]
ds_read_b64_tr_b16 v[44:45], v5 offset:32768
ds_read_b64_tr_b16 v[46:47], v5 offset:33280
v_add_u32 v10, s52, v16
s_mul_i32 s37, s48, 294912
s_waitcnt lgkmcnt(8)
v_mfma_f32_32x32x16_bf16 v[64:79], v[48:51], v[220:223], v[64:79]
ds_read_b64_tr_b16 v[48:49], v2 offset:36864
ds_read_b64_tr_b16 v[50:51], v2 offset:37376
s_lshl_b32 s0, s39, 14
s_lshl_b32 s54, s0, 4
v_mfma_f32_32x32x16_bf16 v[80:95], v[52:55], v[220:223], v[80:95]
ds_read_b64_tr_b16 v[52:53], v3 offset:36864
ds_read_b64_tr_b16 v[54:55], v3 offset:37376
s_add_u32 s0, s0, s37
s_lshl_b32 s1, s39, 13
v_mfma_f32_32x32x16_bf16 v[96:111], v[56:59], v[220:223], v[96:111]
ds_read_b64_tr_b16 v[56:57], v4 offset:36864
ds_read_b64_tr_b16 v[58:59], v4 offset:37376
s_lshl_b32 s60, s1, 4
s_add_u32 s1, s1, s37
v_mfma_f32_32x32x16_bf16 v[112:127], v[60:63], v[220:223], v[112:127]
ds_read_b64_tr_b16 v[60:61], v5 offset:36864
ds_read_b64_tr_b16 v[62:63], v5 offset:37376
s_lshl_b32 s46, s39, 12
s_lshl_b32 s61, s46, 4
s_waitcnt lgkmcnt(8)
v_mfma_f32_32x32x16_bf16 v[64:79], v[32:35], v[224:227], v[64:79]
ds_read_b64_tr_b16 v[32:33], v2 offset:40960
ds_read_b64_tr_b16 v[34:35], v2 offset:41472
s_add_u32 s46, s46, s37
s_lshl_b32 s50, s48, 3
v_mfma_f32_32x32x16_bf16 v[80:95], v[36:39], v[224:227], v[80:95]
ds_read_b64_tr_b16 v[36:37], v3 offset:40960
ds_read_b64_tr_b16 v[38:39], v3 offset:41472
s_add_u32 s50, s50, s49
s_lshl_b32 s50, s50, 2
v_mfma_f32_32x32x16_bf16 v[96:111], v[40:43], v[224:227], v[96:111]
ds_read_b64_tr_b16 v[40:41], v4 offset:40960
ds_read_b64_tr_b16 v[42:43], v4 offset:41472
s_add_u32 s50, s50, s39
s_lshl_b32 s50, s50, 6
v_mfma_f32_32x32x16_bf16 v[112:127], v[44:47], v[224:227], v[112:127]
ds_read_b64_tr_b16 v[44:45], v5 offset:40960
ds_read_b64_tr_b16 v[46:47], v5 offset:41472
s_add_u32 s50, s50, 10092544
s_add_u32 s50, s20, s50
s_addc_u32 s51, s21, 0
s_waitcnt lgkmcnt(8)
v_mfma_f32_32x32x16_bf16 v[64:79], v[48:51], v[228:231], v[64:79]
ds_read_b64_tr_b16 v[48:49], v2 offset:45056
ds_read_b64_tr_b16 v[50:51], v2 offset:45568
v_mfma_f32_32x32x16_bf16 v[80:95], v[52:55], v[228:231], v[80:95]
ds_read_b64_tr_b16 v[52:53], v3 offset:45056
ds_read_b64_tr_b16 v[54:55], v3 offset:45568
v_mfma_f32_32x32x16_bf16 v[96:111], v[56:59], v[228:231], v[96:111]
ds_read_b64_tr_b16 v[56:57], v4 offset:45056
ds_read_b64_tr_b16 v[58:59], v4 offset:45568
v_mfma_f32_32x32x16_bf16 v[112:127], v[60:63], v[228:231], v[112:127]
ds_read_b64_tr_b16 v[60:61], v5 offset:45056
ds_read_b64_tr_b16 v[62:63], v5 offset:45568
s_waitcnt lgkmcnt(8)
v_mfma_f32_32x32x16_bf16 v[64:79], v[32:35], v[232:235], v[64:79]
s_barrier
ds_read_b64_tr_b16 v[32:33], v2 offset:49152
ds_read_b64_tr_b16 v[34:35], v2 offset:49664
v_mfma_f32_32x32x16_bf16 v[80:95], v[36:39], v[232:235], v[80:95]
ds_read_b64_tr_b16 v[36:37], v2 offset:53248
ds_read_b64_tr_b16 v[38:39], v2 offset:53760
v_mfma_f32_32x32x16_bf16 v[96:111], v[40:43], v[232:235], v[96:111]
ds_read_b64_tr_b16 v[40:41], v2 offset:57344
ds_read_b64_tr_b16 v[42:43], v2 offset:57856
v_mfma_f32_32x32x16_bf16 v[112:127], v[44:47], v[232:235], v[112:127]
ds_read_b64_tr_b16 v[44:45], v2 offset:61440
ds_read_b64_tr_b16 v[46:47], v2 offset:61952
s_waitcnt lgkmcnt(8)
v_mfma_f32_32x32x16_bf16 v[64:79], v[48:51], v[236:239], v[64:79]
ds_read_b64_tr_b16 v[48:49], v3 offset:49152
ds_read_b64_tr_b16 v[50:51], v3 offset:49664
v_mfma_f32_32x32x16_bf16 v[80:95], v[52:55], v[236:239], v[80:95]
ds_read_b64_tr_b16 v[52:53], v3 offset:53248
ds_read_b64_tr_b16 v[54:55], v3 offset:53760
v_mfma_f32_32x32x16_bf16 v[96:111], v[56:59], v[236:239], v[96:111]
ds_read_b64_tr_b16 v[56:57], v3 offset:57344
ds_read_b64_tr_b16 v[58:59], v3 offset:57856
v_mfma_f32_32x32x16_bf16 v[112:127], v[60:63], v[236:239], v[112:127]
ds_read_b64_tr_b16 v[60:61], v3 offset:61440
ds_read_b64_tr_b16 v[62:63], v3 offset:61952
s_waitcnt lgkmcnt(8)
v_mfma_f32_32x32x16_bf16 v[64:79], v[32:35], v[240:243], v[64:79]
ds_read_b64_tr_b16 v[32:33], v4 offset:49152
ds_read_b64_tr_b16 v[34:35], v4 offset:49664
v_mfma_f32_32x32x16_bf16 v[64:79], v[36:39], v[244:247], v[64:79]
ds_read_b64_tr_b16 v[36:37], v4 offset:53248
ds_read_b64_tr_b16 v[38:39], v4 offset:53760
v_mfma_f32_32x32x16_bf16 v[64:79], v[40:43], v[248:251], v[64:79]
ds_read_b64_tr_b16 v[40:41], v4 offset:57344
ds_read_b64_tr_b16 v[42:43], v4 offset:57856
v_mfma_f32_32x32x16_bf16 v[64:79], v[44:47], v[252:255], v[64:79]
ds_read_b64_tr_b16 v[44:45], v4 offset:61440
ds_read_b64_tr_b16 v[46:47], v4 offset:61952
s_waitcnt lgkmcnt(8)
v_mfma_f32_32x32x16_bf16 v[80:95], v[48:51], v[240:243], v[80:95]
ds_read_b64_tr_b16 v[48:49], v5 offset:49152
ds_read_b64_tr_b16 v[50:51], v5 offset:49664
v_mfma_f32_32x32x16_bf16 v[80:95], v[52:55], v[244:247], v[80:95]
ds_read_b64_tr_b16 v[52:53], v5 offset:53248
ds_read_b64_tr_b16 v[54:55], v5 offset:53760
s_lshl_b32 s44, s4, 12
s_add_u32 m0, s44, 16384
v_mfma_f32_32x32x16_bf16 v[80:95], v[56:59], v[248:251], v[80:95]
ds_read_b64_tr_b16 v[56:57], v5 offset:57344
ds_read_b64_tr_b16 v[58:59], v5 offset:57856
v_cvt_pk_bf16_f32 v16, v64, v65
v_cvt_pk_bf16_f32 v17, v66, v67
v_mfma_f32_32x32x16_bf16 v[80:95], v[60:63], v[252:255], v[80:95]
ds_write_addtid_b32 v16 offset:49152
ds_read_b64_tr_b16 v[60:61], v5 offset:61440
ds_read_b64_tr_b16 v[62:63], v5 offset:61952
v_cvt_pk_bf16_f32 v18, v68, v69
v_cvt_pk_bf16_f32 v19, v70, v71
s_waitcnt lgkmcnt(9)
v_mfma_f32_32x32x16_bf16 v[96:111], v[32:35], v[240:243], v[96:111]
ds_write_addtid_b32 v17 offset:49408
s_barrier
v_xor_b32 v2, 0x20000, v7
v_xor_b32 v3, 0x20020, v7
ds_read_b64_tr_b16 v[32:33], v2 offset:0
ds_read_b64_tr_b16 v[34:35], v2 offset:256
v_cvt_pk_bf16_f32 v20, v72, v73
v_cvt_pk_bf16_f32 v21, v74, v75
v_mfma_f32_32x32x16_bf16 v[96:111], v[36:39], v[244:247], v[96:111]
ds_write_addtid_b32 v18 offset:49664
ds_read_b64_tr_b16 v[36:37], v2 offset:2048
ds_read_b64_tr_b16 v[38:39], v2 offset:2304
v_cvt_pk_bf16_f32 v22, v76, v77
v_cvt_pk_bf16_f32 v23, v78, v79
v_mfma_f32_32x32x16_bf16 v[96:111], v[40:43], v[248:251], v[96:111]
ds_write_addtid_b32 v19 offset:49920
ds_read_b64_tr_b16 v[40:41], v2 offset:4096
ds_read_b64_tr_b16 v[42:43], v2 offset:4352
v_cvt_pk_bf16_f32 v24, v80, v81
v_cvt_pk_bf16_f32 v25, v82, v83
v_mfma_f32_32x32x16_bf16 v[96:111], v[44:47], v[252:255], v[96:111]
ds_write_addtid_b32 v20 offset:50176
ds_read_b64_tr_b16 v[44:45], v2 offset:6144
ds_read_b64_tr_b16 v[46:47], v2 offset:6400
v_cvt_pk_bf16_f32 v26, v84, v85
v_cvt_pk_bf16_f32 v27, v86, v87
s_waitcnt lgkmcnt(12)
v_mfma_f32_32x32x16_bf16 v[112:127], v[48:51], v[240:243], v[112:127]
ds_write_addtid_b32 v21 offset:50432
ds_read_b64_tr_b16 v[48:49], v3 offset:0
ds_read_b64_tr_b16 v[50:51], v3 offset:256
v_cvt_pk_bf16_f32 v28, v88, v89
v_cvt_pk_bf16_f32 v29, v90, v91
v_mfma_f32_32x32x16_bf16 v[112:127], v[52:55], v[244:247], v[112:127]
ds_write_addtid_b32 v22 offset:50688
ds_read_b64_tr_b16 v[52:53], v3 offset:2048
ds_read_b64_tr_b16 v[54:55], v3 offset:2304
v_cvt_pk_bf16_f32 v30, v92, v93
v_cvt_pk_bf16_f32 v31, v94, v95
v_mfma_f32_32x32x16_bf16 v[112:127], v[56:59], v[248:251], v[112:127]
ds_write_addtid_b32 v23 offset:50944
ds_read_b64_tr_b16 v[56:57], v3 offset:4096
ds_read_b64_tr_b16 v[58:59], v3 offset:4352
v_mfma_f32_32x32x16_bf16 v[112:127], v[60:63], v[252:255], v[112:127]
ds_write_addtid_b32 v24 offset:51200
ds_read_b64_tr_b16 v[60:61], v3 offset:6144
ds_read_b64_tr_b16 v[62:63], v3 offset:6400
s_waitcnt lgkmcnt(12)
v_mfma_f32_32x32x16_bf16 v[64:79], v[32:35], v[128:131], 0
ds_write_addtid_b32 v25 offset:51456
ds_read_b64_tr_b16 v[32:33], v2 offset:8192
ds_read_b64_tr_b16 v[34:35], v2 offset:8448
v_mfma_f32_32x32x16_bf16 v[64:79], v[36:39], v[132:135], v[64:79]
ds_write_addtid_b32 v26 offset:51712
ds_read_b64_tr_b16 v[36:37], v3 offset:8192
ds_read_b64_tr_b16 v[38:39], v3 offset:8448
v_mfma_f32_32x32x16_bf16 v[64:79], v[40:43], v[136:139], v[64:79]
ds_write_addtid_b32 v27 offset:51968
ds_read_b64_tr_b16 v[40:41], v2 offset:10240
ds_read_b64_tr_b16 v[42:43], v2 offset:10496
v_mfma_f32_32x32x16_bf16 v[64:79], v[44:47], v[140:143], v[64:79]
ds_write_addtid_b32 v28 offset:52224
ds_read_b64_tr_b16 v[44:45], v3 offset:10240
ds_read_b64_tr_b16 v[46:47], v3 offset:10496
s_waitcnt lgkmcnt(12)
v_mfma_f32_32x32x16_bf16 v[80:95], v[48:51], v[128:131], 0
ds_write_addtid_b32 v29 offset:52480
ds_read_b64_tr_b16 v[48:49], v2 offset:12288
ds_read_b64_tr_b16 v[50:51], v2 offset:12544
v_mfma_f32_32x32x16_bf16 v[80:95], v[52:55], v[132:135], v[80:95]
ds_write_addtid_b32 v30 offset:52736
ds_read_b64_tr_b16 v[52:53], v3 offset:12288
ds_read_b64_tr_b16 v[54:55], v3 offset:12544
v_mfma_f32_32x32x16_bf16 v[80:95], v[56:59], v[136:139], v[80:95]
ds_write_addtid_b32 v31 offset:52992
ds_read_b64_tr_b16 v[56:57], v2 offset:14336
ds_read_b64_tr_b16 v[58:59], v2 offset:14592
v_mfma_f32_32x32x16_bf16 v[80:95], v[60:63], v[140:143], v[80:95]
ds_read_b64_tr_b16 v[60:61], v3 offset:14336
ds_read_b64_tr_b16 v[62:63], v3 offset:14592
s_lshl_b32 s47, s4, 14
v_mul_f32 v16, v13, v96
v_mul_f32 v17, v13, v97
v_mul_f32 v18, v13, v98
s_waitcnt lgkmcnt(11)
v_mfma_f32_32x32x16_bf16 v[64:79], v[32:35], v[144:147], v[64:79]
s_waitcnt lgkmcnt(4)
s_barrier
ds_read_b64_tr_b16 v[32:33], v2 offset:16384
ds_read_b64_tr_b16 v[34:35], v2 offset:16640
v_mul_f32 v19, v13, v99
v_exp_f32 v16, v16
v_mfma_f32_32x32x16_bf16 v[80:95], v[36:39], v[144:147], v[80:95]
ds_read_b64_tr_b16 v[36:37], v3 offset:16384
ds_read_b64_tr_b16 v[38:39], v3 offset:16640
s_add_u32 s62, s54, 0
s_add_u32 m0, s47, 0
s_add_u32 s63, s62, 7168
v_mfma_f32_32x32x16_bf16 v[64:79], v[40:43], v[148:151], v[64:79]
ds_read_b64_tr_b16 v[40:41], v2 offset:18432
ds_read_b64_tr_b16 v[42:43], v2 offset:18688
buffer_load_dwordx4 v8, s[64:67], s62 offen lds
v_exp_f32 v17, v17
v_mfma_f32_32x32x16_bf16 v[80:95], v[44:47], v[148:151], v[80:95]
ds_read_b64_tr_b16 v[44:45], v3 offset:18432
ds_read_b64_tr_b16 v[46:47], v3 offset:18688
buffer_load_dwordx4 v8, s[64:67], s63 offen offset:1024 lds
v_exp_f32 v18, v18
s_waitcnt lgkmcnt(8)
v_mfma_f32_32x32x16_bf16 v[64:79], v[48:51], v[152:155], v[64:79]
ds_read_b64_tr_b16 v[48:49], v2 offset:20480
ds_read_b64_tr_b16 v[50:51], v2 offset:20736
s_add_u32 s62, s54, 16384
s_add_u32 m0, s47, 2048
s_add_u32 s63, s62, 7168
v_mfma_f32_32x32x16_bf16 v[80:95], v[52:55], v[152:155], v[80:95]
ds_read_b64_tr_b16 v[52:53], v3 offset:20480
ds_read_b64_tr_b16 v[54:55], v3 offset:20736
buffer_load_dwordx4 v8, s[64:67], s62 offen lds
v_exp_f32 v19, v19
v_mul_f32 v96, v96, v104
v_mfma_f32_32x32x16_bf16 v[64:79], v[56:59], v[156:159], v[64:79]
ds_read_b64_tr_b16 v[56:57], v2 offset:22528
ds_read_b64_tr_b16 v[58:59], v2 offset:22784
buffer_load_dwordx4 v8, s[64:67], s63 offen offset:1024 lds
v_mul_f32 v97, v97, v105
v_mul_f32 v98, v98, v106
v_mul_f32 v99, v99, v107
v_mfma_f32_32x32x16_bf16 v[80:95], v[60:63], v[156:159], v[80:95]
ds_read_b64_tr_b16 v[60:61], v3 offset:22528
ds_read_b64_tr_b16 v[62:63], v3 offset:22784
s_add_u32 s62, s54, 32768
s_add_u32 m0, s47, 4096
s_add_u32 s63, s62, 7168
s_waitcnt lgkmcnt(8)
v_mfma_f32_32x32x16_bf16 v[64:79], v[32:35], v[160:163], v[64:79]
ds_read_b64_tr_b16 v[32:33], v2 offset:24576
ds_read_b64_tr_b16 v[34:35], v2 offset:24832
buffer_load_dwordx4 v8, s[64:67], s62 offen lds
v_fma_f32 v16, v16, v15, v15
v_fma_f32 v17, v17, v15, v15
v_fma_f32 v18, v18, v15, v15
v_mfma_f32_32x32x16_bf16 v[80:95], v[36:39], v[160:163], v[80:95]
ds_read_b64_tr_b16 v[36:37], v3 offset:24576
ds_read_b64_tr_b16 v[38:39], v3 offset:24832
buffer_load_dwordx4 v8, s[64:67], s63 offen offset:1024 lds
v_fma_f32 v19, v19, v15, v15
v_rcp_f32 v16, v16
v_mfma_f32_32x32x16_bf16 v[64:79], v[40:43], v[164:167], v[64:79]
ds_read_b64_tr_b16 v[40:41], v2 offset:26624
ds_read_b64_tr_b16 v[42:43], v2 offset:26880
s_add_u32 s62, s54, 49152
s_add_u32 m0, s47, 6144
s_add_u32 s63, s62, 7168
v_mfma_f32_32x32x16_bf16 v[80:95], v[44:47], v[164:167], v[80:95]
ds_read_b64_tr_b16 v[44:45], v3 offset:26624
ds_read_b64_tr_b16 v[46:47], v3 offset:26880
buffer_load_dwordx4 v8, s[64:67], s62 offen lds
v_rcp_f32 v17, v17
s_waitcnt lgkmcnt(8)
v_mfma_f32_32x32x16_bf16 v[64:79], v[48:51], v[168:171], v[64:79]
ds_read_b64_tr_b16 v[48:49], v2 offset:28672
ds_read_b64_tr_b16 v[50:51], v2 offset:28928
buffer_load_dwordx4 v8, s[64:67], s63 offen offset:1024 lds
v_rcp_f32 v18, v18
v_mfma_f32_32x32x16_bf16 v[80:95], v[52:55], v[168:171], v[80:95]
ds_read_b64_tr_b16 v[52:53], v3 offset:28672
ds_read_b64_tr_b16 v[54:55], v3 offset:28928
s_add_u32 s62, s54, 131072
s_add_u32 m0, s47, 8192
s_add_u32 s63, s62, 7168
v_mfma_f32_32x32x16_bf16 v[64:79], v[56:59], v[172:175], v[64:79]
ds_read_b64_tr_b16 v[56:57], v2 offset:30720
ds_read_b64_tr_b16 v[58:59], v2 offset:30976
buffer_load_dwordx4 v8, s[64:67], s62 offen lds
v_rcp_f32 v19, v19
v_mul_f32 v96, v96, v16
v_mfma_f32_32x32x16_bf16 v[80:95], v[60:63], v[172:175], v[80:95]
ds_read_b64_tr_b16 v[60:61], v3 offset:30720
ds_read_b64_tr_b16 v[62:63], v3 offset:30976
buffer_load_dwordx4 v8, s[64:67], s63 offen offset:1024 lds
v_mul_f32 v97, v97, v17
v_mul_f32 v98, v98, v18
s_waitcnt lgkmcnt(8)
v_mfma_f32_32x32x16_bf16 v[64:79], v[32:35], v[176:179], v[64:79]
s_barrier
v_xor_b32 v2, 0x10000, v7
v_xor_b32 v3, 0x10020, v7
ds_read_b64_tr_b16 v[32:33], v2 offset:16384
ds_read_b64_tr_b16 v[34:35], v2 offset:16640
s_add_u32 s62, s54, 147456
s_add_u32 m0, s47, 10240
s_add_u32 s63, s62, 7168
v_mfma_f32_32x32x16_bf16 v[80:95], v[36:39], v[176:179], v[80:95]
ds_read_b64_tr_b16 v[36:37], v3 offset:16384
ds_read_b64_tr_b16 v[38:39], v3 offset:16640
buffer_load_dwordx4 v8, s[64:67], s62 offen lds
v_mul_f32 v99, v99, v19
v_cvt_pk_bf16_f32 v20, v96, v97
v_cvt_pk_bf16_f32 v21, v98, v99
v_mfma_f32_32x32x16_bf16 v[64:79], v[40:43], v[180:183], v[64:79]
ds_read_b64_tr_b16 v[40:41], v2 offset:18432
ds_read_b64_tr_b16 v[42:43], v2 offset:18688
buffer_load_dwordx4 v8, s[64:67], s63 offen offset:1024 lds
v_mul_f32 v16, v13, v100
v_mul_f32 v17, v13, v101
v_mul_f32 v18, v13, v102
v_mfma_f32_32x32x16_bf16 v[80:95], v[44:47], v[180:183], v[80:95]
ds_read_b64_tr_b16 v[44:45], v3 offset:18432
ds_read_b64_tr_b16 v[46:47], v3 offset:18688
s_add_u32 s62, s54, 163840
s_add_u32 m0, s47, 12288
s_add_u32 s63, s62, 7168
s_waitcnt lgkmcnt(8)
v_mfma_f32_32x32x16_bf16 v[64:79], v[48:51], v[184:187], v[64:79]
ds_read_b64_tr_b16 v[48:49], v2 offset:20480
ds_read_b64_tr_b16 v[50:51], v2 offset:20736
buffer_load_dwordx4 v8, s[64:67], s62 offen lds
v_mul_f32 v19, v13, v103
v_exp_f32 v16, v16
v_mfma_f32_32x32x16_bf16 v[80:95], v[52:55], v[184:187], v[80:95]
ds_read_b64_tr_b16 v[52:53], v3 offset:20480
ds_read_b64_tr_b16 v[54:55], v3 offset:20736
buffer_load_dwordx4 v8, s[64:67], s63 offen offset:1024 lds
v_exp_f32 v17, v17
v_mfma_f32_32x32x16_bf16 v[64:79], v[56:59], v[188:191], v[64:79]
ds_read_b64_tr_b16 v[56:57], v2 offset:22528
ds_read_b64_tr_b16 v[58:59], v2 offset:22784
s_add_u32 s62, s54, 180224
s_add_u32 m0, s47, 14336
s_add_u32 s63, s62, 7168
v_mfma_f32_32x32x16_bf16 v[80:95], v[60:63], v[188:191], v[80:95]
ds_read_b64_tr_b16 v[60:61], v3 offset:22528
ds_read_b64_tr_b16 v[62:63], v3 offset:22784
buffer_load_dwordx4 v8, s[64:67], s62 offen lds
v_exp_f32 v18, v18
s_waitcnt lgkmcnt(8)
v_mfma_f32_32x32x16_bf16 v[64:79], v[32:35], v[192:195], v[64:79]
ds_read_b64_tr_b16 v[32:33], v2 offset:24576
ds_read_b64_tr_b16 v[34:35], v2 offset:24832
buffer_load_dwordx4 v8, s[64:67], s63 offen offset:1024 lds
v_exp_f32 v19, v19
v_mul_f32 v100, v100, v108
v_mfma_f32_32x32x16_bf16 v[80:95], v[36:39], v[192:195], v[80:95]
ds_read_b64_tr_b16 v[36:37], v3 offset:24576
ds_read_b64_tr_b16 v[38:39], v3 offset:24832
v_mul_f32 v101, v101, v109
v_mul_f32 v102, v102, v110
v_mul_f32 v103, v103, v111
v_fma_f32 v16, v16, v15, v15
v_mfma_f32_32x32x16_bf16 v[64:79], v[40:43], v[196:199], v[64:79]
ds_read_b64_tr_b16 v[40:41], v2 offset:26624
ds_read_b64_tr_b16 v[42:43], v2 offset:26880
v_fma_f32 v17, v17, v15, v15
v_fma_f32 v18, v18, v15, v15
v_fma_f32 v19, v19, v15, v15
v_mfma_f32_32x32x16_bf16 v[80:95], v[44:47], v[196:199], v[80:95]
ds_read_b64_tr_b16 v[44:45], v3 offset:26624
ds_read_b64_tr_b16 v[46:47], v3 offset:26880
v_rcp_f32 v16, v16
s_waitcnt lgkmcnt(8)
v_mfma_f32_32x32x16_bf16 v[64:79], v[48:51], v[200:203], v[64:79]
ds_read_b64_tr_b16 v[48:49], v2 offset:28672
ds_read_b64_tr_b16 v[50:51], v2 offset:28928
v_rcp_f32 v17, v17
v_rcp_f32 v18, v18
v_mfma_f32_32x32x16_bf16 v[80:95], v[52:55], v[200:203], v[80:95]
ds_read_b64_tr_b16 v[52:53], v3 offset:28672
ds_read_b64_tr_b16 v[54:55], v3 offset:28928
v_rcp_f32 v19, v19
v_mul_f32 v100, v100, v16
v_mul_f32 v101, v101, v17
v_mfma_f32_32x32x16_bf16 v[64:79], v[56:59], v[204:207], v[64:79]
ds_read_b64_tr_b16 v[56:57], v2 offset:30720
ds_read_b64_tr_b16 v[58:59], v2 offset:30976
v_mul_f32 v102, v102, v18
v_mul_f32 v103, v103, v19
v_cvt_pk_bf16_f32 v22, v100, v101
v_cvt_pk_bf16_f32 v23, v102, v103
v_mfma_f32_32x32x16_bf16 v[80:95], v[60:63], v[204:207], v[80:95]
ds_read_b64_tr_b16 v[60:61], v3 offset:30720
ds_read_b64_tr_b16 v[62:63], v3 offset:30976
s_add_u32 s44, s57, 67584
buffer_store_dwordx4 v[20:23], v9, s[20:23], s44 offen sc1
v_mul_f32 v16, v13, v112
s_waitcnt lgkmcnt(8)
v_mfma_f32_32x32x16_bf16 v[64:79], v[32:35], v[208:211], v[64:79]
s_barrier
ds_read_b64_tr_b16 v[32:33], v2 offset:32768
ds_read_b64_tr_b16 v[34:35], v2 offset:33024
v_mul_f32 v17, v13, v113
v_mul_f32 v18, v13, v114
v_mul_f32 v19, v13, v115
v_mfma_f32_32x32x16_bf16 v[80:95], v[36:39], v[208:211], v[80:95]
ds_read_b64_tr_b16 v[36:37], v3 offset:32768
ds_read_b64_tr_b16 v[38:39], v3 offset:33024
v_exp_f32 v16, v16
v_exp_f32 v17, v17
v_mfma_f32_32x32x16_bf16 v[64:79], v[40:43], v[212:215], v[64:79]
ds_read_b64_tr_b16 v[40:41], v2 offset:34816
ds_read_b64_tr_b16 v[42:43], v2 offset:35072
v_exp_f32 v18, v18
v_exp_f32 v19, v19
v_mfma_f32_32x32x16_bf16 v[80:95], v[44:47], v[212:215], v[80:95]
ds_read_b64_tr_b16 v[44:45], v3 offset:34816
ds_read_b64_tr_b16 v[46:47], v3 offset:35072
v_mul_f32 v112, v112, v120
v_mul_f32 v113, v113, v121
v_mul_f32 v114, v114, v122
s_waitcnt lgkmcnt(8)
v_mfma_f32_32x32x16_bf16 v[64:79], v[48:51], v[216:219], v[64:79]
ds_read_b64_tr_b16 v[48:49], v2 offset:36864
ds_read_b64_tr_b16 v[50:51], v2 offset:37120
v_mul_f32 v115, v115, v123
v_fma_f32 v16, v16, v15, v15
v_fma_f32 v17, v17, v15, v15
v_fma_f32 v18, v18, v15, v15
v_mfma_f32_32x32x16_bf16 v[80:95], v[52:55], v[216:219], v[80:95]
ds_read_b64_tr_b16 v[52:53], v3 offset:36864
ds_read_b64_tr_b16 v[54:55], v3 offset:37120
v_fma_f32 v19, v19, v15, v15
v_rcp_f32 v16, v16
v_mfma_f32_32x32x16_bf16 v[64:79], v[56:59], v[220:223], v[64:79]
ds_read_b64_tr_b16 v[56:57], v2 offset:38912
ds_read_b64_tr_b16 v[58:59], v2 offset:39168
v_rcp_f32 v17, v17
v_rcp_f32 v18, v18
v_mfma_f32_32x32x16_bf16 v[80:95], v[60:63], v[220:223], v[80:95]
ds_read_b64_tr_b16 v[60:61], v3 offset:38912
ds_read_b64_tr_b16 v[62:63], v3 offset:39168
v_rcp_f32 v19, v19
v_mul_f32 v112, v112, v16
s_waitcnt lgkmcnt(8)
v_mfma_f32_32x32x16_bf16 v[64:79], v[32:35], v[224:227], v[64:79]
ds_read_b64_tr_b16 v[32:33], v2 offset:40960
ds_read_b64_tr_b16 v[34:35], v2 offset:41216
v_mul_f32 v113, v113, v17
v_mul_f32 v114, v114, v18
v_mul_f32 v115, v115, v19
v_cvt_pk_bf16_f32 v24, v112, v113
v_mfma_f32_32x32x16_bf16 v[80:95], v[36:39], v[224:227], v[80:95]
ds_read_b64_tr_b16 v[36:37], v3 offset:40960
ds_read_b64_tr_b16 v[38:39], v3 offset:41216
v_cvt_pk_bf16_f32 v25, v114, v115
v_mul_f32 v16, v13, v116
v_mul_f32 v17, v13, v117
v_mul_f32 v18, v13, v118
v_mfma_f32_32x32x16_bf16 v[64:79], v[40:43], v[228:231], v[64:79]
ds_read_b64_tr_b16 v[40:41], v2 offset:43008
ds_read_b64_tr_b16 v[42:43], v2 offset:43264
v_mul_f32 v19, v13, v119
v_exp_f32 v16, v16
v_mfma_f32_32x32x16_bf16 v[80:95], v[44:47], v[228:231], v[80:95]
ds_read_b64_tr_b16 v[44:45], v3 offset:43008
ds_read_b64_tr_b16 v[46:47], v3 offset:43264
v_exp_f32 v17, v17
s_waitcnt lgkmcnt(8)
v_mfma_f32_32x32x16_bf16 v[64:79], v[48:51], v[232:235], v[64:79]
ds_read_b64_tr_b16 v[48:49], v2 offset:45056
ds_read_b64_tr_b16 v[50:51], v2 offset:45312
v_exp_f32 v18, v18
v_exp_f32 v19, v19
v_mfma_f32_32x32x16_bf16 v[80:95], v[52:55], v[232:235], v[80:95]
ds_read_b64_tr_b16 v[52:53], v3 offset:45056
ds_read_b64_tr_b16 v[54:55], v3 offset:45312
v_mul_f32 v116, v116, v124
v_mul_f32 v117, v117, v125
v_mul_f32 v118, v118, v126
v_mul_f32 v119, v119, v127
v_mfma_f32_32x32x16_bf16 v[64:79], v[56:59], v[236:239], v[64:79]
ds_read_b64_tr_b16 v[56:57], v2 offset:47104
ds_read_b64_tr_b16 v[58:59], v2 offset:47360
v_fma_f32 v16, v16, v15, v15
v_fma_f32 v17, v17, v15, v15
v_fma_f32 v18, v18, v15, v15
v_fma_f32 v19, v19, v15, v15
v_mfma_f32_32x32x16_bf16 v[80:95], v[60:63], v[236:239], v[80:95]
ds_read_b64_tr_b16 v[60:61], v3 offset:47104
ds_read_b64_tr_b16 v[62:63], v3 offset:47360
v_rcp_f32 v16, v16
s_waitcnt lgkmcnt(8)
v_mfma_f32_32x32x16_bf16 v[64:79], v[32:35], v[240:243], v[64:79]
v_rcp_f32 v17, v17
v_rcp_f32 v18, v18
v_rcp_f32 v19, v19
v_mfma_f32_32x32x16_bf16 v[80:95], v[36:39], v[240:243], v[80:95]
v_mul_f32 v116, v116, v16
v_mul_f32 v117, v117, v17
v_mul_f32 v118, v118, v18
v_mul_f32 v119, v119, v19
v_cvt_pk_bf16_f32 v26, v116, v117
v_cvt_pk_bf16_f32 v27, v118, v119
v_mfma_f32_32x32x16_bf16 v[64:79], v[40:43], v[244:247], v[64:79]
s_add_u32 s44, s57, 68608
buffer_store_dwordx4 v[24:27], v9, s[20:23], s44 offen sc1
v_mfma_f32_32x32x16_bf16 v[80:95], v[44:47], v[244:247], v[80:95]
s_waitcnt lgkmcnt(0)
v_mfma_f32_32x32x16_bf16 v[64:79], v[48:51], v[248:251], v[64:79]
v_mfma_f32_32x32x16_bf16 v[80:95], v[52:55], v[248:251], v[80:95]
v_mfma_f32_32x32x16_bf16 v[64:79], v[56:59], v[252:255], v[64:79]
v_mfma_f32_32x32x16_bf16 v[80:95], v[60:63], v[252:255], v[80:95]
s_waitcnt vmcnt(2)
s_barrier
s_waitcnt vmcnt(0)
v_mov_b32 v7, 1
buffer_store_dword v7, v12, s[20:23], s56 offen sc1
v_xor_b32 v2, 64, v10
s_lshl_b32 s57, s6, 11
s_add_u32 s57, s57, s55
s_add_u32 s62, s60, 1081344
s_add_u32 m0, s52, 0
s_add_u32 s63, s62, 7168
buffer_load_dwordx4 v8, s[64:67], s62 offen lds
buffer_load_dwordx4 v8, s[64:67], s63 offen offset:1024 lds
v_mul_f32 v16, v13, v64
v_mul_f32 v17, v13, v65
v_mul_f32 v18, v13, v66
v_mul_f32 v19, v13, v67
v_mul_f32 v20, v13, v68
v_mul_f32 v21, v13, v69
v_mul_f32 v22, v13, v70
v_mul_f32 v23, v13, v71
v_exp_f32 v16, v16
v_exp_f32 v17, v17
v_exp_f32 v18, v18
v_exp_f32 v19, v19
v_exp_f32 v20, v20
v_exp_f32 v21, v21
v_exp_f32 v22, v22
v_exp_f32 v23, v23
v_mul_f32 v64, v64, v72
v_mul_f32 v65, v65, v73
v_mul_f32 v66, v66, v74
v_mul_f32 v67, v67, v75
v_mul_f32 v68, v68, v76
v_mul_f32 v69, v69, v77
v_mul_f32 v70, v70, v78
v_mul_f32 v71, v71, v79
v_fma_f32 v16, v16, v15, v15
v_fma_f32 v17, v17, v15, v15
v_fma_f32 v18, v18, v15, v15
s_add_u32 s62, s60, 1097728
s_add_u32 m0, s52, 2048
s_add_u32 s63, s62, 7168
buffer_load_dwordx4 v8, s[64:67], s62 offen lds
buffer_load_dwordx4 v8, s[64:67], s63 offen offset:1024 lds
v_fma_f32 v19, v19, v15, v15
v_fma_f32 v20, v20, v15, v15
v_fma_f32 v21, v21, v15, v15
v_fma_f32 v22, v22, v15, v15
v_fma_f32 v23, v23, v15, v15
v_rcp_f32 v16, v16
v_rcp_f32 v17, v17
v_rcp_f32 v18, v18
v_rcp_f32 v19, v19
v_rcp_f32 v20, v20
v_rcp_f32 v21, v21
v_rcp_f32 v22, v22
v_rcp_f32 v23, v23
v_mul_f32 v64, v64, v16
v_mul_f32 v65, v65, v17
v_mul_f32 v66, v66, v18
v_mul_f32 v67, v67, v19
v_mul_f32 v68, v68, v20
v_mul_f32 v69, v69, v21
v_mul_f32 v70, v70, v22
v_mul_f32 v71, v71, v23
v_cvt_pk_bf16_f32 v24, v64, v65
v_cvt_pk_bf16_f32 v25, v66, v67
v_cvt_pk_bf16_f32 v26, v68, v69
v_cvt_pk_bf16_f32 v27, v70, v71
s_add_u32 s44, s57, 98304
buffer_store_dwordx4 v[24:27], v9, s[20:23], s44 offen sc1
s_add_u32 s62, s60, 1114112
s_add_u32 m0, s52, 4096
s_add_u32 s63, s62, 7168
buffer_load_dwordx4 v8, s[64:67], s62 offen lds
buffer_load_dwordx4 v8, s[64:67], s63 offen offset:1024 lds
v_mul_f32 v16, v13, v80
v_mul_f32 v17, v13, v81
v_mul_f32 v18, v13, v82
v_mul_f32 v19, v13, v83
v_mul_f32 v20, v13, v84
v_mul_f32 v21, v13, v85
v_mul_f32 v22, v13, v86
v_mul_f32 v23, v13, v87
v_exp_f32 v16, v16
v_exp_f32 v17, v17
v_exp_f32 v18, v18
v_exp_f32 v19, v19
v_exp_f32 v20, v20
v_exp_f32 v21, v21
v_exp_f32 v22, v22
v_exp_f32 v23, v23
v_mul_f32 v80, v80, v88
v_mul_f32 v81, v81, v89
v_mul_f32 v82, v82, v90
v_mul_f32 v83, v83, v91
v_mul_f32 v84, v84, v92
v_mul_f32 v85, v85, v93
v_mul_f32 v86, v86, v94
v_mul_f32 v87, v87, v95
v_fma_f32 v16, v16, v15, v15
v_fma_f32 v17, v17, v15, v15
v_fma_f32 v18, v18, v15, v15
v_fma_f32 v19, v19, v15, v15
v_fma_f32 v20, v20, v15, v15
v_fma_f32 v21, v21, v15, v15
v_fma_f32 v22, v22, v15, v15
v_fma_f32 v23, v23, v15, v15
v_rcp_f32 v16, v16
v_rcp_f32 v17, v17
v_rcp_f32 v18, v18
v_rcp_f32 v19, v19
v_rcp_f32 v20, v20
v_rcp_f32 v21, v21
v_rcp_f32 v22, v22
v_rcp_f32 v23, v23
v_mul_f32 v80, v80, v16
v_mul_f32 v81, v81, v17
v_mul_f32 v82, v82, v18
v_mul_f32 v83, v83, v19
v_mul_f32 v84, v84, v20
v_mul_f32 v85, v85, v21
v_mul_f32 v86, v86, v22
v_mul_f32 v87, v87, v23
v_cvt_pk_bf16_f32 v28, v80, v81
v_cvt_pk_bf16_f32 v29, v82, v83
v_cvt_pk_bf16_f32 v30, v84, v85
v_cvt_pk_bf16_f32 v31, v86, v87
s_add_u32 s44, s57, 99328
buffer_store_dwordx4 v[28:31], v9, s[20:23], s44 offen sc1
s_add_u32 s62, s60, 1130496
s_add_u32 m0, s52, 6144
s_add_u32 s63, s62, 7168
buffer_load_dwordx4 v8, s[64:67], s62 offen lds
buffer_load_dwordx4 v8, s[64:67], s63 offen offset:1024 lds
s_add_u32 s62, s60, 1146880
s_add_u32 m0, s52, 8192
s_add_u32 s63, s62, 7168
buffer_load_dwordx4 v8, s[64:67], s62 offen lds
buffer_load_dwordx4 v8, s[64:67], s63 offen offset:1024 lds
s_waitcnt vmcnt(4)
v_mov_b32 v7, 2
buffer_store_dword v7, v12, s[20:23], s56 offen sc1
s_load_dwordx16 s[28:43], s[50:51], 0 glc
s_add_u32 s62, s60, 1163264
s_add_u32 m0, s52, 10240
s_add_u32 s63, s62, 7168
buffer_load_dwordx4 v8, s[64:67], s62 offen lds
buffer_load_dwordx4 v8, s[64:67], s63 offen offset:1024 lds
s_add_u32 s62, s61, 1572864
s_add_u32 m0, s52, 12288
s_add_u32 s63, s62, 7168
buffer_load_dwordx4 v8, s[64:67], s62 offen lds
buffer_load_dwordx4 v8, s[64:67], s63 offen offset:1024 lds
s_add_u32 s62, s61, 1589248
s_add_u32 m0, s52, 14336
s_add_u32 s63, s62, 7168
buffer_load_dwordx4 v8, s[64:67], s62 offen lds
buffer_load_dwordx4 v8, s[64:67], s63 offen offset:1024 lds
s_setprio 0
s_waitcnt lgkmcnt(0)
s_min_u32 s12, s28, s29
s_min_u32 s12, s12, s36
s_min_u32 s12, s12, s37
s_sub_u32 s13, s12, 1
s_min_u32 s12, s30, s31
s_min_u32 s12, s12, s38
s_min_u32 s12, s12, s39
s_sub_u32 s12, s12, 1
s_or_b32 s13, s13, s12
s_cmp_ge_i32 s13, 0
s_cbranch_scc1 L_pf_cD_2_ok
s_mov_b32 s58, 0
L_pf_cD_2:
s_load_dwordx16 s[28:43], s[50:51], 0 glc
s_waitcnt lgkmcnt(0)
s_min_u32 s12, s28, s29
s_min_u32 s12, s12, s36
s_min_u32 s12, s12, s37
s_sub_u32 s13, s12, 1
s_min_u32 s12, s30, s31
s_min_u32 s12, s12, s38
s_min_u32 s12, s12, s39
s_sub_u32 s12, s12, 1
s_or_b32 s13, s13, s12
s_cmp_ge_i32 s13, 0
s_cbranch_scc1 L_pf_cD_2_ok
s_sleep 1
s_add_u32 s58, s58, 1
s_cmp_lt_u32 s58, 0x20000
s_cbranch_scc1 L_pf_cD_2
L_pf_cD_2_ok:
s_add_u32 s62, s1, 67584
s_add_u32 s63, s1, 215040
buffer_load_dwordx4 v[128:131], v9, s[20:23], s62 offen sc1
buffer_load_dwordx4 v[132:135], v9, s[20:23], s63 offen sc1
s_add_u32 s62, s1, 68608
s_add_u32 s63, s1, 216064
buffer_load_dwordx4 v[136:139], v9, s[20:23], s62 offen sc1
buffer_load_dwordx4 v[140:143], v9, s[20:23], s63 offen sc1
s_add_u32 s62, s1, 69632
s_add_u32 s63, s1, 217088
buffer_load_dwordx4 v[144:147], v9, s[20:23], s62 offen sc1
buffer_load_dwordx4 v[148:151], v9, s[20:23], s63 offen sc1
s_add_u32 s62, s1, 70656
s_add_u32 s63, s1, 218112
buffer_load_dwordx4 v[152:155], v9, s[20:23], s62 offen sc1
buffer_load_dwordx4 v[156:159], v9, s[20:23], s63 offen sc1
ds_read_b64_tr_b16 v[16:17], v10 offset:0
ds_read_b64_tr_b16 v[18:19], v10 offset:1024
ds_read_b64_tr_b16 v[20:21], v2 offset:0
ds_read_b64_tr_b16 v[22:23], v2 offset:1024
s_add_u32 s62, s1, 71680
s_add_u32 s63, s1, 219136
buffer_load_dwordx4 v[160:163], v9, s[20:23], s62 offen sc1
buffer_load_dwordx4 v[164:167], v9, s[20:23], s63 offen sc1
ds_read_b64_tr_b16 v[24:25], v10 offset:2048
ds_read_b64_tr_b16 v[26:27], v10 offset:3072
ds_read_b64_tr_b16 v[28:29], v2 offset:2048
ds_read_b64_tr_b16 v[30:31], v2 offset:3072
s_waitcnt lgkmcnt(4)
s_waitcnt vmcnt(8)
v_mfma_f32_32x32x16_bf16 v[192:207], v[16:19], v[128:131], 0
v_mfma_f32_32x32x16_bf16 v[224:239], v[16:19], v[132:135], 0
v_mfma_f32_32x32x16_bf16 v[208:223], v[20:23], v[128:131], 0
v_mfma_f32_32x32x16_bf16 v[240:255], v[20:23], v[132:135], 0
s_add_u32 s62, s1, 72704
s_add_u32 s63, s1, 220160
buffer_load_dwordx4 v[168:171], v9, s[20:23], s62 offen sc1
buffer_load_dwordx4 v[172:175], v9, s[20:23], s63 offen sc1
ds_read_b64_tr_b16 v[16:17], v10 offset:4096
ds_read_b64_tr_b16 v[18:19], v10 offset:5120
ds_read_b64_tr_b16 v[20:21], v2 offset:4096
ds_read_b64_tr_b16 v[22:23], v2 offset:5120
s_waitcnt lgkmcnt(4)
s_load_dwordx16 s[28:43], s[50:51], 0 glc
s_waitcnt vmcnt(8)
v_mfma_f32_32x32x16_bf16 v[192:207], v[24:27], v[136:139], v[192:207]
v_mfma_f32_32x32x16_bf16 v[224:239], v[24:27], v[140:143], v[224:239]
v_mfma_f32_32x32x16_bf16 v[208:223], v[28:31], v[136:139], v[208:223]
v_mfma_f32_32x32x16_bf16 v[240:255], v[28:31], v[140:143], v[240:255]
s_waitcnt lgkmcnt(0)
s_min_u32 s12, s30, s31
s_min_u32 s12, s12, s38
s_min_u32 s12, s12, s39
s_sub_u32 s13, s12, 2
s_cmp_ge_i32 s13, 0
s_cbranch_scc1 L_pf_cD_3_ok
s_mov_b32 s58, 0
L_pf_cD_3:
s_load_dwordx16 s[28:43], s[50:51], 0 glc
s_waitcnt lgkmcnt(0)
s_min_u32 s12, s30, s31
s_min_u32 s12, s12, s38
s_min_u32 s12, s12, s39
s_sub_u32 s13, s12, 2
s_cmp_ge_i32 s13, 0
s_cbranch_scc1 L_pf_cD_3_ok
s_sleep 1
s_add_u32 s58, s58, 1
s_cmp_lt_u32 s58, 0x20000
s_cbranch_scc1 L_pf_cD_3
L_pf_cD_3_ok:
s_add_u32 s62, s46, 98304
s_add_u32 s63, s46, 245760
buffer_load_dwordx4 v[176:179], v9, s[20:23], s62 offen sc1
buffer_load_dwordx4 v[180:183], v9, s[20:23], s63 offen sc1
ds_read_b64_tr_b16 v[24:25], v10 offset:6144
ds_read_b64_tr_b16 v[26:27], v10 offset:7168
ds_read_b64_tr_b16 v[28:29], v2 offset:6144
ds_read_b64_tr_b16 v[30:31], v2 offset:7168
s_add_u32 s62, s61, 1605632
s_add_u32 m0, s52, 0
s_add_u32 s63, s62, 7168
buffer_load_dwordx4 v8, s[64:67], s62 offen lds
buffer_load_dwordx4 v8, s[64:67], s63 offen offset:1024 lds
s_waitcnt vmcnt(10)
v_mfma_f32_32x32x16_bf16 v[192:207], v[16:19], v[144:147], v[192:207]
v_mfma_f32_32x32x16_bf16 v[224:239], v[16:19], v[148:151], v[224:239]
v_mfma_f32_32x32x16_bf16 v[208:223], v[20:23], v[144:147], v[208:223]
v_mfma_f32_32x32x16_bf16 v[240:255], v[20:23], v[148:151], v[240:255]
s_add_u32 s62, s46, 99328
s_add_u32 s63, s46, 246784
buffer_load_dwordx4 v[184:187], v9, s[20:23], s62 offen sc1
buffer_load_dwordx4 v[188:191], v9, s[20:23], s63 offen sc1
ds_read_b64_tr_b16 v[16:17], v10 offset:8192
ds_read_b64_tr_b16 v[18:19], v10 offset:9216
ds_read_b64_tr_b16 v[20:21], v2 offset:8192
ds_read_b64_tr_b16 v[22:23], v2 offset:9216
s_waitcnt lgkmcnt(4)
s_add_u32 s62, s61, 1622016
s_add_u32 m0, s52, 2048
s_add_u32 s63, s62, 7168
buffer_load_dwordx4 v8, s[64:67], s62 offen lds
buffer_load_dwordx4 v8, s[64:67], s63 offen offset:1024 lds
s_waitcnt vmcnt(12)
v_mfma_f32_32x32x16_bf16 v[192:207], v[24:27], v[152:155], v[192:207]
v_mfma_f32_32x32x16_bf16 v[224:239], v[24:27], v[156:159], v[224:239]
v_mfma_f32_32x32x16_bf16 v[208:223], v[28:31], v[152:155], v[208:223]
v_mfma_f32_32x32x16_bf16 v[240:255], v[28:31], v[156:159], v[240:255]
s_add_u32 s62, s46, 100352
s_add_u32 s63, s46, 247808
buffer_load_dwordx4 v[128:131], v9, s[20:23], s62 offen sc1
buffer_load_dwordx4 v[132:135], v9, s[20:23], s63 offen sc1
ds_read_b64_tr_b16 v[24:25], v10 offset:10240
ds_read_b64_tr_b16 v[26:27], v10 offset:11264
ds_read_b64_tr_b16 v[28:29], v2 offset:10240
ds_read_b64_tr_b16 v[30:31], v2 offset:11264
s_waitcnt lgkmcnt(4)
s_add_u32 s62, s60, 0
s_add_u32 m0, s52, 4096
s_add_u32 s63, s62, 7168
buffer_load_dwordx4 v8, s[68:71], s62 offen lds
buffer_load_dwordx4 v8, s[68:71], s63 offen offset:1024 lds
s_waitcnt vmcnt(14)
v_mfma_f32_32x32x16_bf16 v[192:207], v[16:19], v[160:163], v[192:207]
v_mfma_f32_32x32x16_bf16 v[224:239], v[16:19], v[164:167], v[224:239]
v_mfma_f32_32x32x16_bf16 v[208:223], v[20:23], v[160:163], v[208:223]
v_mfma_f32_32x32x16_bf16 v[240:255], v[20:23], v[164:167], v[240:255]
s_add_u32 s62, s46, 101376
s_add_u32 s63, s46, 248832
buffer_load_dwordx4 v[136:139], v9, s[20:23], s62 offen sc1
buffer_load_dwordx4 v[140:143], v9, s[20:23], s63 offen sc1
ds_read_b64_tr_b16 v[16:17], v10 offset:12288
ds_read_b64_tr_b16 v[18:19], v10 offset:13312
ds_read_b64_tr_b16 v[20:21], v2 offset:12288
ds_read_b64_tr_b16 v[22:23], v2 offset:13312
s_waitcnt lgkmcnt(4)
s_load_dwordx16 s[28:43], s[50:51], 0 glc
s_add_u32 s62, s60, 16384
s_add_u32 m0, s52, 6144
s_add_u32 s63, s62, 7168
buffer_load_dwordx4 v8, s[68:71], s62 offen lds
buffer_load_dwordx4 v8, s[68:71], s63 offen offset:1024 lds
s_waitcnt vmcnt(16)
v_mfma_f32_32x32x16_bf16 v[192:207], v[24:27], v[168:171], v[192:207]
v_mfma_f32_32x32x16_bf16 v[224:239], v[24:27], v[172:175], v[224:239]
v_mfma_f32_32x32x16_bf16 v[208:223], v[28:31], v[168:171], v[208:223]
v_mfma_f32_32x32x16_bf16 v[240:255], v[28:31], v[172:175], v[240:255]
s_waitcnt lgkmcnt(0)
s_min_u32 s12, s34, s35
s_min_u32 s12, s12, s42
s_min_u32 s12, s12, s43
s_sub_u32 s13, s12, 2
s_cmp_ge_i32 s13, 0
s_cbranch_scc1 L_pf_cD_4_ok
s_mov_b32 s58, 0
L_pf_cD_4:
s_load_dwordx16 s[28:43], s[50:51], 0 glc
s_waitcnt lgkmcnt(0)
s_min_u32 s12, s34, s35
s_min_u32 s12, s12, s42
s_min_u32 s12, s12, s43
s_sub_u32 s13, s12, 2
s_cmp_ge_i32 s13, 0
s_cbranch_scc1 L_pf_cD_4_ok
s_sleep 1
s_add_u32 s58, s58, 1
s_cmp_lt_u32 s58, 0x20000
s_cbranch_scc1 L_pf_cD_4
L_pf_cD_4_ok:
s_add_u32 s62, s1, 114688
s_add_u32 s63, s1, 262144
buffer_load_dwordx4 v[144:147], v9, s[20:23], s62 offen sc1
buffer_load_dwordx4 v[148:151], v9, s[20:23], s63 offen sc1
ds_read_b64_tr_b16 v[24:25], v10 offset:14336
ds_read_b64_tr_b16 v[26:27], v10 offset:15360
ds_read_b64_tr_b16 v[28:29], v2 offset:14336
ds_read_b64_tr_b16 v[30:31], v2 offset:15360
s_add_u32 s62, s60, 32768
s_add_u32 m0, s52, 8192
s_add_u32 s63, s62, 7168
buffer_load_dwordx4 v8, s[68:71], s62 offen lds
buffer_load_dwordx4 v8, s[68:71], s63 offen offset:1024 lds
s_waitcnt vmcnt(18)
v_mfma_f32_32x32x16_bf16 v[192:207], v[16:19], v[176:179], v[192:207]
v_mfma_f32_32x32x16_bf16 v[224:239], v[16:19], v[180:183], v[224:239]
v_mfma_f32_32x32x16_bf16 v[208:223], v[20:23], v[176:179], v[208:223]
v_mfma_f32_32x32x16_bf16 v[240:255], v[20:23], v[180:183], v[240:255]
s_add_u32 s62, s1, 115712
s_add_u32 s63, s1, 263168
buffer_load_dwordx4 v[152:155], v9, s[20:23], s62 offen sc1
buffer_load_dwordx4 v[156:159], v9, s[20:23], s63 offen sc1
s_waitcnt vmcnt(18)
ds_read_b64_tr_b16 v[16:17], v10 offset:0
ds_read_b64_tr_b16 v[18:19], v10 offset:1024
ds_read_b64_tr_b16 v[20:21], v2 offset:0
ds_read_b64_tr_b16 v[22:23], v2 offset:1024
s_waitcnt lgkmcnt(4)
s_add_u32 s62, s60, 49152
s_add_u32 m0, s52, 10240
s_add_u32 s63, s62, 7168
buffer_load_dwordx4 v8, s[68:71], s62 offen lds
buffer_load_dwordx4 v8, s[68:71], s63 offen offset:1024 lds
s_waitcnt vmcnt(18)
v_mfma_f32_32x32x16_bf16 v[192:207], v[24:27], v[184:187], v[192:207]
v_mfma_f32_32x32x16_bf16 v[224:239], v[24:27], v[188:191], v[224:239]
v_mfma_f32_32x32x16_bf16 v[208:223], v[28:31], v[184:187], v[208:223]
v_mfma_f32_32x32x16_bf16 v[240:255], v[28:31], v[188:191], v[240:255]
s_add_u32 s62, s1, 116736
s_add_u32 s63, s1, 264192
buffer_load_dwordx4 v[160:163], v9, s[20:23], s62 offen sc1
buffer_load_dwordx4 v[164:167], v9, s[20:23], s63 offen sc1
s_waitcnt vmcnt(18)
ds_read_b64_tr_b16 v[24:25], v10 offset:2048
ds_read_b64_tr_b16 v[26:27], v10 offset:3072
ds_read_b64_tr_b16 v[28:29], v2 offset:2048
ds_read_b64_tr_b16 v[30:31], v2 offset:3072
s_waitcnt lgkmcnt(4)
s_add_u32 s62, s60, 65536
s_add_u32 m0, s52, 12288
s_add_u32 s63, s62, 7168
buffer_load_dwordx4 v8, s[68:71], s62 offen lds
buffer_load_dwordx4 v8, s[68:71], s63 offen offset:1024 lds
s_waitcnt vmcnt(18)
v_mfma_f32_32x32x16_bf16 v[192:207], v[16:19], v[128:131], v[192:207]
v_mfma_f32_32x32x16_bf16 v[224:239], v[16:19], v[132:135], v[224:239]
v_mfma_f32_32x32x16_bf16 v[208:223], v[20:23], v[128:131], v[208:223]
v_mfma_f32_32x32x16_bf16 v[240:255], v[20:23], v[132:135], v[240:255]
s_add_u32 s62, s1, 117760
s_add_u32 s63, s1, 265216
buffer_load_dwordx4 v[168:171], v9, s[20:23], s62 offen sc1
buffer_load_dwordx4 v[172:175], v9, s[20:23], s63 offen sc1
s_waitcnt vmcnt(18)
ds_read_b64_tr_b16 v[16:17], v10 offset:4096
ds_read_b64_tr_b16 v[18:19], v10 offset:5120
ds_read_b64_tr_b16 v[20:21], v2 offset:4096
ds_read_b64_tr_b16 v[22:23], v2 offset:5120
s_waitcnt lgkmcnt(4)
s_add_u32 s62, s60, 81920
s_add_u32 m0, s52, 14336
s_add_u32 s63, s62, 7168
buffer_load_dwordx4 v8, s[68:71], s62 offen lds
buffer_load_dwordx4 v8, s[68:71], s63 offen offset:1024 lds
s_waitcnt vmcnt(18)
v_mfma_f32_32x32x16_bf16 v[192:207], v[24:27], v[136:139], v[192:207]
v_mfma_f32_32x32x16_bf16 v[224:239], v[24:27], v[140:143], v[224:239]
v_mfma_f32_32x32x16_bf16 v[208:223], v[28:31], v[136:139], v[208:223]
v_mfma_f32_32x32x16_bf16 v[240:255], v[28:31], v[140:143], v[240:255]
s_add_u32 s62, s1, 118784
s_add_u32 s63, s1, 266240
buffer_load_dwordx4 v[176:179], v9, s[20:23], s62 offen sc1
buffer_load_dwordx4 v[180:183], v9, s[20:23], s63 offen sc1
s_waitcnt vmcnt(18)
ds_read_b64_tr_b16 v[24:25], v10 offset:6144
ds_read_b64_tr_b16 v[26:27], v10 offset:7168
ds_read_b64_tr_b16 v[28:29], v2 offset:6144
ds_read_b64_tr_b16 v[30:31], v2 offset:7168
s_waitcnt lgkmcnt(4)
s_add_u32 s62, s60, 98304
s_add_u32 m0, s52, 0
s_add_u32 s63, s62, 7168
buffer_load_dwordx4 v8, s[68:71], s62 offen lds
buffer_load_dwordx4 v8, s[68:71], s63 offen offset:1024 lds
s_waitcnt vmcnt(18)
v_mfma_f32_32x32x16_bf16 v[192:207], v[16:19], v[144:147], v[192:207]
v_mfma_f32_32x32x16_bf16 v[224:239], v[16:19], v[148:151], v[224:239]
v_mfma_f32_32x32x16_bf16 v[208:223], v[20:23], v[144:147], v[208:223]
v_mfma_f32_32x32x16_bf16 v[240:255], v[20:23], v[148:151], v[240:255]
s_add_u32 s62, s1, 119808
s_add_u32 s63, s1, 267264
buffer_load_dwordx4 v[184:187], v9, s[20:23], s62 offen sc1
buffer_load_dwordx4 v[188:191], v9, s[20:23], s63 offen sc1
s_waitcnt vmcnt(18)
ds_read_b64_tr_b16 v[16:17], v10 offset:8192
ds_read_b64_tr_b16 v[18:19], v10 offset:9216
ds_read_b64_tr_b16 v[20:21], v2 offset:8192
ds_read_b64_tr_b16 v[22:23], v2 offset:9216
s_waitcnt lgkmcnt(4)
s_add_u32 s62, s60, 114688
s_add_u32 m0, s52, 2048
s_add_u32 s63, s62, 7168
buffer_load_dwordx4 v8, s[68:71], s62 offen lds
buffer_load_dwordx4 v8, s[68:71], s63 offen offset:1024 lds
s_waitcnt vmcnt(18)
v_mfma_f32_32x32x16_bf16 v[192:207], v[24:27], v[152:155], v[192:207]
v_mfma_f32_32x32x16_bf16 v[224:239], v[24:27], v[156:159], v[224:239]
v_mfma_f32_32x32x16_bf16 v[208:223], v[28:31], v[152:155], v[208:223]
v_mfma_f32_32x32x16_bf16 v[240:255], v[28:31], v[156:159], v[240:255]
s_add_u32 s62, s1, 120832
s_add_u32 s63, s1, 268288
buffer_load_dwordx4 v[128:131], v9, s[20:23], s62 offen sc1
buffer_load_dwordx4 v[132:135], v9, s[20:23], s63 offen sc1
s_waitcnt vmcnt(18)
ds_read_b64_tr_b16 v[24:25], v10 offset:10240
ds_read_b64_tr_b16 v[26:27], v10 offset:11264
ds_read_b64_tr_b16 v[28:29], v2 offset:10240
ds_read_b64_tr_b16 v[30:31], v2 offset:11264
s_waitcnt lgkmcnt(4)
s_waitcnt vmcnt(16)
v_mfma_f32_32x32x16_bf16 v[192:207], v[16:19], v[160:163], v[192:207]
v_mfma_f32_32x32x16_bf16 v[224:239], v[16:19], v[164:167], v[224:239]
v_mfma_f32_32x32x16_bf16 v[208:223], v[20:23], v[160:163], v[208:223]
v_mfma_f32_32x32x16_bf16 v[240:255], v[20:23], v[164:167], v[240:255]
s_mov_b32 s24, s100
s_mov_b32 s25, s101
s_mov_b32 s26, 0x200000
s_mov_b32 s27, 0x20000
s_lshl_b32 s44, s48, 1
s_lshr_b32 s45, s3, 2
s_add_u32 s44, s44, s45
s_lshl_b32 s44, s44, 15
s_lshl_b32 s45, s49, 7
s_add_u32 s44, s44, s45
s_lshl_b32 s45, s4, 5
s_add_u32 s44, s44, s45
v_and_b32 v6, 31, v1
v_lshlrev_b32 v6, 10, v6
v_lshrrev_b32 v7, 5, v1
v_lshl_add_u32 v6, v7, 4, v6
v_add_u32 v6, s44, v6
buffer_load_dwordx4 v[32:35], v6, s[8:11], 0 offen
s_add_u32 s62, s1, 121856
s_add_u32 s63, s1, 269312
buffer_load_dwordx4 v[136:139], v9, s[20:23], s62 offen sc1
buffer_load_dwordx4 v[140:143], v9, s[20:23], s63 offen sc1
s_waitcnt vmcnt(17)
ds_read_b64_tr_b16 v[16:17], v10 offset:12288
ds_read_b64_tr_b16 v[18:19], v10 offset:13312
ds_read_b64_tr_b16 v[20:21], v2 offset:12288
ds_read_b64_tr_b16 v[22:23], v2 offset:13312
s_waitcnt lgkmcnt(4)
s_waitcnt vmcnt(15)
v_mfma_f32_32x32x16_bf16 v[192:207], v[24:27], v[168:171], v[192:207]
v_mfma_f32_32x32x16_bf16 v[224:239], v[24:27], v[172:175], v[224:239]
v_mfma_f32_32x32x16_bf16 v[208:223], v[28:31], v[168:171], v[208:223]
v_mfma_f32_32x32x16_bf16 v[240:255], v[28:31], v[172:175], v[240:255]
s_waitcnt vmcnt(13)
ds_read_b64_tr_b16 v[24:25], v10 offset:14336
ds_read_b64_tr_b16 v[26:27], v10 offset:15360
ds_read_b64_tr_b16 v[28:29], v2 offset:14336
ds_read_b64_tr_b16 v[30:31], v2 offset:15360
s_waitcnt lgkmcnt(4)
s_waitcnt vmcnt(11)
v_mfma_f32_32x32x16_bf16 v[192:207], v[16:19], v[176:179], v[192:207]
v_mfma_f32_32x32x16_bf16 v[224:239], v[16:19], v[180:183], v[224:239]
v_mfma_f32_32x32x16_bf16 v[208:223], v[20:23], v[176:179], v[208:223]
v_mfma_f32_32x32x16_bf16 v[240:255], v[20:23], v[180:183], v[240:255]
s_waitcnt vmcnt(9)
ds_read_b64_tr_b16 v[16:17], v10 offset:0
ds_read_b64_tr_b16 v[18:19], v10 offset:1024
ds_read_b64_tr_b16 v[20:21], v2 offset:0
ds_read_b64_tr_b16 v[22:23], v2 offset:1024
s_waitcnt lgkmcnt(4)
s_waitcnt vmcnt(7)
v_mfma_f32_32x32x16_bf16 v[192:207], v[24:27], v[184:187], v[192:207]
v_mfma_f32_32x32x16_bf16 v[224:239], v[24:27], v[188:191], v[224:239]
v_mfma_f32_32x32x16_bf16 v[208:223], v[28:31], v[184:187], v[208:223]
v_mfma_f32_32x32x16_bf16 v[240:255], v[28:31], v[188:191], v[240:255]
s_waitcnt vmcnt(5)
ds_read_b64_tr_b16 v[24:25], v10 offset:2048
ds_read_b64_tr_b16 v[26:27], v10 offset:3072
ds_read_b64_tr_b16 v[28:29], v2 offset:2048
ds_read_b64_tr_b16 v[30:31], v2 offset:3072
s_waitcnt lgkmcnt(4)
s_waitcnt vmcnt(3)
v_mfma_f32_32x32x16_bf16 v[192:207], v[16:19], v[128:131], v[192:207]
v_mfma_f32_32x32x16_bf16 v[224:239], v[16:19], v[132:135], v[224:239]
v_mfma_f32_32x32x16_bf16 v[208:223], v[20:23], v[128:131], v[208:223]
v_mfma_f32_32x32x16_bf16 v[240:255], v[20:23], v[132:135], v[240:255]
s_waitcnt lgkmcnt(0)
s_waitcnt vmcnt(0)
v_mfma_f32_32x32x16_bf16 v[192:207], v[24:27], v[136:139], v[192:207]
v_mfma_f32_32x32x16_bf16 v[224:239], v[24:27], v[140:143], v[224:239]
v_mfma_f32_32x32x16_bf16 v[208:223], v[28:31], v[136:139], v[208:223]
v_mfma_f32_32x32x16_bf16 v[240:255], v[28:31], v[140:143], v[240:255]
s_lshl_b32 s40, s3, 11
v_lshl_add_u32 v12, v1, 2, s40
v_add_u32 v13, 0x10000, v12
s_lshl_b32 s41, s4, 14
s_add_u32 m0, s41, 16136
s_nop 0
s_nop 2
ds_write_addtid_b32 v192 offset:49400
ds_write_addtid_b32 v193 offset:49656
ds_write_addtid_b32 v194 offset:49912
ds_write_addtid_b32 v195 offset:50168
ds_write_addtid_b32 v196 offset:50424
ds_write_addtid_b32 v197 offset:50680
ds_write_addtid_b32 v198 offset:50936
ds_write_addtid_b32 v199 offset:51192
ds_write_addtid_b32 v200 offset:51448
ds_write_addtid_b32 v201 offset:51704
ds_write_addtid_b32 v202 offset:51960
ds_write_addtid_b32 v203 offset:52216
ds_write_addtid_b32 v204 offset:52472
ds_write_addtid_b32 v205 offset:52728
ds_write_addtid_b32 v206 offset:52984
ds_write_addtid_b32 v207 offset:53240
ds_write_addtid_b32 v208 offset:53496
ds_write_addtid_b32 v209 offset:53752
ds_write_addtid_b32 v210 offset:54008
ds_write_addtid_b32 v211 offset:54264
ds_write_addtid_b32 v212 offset:54520
ds_write_addtid_b32 v213 offset:54776
ds_write_addtid_b32 v214 offset:55032
ds_write_addtid_b32 v215 offset:55288
ds_write_addtid_b32 v216 offset:55544
ds_write_addtid_b32 v217 offset:55800
ds_write_addtid_b32 v218 offset:56056
ds_write_addtid_b32 v219 offset:56312
ds_write_addtid_b32 v220 offset:56568
ds_write_addtid_b32 v221 offset:56824
ds_write_addtid_b32 v222 offset:57080
ds_write_addtid_b32 v223 offset:57336
ds_write_addtid_b32 v224 offset:57592
ds_write_addtid_b32 v225 offset:57848
ds_write_addtid_b32 v226 offset:58104
ds_write_addtid_b32 v227 offset:58360
ds_write_addtid_b32 v228 offset:58616
ds_write_addtid_b32 v229 offset:58872
ds_write_addtid_b32 v230 offset:59128
ds_write_addtid_b32 v231 offset:59384
ds_write_addtid_b32 v232 offset:59640
ds_write_addtid_b32 v233 offset:59896
ds_write_addtid_b32 v234 offset:60152
ds_write_addtid_b32 v235 offset:60408
ds_write_addtid_b32 v236 offset:60664
ds_write_addtid_b32 v237 offset:60920
ds_write_addtid_b32 v238 offset:61176
ds_write_addtid_b32 v239 offset:61432
ds_write_addtid_b32 v240 offset:61688
ds_write_addtid_b32 v241 offset:61944
ds_write_addtid_b32 v242 offset:62200
ds_write_addtid_b32 v243 offset:62456
ds_write_addtid_b32 v244 offset:62712
ds_write_addtid_b32 v245 offset:62968
ds_write_addtid_b32 v246 offset:63224
ds_write_addtid_b32 v247 offset:63480
ds_write_addtid_b32 v248 offset:63736
ds_write_addtid_b32 v249 offset:63992
ds_write_addtid_b32 v250 offset:64248
ds_write_addtid_b32 v251 offset:64504
ds_write_addtid_b32 v252 offset:64760
ds_write_addtid_b32 v253 offset:65016
ds_write_addtid_b32 v254 offset:65272
ds_write_addtid_b32 v255 offset:65528
v_mov_b32 v9, 0xffff0000
v_permlane32_swap_b32 v32, v34
v_permlane32_swap_b32 v33, v35
v_lshlrev_b32 v36, 16, v32
v_and_b32 v37, v9, v32
v_lshlrev_b32 v38, 16, v33
v_and_b32 v39, v9, v33
v_lshlrev_b32 v40, 16, v34
v_and_b32 v41, v9, v34
v_lshlrev_b32 v42, 16, v35
v_and_b32 v43, v9, v35
s_waitcnt lgkmcnt(0)
s_barrier
ds_read2st64_b32 v[64:65], v12 offset0:0 offset1:1
ds_read2st64_b32 v[66:67], v12 offset0:2 offset1:3
ds_read2st64_b32 v[68:69], v12 offset0:4 offset1:5
ds_read2st64_b32 v[70:71], v12 offset0:6 offset1:7
ds_read2st64_b32 v[72:73], v12 offset0:64 offset1:65
ds_read2st64_b32 v[74:75], v12 offset0:66 offset1:67
ds_read2st64_b32 v[76:77], v12 offset0:68 offset1:69
ds_read2st64_b32 v[78:79], v12 offset0:70 offset1:71
ds_read2st64_b32 v[80:81], v12 offset0:128 offset1:129
ds_read2st64_b32 v[82:83], v12 offset0:130 offset1:131
ds_read2st64_b32 v[84:85], v12 offset0:132 offset1:133
ds_read2st64_b32 v[86:87], v12 offset0:134 offset1:135
ds_read2st64_b32 v[88:89], v12 offset0:192 offset1:193
ds_read2st64_b32 v[90:91], v12 offset0:194 offset1:195
ds_read2st64_b32 v[92:93], v12 offset0:196 offset1:197
ds_read2st64_b32 v[94:95], v12 offset0:198 offset1:199
ds_read2st64_b32 v[96:97], v13 offset0:0 offset1:1
ds_read2st64_b32 v[98:99], v13 offset0:2 offset1:3
ds_read2st64_b32 v[100:101], v13 offset0:4 offset1:5
ds_read2st64_b32 v[102:103], v13 offset0:6 offset1:7
ds_read2st64_b32 v[104:105], v13 offset0:64 offset1:65
ds_read2st64_b32 v[106:107], v13 offset0:66 offset1:67
ds_read2st64_b32 v[108:109], v13 offset0:68 offset1:69
ds_read2st64_b32 v[110:111], v13 offset0:70 offset1:71
ds_read2st64_b32 v[112:113], v13 offset0:128 offset1:129
ds_read2st64_b32 v[114:115], v13 offset0:130 offset1:131
ds_read2st64_b32 v[116:117], v13 offset0:132 offset1:133
ds_read2st64_b32 v[118:119], v13 offset0:134 offset1:135
ds_read2st64_b32 v[120:121], v13 offset0:192 offset1:193
ds_read2st64_b32 v[122:123], v13 offset0:194 offset1:195
ds_read2st64_b32 v[124:125], v13 offset0:196 offset1:197
ds_read2st64_b32 v[126:127], v13 offset0:198 offset1:199
s_waitcnt lgkmcnt(15)
v_add_f32 v36, v36, v64
v_add_f32 v37, v37, v65
v_add_f32 v38, v38, v66
v_add_f32 v39, v39, v67
v_add_f32 v40, v40, v68
v_add_f32 v41, v41, v69
v_add_f32 v42, v42, v70
v_add_f32 v43, v43, v71
v_add_f32 v36, v36, v72
v_add_f32 v37, v37, v73
v_add_f32 v38, v38, v74
v_add_f32 v39, v39, v75
v_add_f32 v40, v40, v76
v_add_f32 v41, v41, v77
v_add_f32 v42, v42, v78
v_add_f32 v43, v43, v79
v_add_f32 v36, v36, v80
v_add_f32 v37, v37, v81
v_add_f32 v38, v38, v82
v_add_f32 v39, v39, v83
v_add_f32 v40, v40, v84
v_add_f32 v41, v41, v85
v_add_f32 v42, v42, v86
v_add_f32 v43, v43, v87
v_add_f32 v36, v36, v88
v_add_f32 v37, v37, v89
v_add_f32 v38, v38, v90
v_add_f32 v39, v39, v91
v_add_f32 v40, v40, v92
v_add_f32 v41, v41, v93
v_add_f32 v42, v42, v94
v_add_f32 v43, v43, v95
s_waitcnt lgkmcnt(12)
v_add_f32 v36, v36, v96
v_add_f32 v37, v37, v97
v_add_f32 v38, v38, v98
v_add_f32 v39, v39, v99
v_add_f32 v40, v40, v100
v_add_f32 v41, v41, v101
v_add_f32 v42, v42, v102
v_add_f32 v43, v43, v103
s_waitcnt lgkmcnt(8)
v_add_f32 v36, v36, v104
v_add_f32 v37, v37, v105
v_add_f32 v38, v38, v106
v_add_f32 v39, v39, v107
v_add_f32 v40, v40, v108
v_add_f32 v41, v41, v109
v_add_f32 v42, v42, v110
v_add_f32 v43, v43, v111
s_waitcnt lgkmcnt(4)
v_add_f32 v36, v36, v112
v_add_f32 v37, v37, v113
v_add_f32 v38, v38, v114
v_add_f32 v39, v39, v115
v_add_f32 v40, v40, v116
v_add_f32 v41, v41, v117
v_add_f32 v42, v42, v118
v_add_f32 v43, v43, v119
s_waitcnt lgkmcnt(0)
v_add_f32 v36, v36, v120
v_add_f32 v37, v37, v121
v_add_f32 v38, v38, v122
v_add_f32 v39, v39, v123
v_add_f32 v40, v40, v124
v_add_f32 v41, v41, v125
v_add_f32 v42, v42, v126
v_add_f32 v43, v43, v127
v_cvt_pk_bf16_f32 v32, v36, v37
v_cvt_pk_bf16_f32 v33, v38, v39
v_cvt_pk_bf16_f32 v34, v40, v41
v_cvt_pk_bf16_f32 v35, v42, v43
s_nop 0
v_permlane32_swap_b32 v32, v34
v_permlane32_swap_b32 v33, v35
buffer_store_dwordx4 v[32:35], v6, s[24:27], 0 offen
s_endpgm
.p2align 6
L_cQ:
s_setprio 1
v_lshrrev_b32 v18, 3, v1
v_lshlrev_b32 v18, 10, v18
v_lshrrev_b32 v19, 4, v1
v_and_b32 v20, 7, v1
v_xor_b32 v21, v20, v19
v_lshl_add_u32 v16, v21, 4, v18
v_xor_b32 v17, 64, v16
s_lshl_b32 s40, s5, 17
s_lshl_b32 s41, s4, 15
s_add_u32 s40, s40, s41
s_lshr_b32 s42, s4, 1
s_lshl_b32 s42, s42, 15
s_add_u32 s41, s41, s42
s_add_u32 s42, s7, 0
s_and_b32 s42, s42, 7
s_lshl_b32 s42, s42, 7
s_add_u32 s42, s42, s40
s_add_u32 m0, s41, 0
s_add_u32 s43, s42, 0
buffer_load_dwordx4 v16, s[8:11], s43 offen lds
s_add_u32 m0, s41, 1024
s_add_u32 s43, s42, 8192
buffer_load_dwordx4 v17, s[8:11], s43 offen lds
s_add_u32 m0, s41, 2048
s_add_u32 s43, s42, 16384
buffer_load_dwordx4 v16, s[8:11], s43 offen lds
s_add_u32 m0, s41, 3072
s_add_u32 s43, s42, 24576
buffer_load_dwordx4 v17, s[8:11], s43 offen lds
s_add_u32 s42, s7, 1
s_and_b32 s42, s42, 7
s_lshl_b32 s42, s42, 7
s_add_u32 s42, s42, s40
s_add_u32 m0, s41, 4096
s_add_u32 s43, s42, 0
buffer_load_dwordx4 v16, s[8:11], s43 offen lds
s_add_u32 m0, s41, 5120
s_add_u32 s43, s42, 8192
buffer_load_dwordx4 v17, s[8:11], s43 offen lds
s_add_u32 m0, s41, 6144
s_add_u32 s43, s42, 16384
buffer_load_dwordx4 v16, s[8:11], s43 offen lds
s_add_u32 m0, s41, 7168
s_add_u32 s43, s42, 24576
buffer_load_dwordx4 v17, s[8:11], s43 offen lds
s_add_u32 s42, s7, 2
s_and_b32 s42, s42, 7
s_lshl_b32 s42, s42, 7
s_add_u32 s42, s42, s40
s_add_u32 m0, s41, 8192
s_add_u32 s43, s42, 0
buffer_load_dwordx4 v16, s[8:11], s43 offen lds
s_add_u32 m0, s41, 9216
s_add_u32 s43, s42, 8192
buffer_load_dwordx4 v17, s[8:11], s43 offen lds
s_add_u32 m0, s41, 10240
s_add_u32 s43, s42, 16384
buffer_load_dwordx4 v16, s[8:11], s43 offen lds
s_add_u32 m0, s41, 11264
s_add_u32 s43, s42, 24576
buffer_load_dwordx4 v17, s[8:11], s43 offen lds
v_and_b32 v18, 31, v1
v_lshrrev_b32 v19, 5, v1
v_bfe_u32 v20, v1, 1, 3
v_xor_b32 v20, v20, v19
v_lshlrev_b32 v20, 4, v20
v_lshl_add_u32 v20, v18, 7, v20
v_add_u32 v2, s41, v20
v_xor_b32 v3, 32, v2
v_xor_b32 v4, 64, v2
v_xor_b32 v5, 0x60, v2
s_lshl_b32 s44, s4, 8
s_add_u32 s44, s44, 61440
v_lshl_add_u32 v13, v18, 3, s44
v_bfe_u32 v22, v1, 4, 1
v_bfe_u32 v23, v1, 2, 2
v_and_b32 v24, 3, v1
v_bfe_u32 v25, v1, 3, 1
v_lshlrev_b32 v26, 11, v22
v_lshl_add_u32 v26, v19, 10, v26
v_lshl_add_u32 v26, v23, 7, v26
v_lshl_add_u32 v27, v22, 1, v25
v_lshl_add_u32 v26, v27, 5, v26
v_lshl_add_u32 v14, v24, 3, v26
v_lshlrev_b32 v26, 10, v19
v_lshl_add_u32 v26, v23, 7, v26
v_lshl_add_u32 v27, v25, 1, v22
v_lshl_add_u32 v26, v27, 5, v26
v_lshl_add_u32 v6, v24, 3, v26
s_mov_b32 s45, 0x3f803f80
v_mov_b32 v28, 0
v_mov_b32 v29, 0
v_mov_b32 v30, 0
v_mov_b32 v31, 0
s_waitcnt vmcnt(8)
ds_read_b128 v[128:131], v2 offset:0
ds_read_b128 v[132:135], v3 offset:0
ds_read_b128 v[136:139], v4 offset:0
ds_read_b128 v[140:143], v5 offset:0
s_add_u32 s42, s7, 3
s_and_b32 s42, s42, 7
s_lshl_b32 s42, s42, 7
s_add_u32 s42, s42, s40
s_add_u32 m0, s41, 12288
s_add_u32 s43, s42, 0
buffer_load_dwordx4 v16, s[8:11], s43 offen lds
s_add_u32 m0, s41, 13312
s_add_u32 s43, s42, 8192
buffer_load_dwordx4 v17, s[8:11], s43 offen lds
s_add_u32 m0, s41, 14336
s_add_u32 s43, s42, 16384
buffer_load_dwordx4 v16, s[8:11], s43 offen lds
s_add_u32 m0, s41, 15360
s_add_u32 s43, s42, 24576
buffer_load_dwordx4 v17, s[8:11], s43 offen lds
s_waitcnt vmcnt(8)
ds_read_b128 v[144:147], v2 offset:4096
ds_read_b128 v[148:151], v3 offset:4096
ds_read_b128 v[152:155], v4 offset:4096
ds_read_b128 v[156:159], v5 offset:4096
s_add_u32 s42, s7, 4
s_and_b32 s42, s42, 7
s_lshl_b32 s42, s42, 7
s_add_u32 s42, s42, s40
s_add_u32 m0, s41, 16384
s_add_u32 s43, s42, 0
buffer_load_dwordx4 v16, s[8:11], s43 offen lds
s_add_u32 m0, s41, 17408
s_add_u32 s43, s42, 8192
buffer_load_dwordx4 v17, s[8:11], s43 offen lds
s_add_u32 m0, s41, 18432
s_add_u32 s43, s42, 16384
buffer_load_dwordx4 v16, s[8:11], s43 offen lds
s_add_u32 m0, s41, 19456
s_add_u32 s43, s42, 24576
buffer_load_dwordx4 v17, s[8:11], s43 offen lds
s_waitcnt lgkmcnt(4)
v_dot2_f32_bf16 v28, v128, s45, v28
v_dot2_f32_bf16 v30, v128, v128, v30
v_dot2_f32_bf16 v29, v129, s45, v29
v_dot2_f32_bf16 v31, v129, v129, v31
v_dot2_f32_bf16 v28, v130, s45, v28
v_dot2_f32_bf16 v30, v130, v130, v30
v_dot2_f32_bf16 v29, v131, s45, v29
v_dot2_f32_bf16 v31, v131, v131, v31
v_dot2_f32_bf16 v28, v132, s45, v28
v_dot2_f32_bf16 v30, v132, v132, v30
v_dot2_f32_bf16 v29, v133, s45, v29
v_dot2_f32_bf16 v31, v133, v133, v31
v_dot2_f32_bf16 v28, v134, s45, v28
v_dot2_f32_bf16 v30, v134, v134, v30
v_dot2_f32_bf16 v29, v135, s45, v29
v_dot2_f32_bf16 v31, v135, v135, v31
v_dot2_f32_bf16 v28, v136, s45, v28
v_dot2_f32_bf16 v30, v136, v136, v30
v_dot2_f32_bf16 v29, v137, s45, v29
v_dot2_f32_bf16 v31, v137, v137, v31
v_dot2_f32_bf16 v28, v138, s45, v28
v_dot2_f32_bf16 v30, v138, v138, v30
v_dot2_f32_bf16 v29, v139, s45, v29
v_dot2_f32_bf16 v31, v139, v139, v31
v_dot2_f32_bf16 v28, v140, s45, v28
v_dot2_f32_bf16 v30, v140, v140, v30
v_dot2_f32_bf16 v29, v141, s45, v29
v_dot2_f32_bf16 v31, v141, v141, v31
v_dot2_f32_bf16 v28, v142, s45, v28
v_dot2_f32_bf16 v30, v142, v142, v30
v_dot2_f32_bf16 v29, v143, s45, v29
v_dot2_f32_bf16 v31, v143, v143, v31
s_waitcnt vmcnt(8)
ds_read_b128 v[160:163], v2 offset:8192
ds_read_b128 v[164:167], v3 offset:8192
ds_read_b128 v[168:171], v4 offset:8192
ds_read_b128 v[172:175], v5 offset:8192
s_add_u32 s42, s7, 5
s_and_b32 s42, s42, 7
s_lshl_b32 s42, s42, 7
s_add_u32 s42, s42, s40
s_add_u32 m0, s41, 20480
s_add_u32 s43, s42, 0
buffer_load_dwordx4 v16, s[8:11], s43 offen lds
s_add_u32 m0, s41, 21504
s_add_u32 s43, s42, 8192
buffer_load_dwordx4 v17, s[8:11], s43 offen lds
s_add_u32 m0, s41, 22528
s_add_u32 s43, s42, 16384
buffer_load_dwordx4 v16, s[8:11], s43 offen lds
s_add_u32 m0, s41, 23552
s_add_u32 s43, s42, 24576
buffer_load_dwordx4 v17, s[8:11], s43 offen lds
s_waitcnt lgkmcnt(4)
v_dot2_f32_bf16 v28, v144, s45, v28
v_dot2_f32_bf16 v30, v144, v144, v30
v_dot2_f32_bf16 v29, v145, s45, v29
v_dot2_f32_bf16 v31, v145, v145, v31
v_dot2_f32_bf16 v28, v146, s45, v28
v_dot2_f32_bf16 v30, v146, v146, v30
v_dot2_f32_bf16 v29, v147, s45, v29
v_dot2_f32_bf16 v31, v147, v147, v31
v_dot2_f32_bf16 v28, v148, s45, v28
v_dot2_f32_bf16 v30, v148, v148, v30
v_dot2_f32_bf16 v29, v149, s45, v29
v_dot2_f32_bf16 v31, v149, v149, v31
v_dot2_f32_bf16 v28, v150, s45, v28
v_dot2_f32_bf16 v30, v150, v150, v30
v_dot2_f32_bf16 v29, v151, s45, v29
v_dot2_f32_bf16 v31, v151, v151, v31
v_dot2_f32_bf16 v28, v152, s45, v28
v_dot2_f32_bf16 v30, v152, v152, v30
v_dot2_f32_bf16 v29, v153, s45, v29
v_dot2_f32_bf16 v31, v153, v153, v31
v_dot2_f32_bf16 v28, v154, s45, v28
v_dot2_f32_bf16 v30, v154, v154, v30
v_dot2_f32_bf16 v29, v155, s45, v29
v_dot2_f32_bf16 v31, v155, v155, v31
v_dot2_f32_bf16 v28, v156, s45, v28
v_dot2_f32_bf16 v30, v156, v156, v30
v_dot2_f32_bf16 v29, v157, s45, v29
v_dot2_f32_bf16 v31, v157, v157, v31
v_dot2_f32_bf16 v28, v158, s45, v28
v_dot2_f32_bf16 v30, v158, v158, v30
v_dot2_f32_bf16 v29, v159, s45, v29
v_dot2_f32_bf16 v31, v159, v159, v31
s_waitcnt vmcnt(8)
ds_read_b128 v[176:179], v2 offset:12288
ds_read_b128 v[180:183], v3 offset:12288
ds_read_b128 v[184:187], v4 offset:12288
ds_read_b128 v[188:191], v5 offset:12288
s_add_u32 s42, s7, 6
s_and_b32 s42, s42, 7
s_lshl_b32 s42, s42, 7
s_add_u32 s42, s42, s40
s_add_u32 m0, s41, 24576
s_add_u32 s43, s42, 0
buffer_load_dwordx4 v16, s[8:11], s43 offen lds
s_add_u32 m0, s41, 25600
s_add_u32 s43, s42, 8192
buffer_load_dwordx4 v17, s[8:11], s43 offen lds
s_add_u32 m0, s41, 26624
s_add_u32 s43, s42, 16384
buffer_load_dwordx4 v16, s[8:11], s43 offen lds
s_add_u32 m0, s41, 27648
s_add_u32 s43, s42, 24576
buffer_load_dwordx4 v17, s[8:11], s43 offen lds
s_waitcnt lgkmcnt(4)
v_dot2_f32_bf16 v28, v160, s45, v28
v_dot2_f32_bf16 v30, v160, v160, v30
v_dot2_f32_bf16 v29, v161, s45, v29
v_dot2_f32_bf16 v31, v161, v161, v31
v_dot2_f32_bf16 v28, v162, s45, v28
v_dot2_f32_bf16 v30, v162, v162, v30
v_dot2_f32_bf16 v29, v163, s45, v29
v_dot2_f32_bf16 v31, v163, v163, v31
v_dot2_f32_bf16 v28, v164, s45, v28
v_dot2_f32_bf16 v30, v164, v164, v30
v_dot2_f32_bf16 v29, v165, s45, v29
v_dot2_f32_bf16 v31, v165, v165, v31
v_dot2_f32_bf16 v28, v166, s45, v28
v_dot2_f32_bf16 v30, v166, v166, v30
v_dot2_f32_bf16 v29, v167, s45, v29
v_dot2_f32_bf16 v31, v167, v167, v31
v_dot2_f32_bf16 v28, v168, s45, v28
v_dot2_f32_bf16 v30, v168, v168, v30
v_dot2_f32_bf16 v29, v169, s45, v29
v_dot2_f32_bf16 v31, v169, v169, v31
v_dot2_f32_bf16 v28, v170, s45, v28
v_dot2_f32_bf16 v30, v170, v170, v30
v_dot2_f32_bf16 v29, v171, s45, v29
v_dot2_f32_bf16 v31, v171, v171, v31
v_dot2_f32_bf16 v28, v172, s45, v28
v_dot2_f32_bf16 v30, v172, v172, v30
v_dot2_f32_bf16 v29, v173, s45, v29
v_dot2_f32_bf16 v31, v173, v173, v31
v_dot2_f32_bf16 v28, v174, s45, v28
v_dot2_f32_bf16 v30, v174, v174, v30
v_dot2_f32_bf16 v29, v175, s45, v29
v_dot2_f32_bf16 v31, v175, v175, v31
s_waitcnt vmcnt(8)
ds_read_b128 v[192:195], v2 offset:16384
ds_read_b128 v[196:199], v3 offset:16384
ds_read_b128 v[200:203], v4 offset:16384
ds_read_b128 v[204:207], v5 offset:16384
s_add_u32 s42, s7, 7
s_and_b32 s42, s42, 7
s_lshl_b32 s42, s42, 7
s_add_u32 s42, s42, s40
s_add_u32 m0, s41, 28672
s_add_u32 s43, s42, 0
buffer_load_dwordx4 v16, s[8:11], s43 offen lds
s_add_u32 m0, s41, 29696
s_add_u32 s43, s42, 8192
buffer_load_dwordx4 v17, s[8:11], s43 offen lds
s_add_u32 m0, s41, 30720
s_add_u32 s43, s42, 16384
buffer_load_dwordx4 v16, s[8:11], s43 offen lds
s_add_u32 m0, s41, 31744
s_add_u32 s43, s42, 24576
buffer_load_dwordx4 v17, s[8:11], s43 offen lds
s_barrier
s_waitcnt lgkmcnt(4)
v_dot2_f32_bf16 v28, v176, s45, v28
v_dot2_f32_bf16 v30, v176, v176, v30
v_dot2_f32_bf16 v29, v177, s45, v29
v_dot2_f32_bf16 v31, v177, v177, v31
v_dot2_f32_bf16 v28, v178, s45, v28
v_dot2_f32_bf16 v30, v178, v178, v30
v_dot2_f32_bf16 v29, v179, s45, v29
v_dot2_f32_bf16 v31, v179, v179, v31
v_dot2_f32_bf16 v28, v180, s45, v28
v_dot2_f32_bf16 v30, v180, v180, v30
v_dot2_f32_bf16 v29, v181, s45, v29
v_dot2_f32_bf16 v31, v181, v181, v31
v_dot2_f32_bf16 v28, v182, s45, v28
v_dot2_f32_bf16 v30, v182, v182, v30
v_dot2_f32_bf16 v29, v183, s45, v29
v_dot2_f32_bf16 v31, v183, v183, v31
v_dot2_f32_bf16 v28, v184, s45, v28
v_dot2_f32_bf16 v30, v184, v184, v30
v_dot2_f32_bf16 v29, v185, s45, v29
v_dot2_f32_bf16 v31, v185, v185, v31
v_dot2_f32_bf16 v28, v186, s45, v28
v_dot2_f32_bf16 v30, v186, v186, v30
v_dot2_f32_bf16 v29, v187, s45, v29
v_dot2_f32_bf16 v31, v187, v187, v31
v_dot2_f32_bf16 v28, v188, s45, v28
v_dot2_f32_bf16 v30, v188, v188, v30
v_dot2_f32_bf16 v29, v189, s45, v29
v_dot2_f32_bf16 v31, v189, v189, v31
v_dot2_f32_bf16 v28, v190, s45, v28
v_dot2_f32_bf16 v30, v190, v190, v30
v_dot2_f32_bf16 v29, v191, s45, v29
v_dot2_f32_bf16 v31, v191, v191, v31
s_waitcnt vmcnt(8)
ds_read_b128 v[208:211], v2 offset:20480
ds_read_b128 v[212:215], v3 offset:20480
ds_read_b128 v[216:219], v4 offset:20480
ds_read_b128 v[220:223], v5 offset:20480
s_waitcnt lgkmcnt(4)
v_dot2_f32_bf16 v28, v192, s45, v28
v_dot2_f32_bf16 v30, v192, v192, v30
v_dot2_f32_bf16 v29, v193, s45, v29
v_dot2_f32_bf16 v31, v193, v193, v31
v_dot2_f32_bf16 v28, v194, s45, v28
v_dot2_f32_bf16 v30, v194, v194, v30
v_dot2_f32_bf16 v29, v195, s45, v29
v_dot2_f32_bf16 v31, v195, v195, v31
v_dot2_f32_bf16 v28, v196, s45, v28
v_dot2_f32_bf16 v30, v196, v196, v30
v_dot2_f32_bf16 v29, v197, s45, v29
v_dot2_f32_bf16 v31, v197, v197, v31
v_dot2_f32_bf16 v28, v198, s45, v28
v_dot2_f32_bf16 v30, v198, v198, v30
v_dot2_f32_bf16 v29, v199, s45, v29
v_dot2_f32_bf16 v31, v199, v199, v31
v_dot2_f32_bf16 v28, v200, s45, v28
v_dot2_f32_bf16 v30, v200, v200, v30
v_dot2_f32_bf16 v29, v201, s45, v29
v_dot2_f32_bf16 v31, v201, v201, v31
v_dot2_f32_bf16 v28, v202, s45, v28
v_dot2_f32_bf16 v30, v202, v202, v30
v_dot2_f32_bf16 v29, v203, s45, v29
v_dot2_f32_bf16 v31, v203, v203, v31
v_dot2_f32_bf16 v28, v204, s45, v28
v_dot2_f32_bf16 v30, v204, v204, v30
v_dot2_f32_bf16 v29, v205, s45, v29
v_dot2_f32_bf16 v31, v205, v205, v31
v_dot2_f32_bf16 v28, v206, s45, v28
v_dot2_f32_bf16 v30, v206, v206, v30
v_dot2_f32_bf16 v29, v207, s45, v29
v_dot2_f32_bf16 v31, v207, v207, v31
s_waitcnt vmcnt(4)
ds_read_b128 v[224:227], v2 offset:24576
ds_read_b128 v[228:231], v3 offset:24576
ds_read_b128 v[232:235], v4 offset:24576
ds_read_b128 v[236:239], v5 offset:24576
s_waitcnt lgkmcnt(4)
v_dot2_f32_bf16 v28, v208, s45, v28
v_dot2_f32_bf16 v30, v208, v208, v30
v_dot2_f32_bf16 v29, v209, s45, v29
v_dot2_f32_bf16 v31, v209, v209, v31
v_dot2_f32_bf16 v28, v210, s45, v28
v_dot2_f32_bf16 v30, v210, v210, v30
v_dot2_f32_bf16 v29, v211, s45, v29
v_dot2_f32_bf16 v31, v211, v211, v31
v_dot2_f32_bf16 v28, v212, s45, v28
v_dot2_f32_bf16 v30, v212, v212, v30
v_dot2_f32_bf16 v29, v213, s45, v29
v_dot2_f32_bf16 v31, v213, v213, v31
v_dot2_f32_bf16 v28, v214, s45, v28
v_dot2_f32_bf16 v30, v214, v214, v30
v_dot2_f32_bf16 v29, v215, s45, v29
v_dot2_f32_bf16 v31, v215, v215, v31
v_dot2_f32_bf16 v28, v216, s45, v28
v_dot2_f32_bf16 v30, v216, v216, v30
v_dot2_f32_bf16 v29, v217, s45, v29
v_dot2_f32_bf16 v31, v217, v217, v31
v_dot2_f32_bf16 v28, v218, s45, v28
v_dot2_f32_bf16 v30, v218, v218, v30
v_dot2_f32_bf16 v29, v219, s45, v29
v_dot2_f32_bf16 v31, v219, v219, v31
v_dot2_f32_bf16 v28, v220, s45, v28
v_dot2_f32_bf16 v30, v220, v220, v30
v_dot2_f32_bf16 v29, v221, s45, v29
v_dot2_f32_bf16 v31, v221, v221, v31
v_dot2_f32_bf16 v28, v222, s45, v28
v_dot2_f32_bf16 v30, v222, v222, v30
v_dot2_f32_bf16 v29, v223, s45, v29
v_dot2_f32_bf16 v31, v223, v223, v31
s_waitcnt vmcnt(0)
ds_read_b128 v[240:243], v2 offset:28672
ds_read_b128 v[244:247], v3 offset:28672
ds_read_b128 v[248:251], v4 offset:28672
ds_read_b128 v[252:255], v5 offset:28672
s_waitcnt lgkmcnt(4)
v_dot2_f32_bf16 v28, v224, s45, v28
v_dot2_f32_bf16 v30, v224, v224, v30
v_dot2_f32_bf16 v29, v225, s45, v29
v_dot2_f32_bf16 v31, v225, v225, v31
v_dot2_f32_bf16 v28, v226, s45, v28
v_dot2_f32_bf16 v30, v226, v226, v30
v_dot2_f32_bf16 v29, v227, s45, v29
v_dot2_f32_bf16 v31, v227, v227, v31
v_dot2_f32_bf16 v28, v228, s45, v28
v_dot2_f32_bf16 v30, v228, v228, v30
v_dot2_f32_bf16 v29, v229, s45, v29
v_dot2_f32_bf16 v31, v229, v229, v31
v_dot2_f32_bf16 v28, v230, s45, v28
v_dot2_f32_bf16 v30, v230, v230, v30
v_dot2_f32_bf16 v29, v231, s45, v29
v_dot2_f32_bf16 v31, v231, v231, v31
v_dot2_f32_bf16 v28, v232, s45, v28
v_dot2_f32_bf16 v30, v232, v232, v30
v_dot2_f32_bf16 v29, v233, s45, v29
v_dot2_f32_bf16 v31, v233, v233, v31
v_dot2_f32_bf16 v28, v234, s45, v28
v_dot2_f32_bf16 v30, v234, v234, v30
v_dot2_f32_bf16 v29, v235, s45, v29
v_dot2_f32_bf16 v31, v235, v235, v31
v_dot2_f32_bf16 v28, v236, s45, v28
v_dot2_f32_bf16 v30, v236, v236, v30
v_dot2_f32_bf16 v29, v237, s45, v29
v_dot2_f32_bf16 v31, v237, v237, v31
v_dot2_f32_bf16 v28, v238, s45, v28
v_dot2_f32_bf16 v30, v238, v238, v30
v_dot2_f32_bf16 v29, v239, s45, v29
v_dot2_f32_bf16 v31, v239, v239, v31
s_waitcnt lgkmcnt(0)
s_barrier
s_mul_i32 s44, s4, 15360
s_mov_b32 m0, s44
v_xor_b32 v2, 0x10000, v14
v_xor_b32 v3, 0x10020, v14
v_xor_b32 v4, 0x10040, v14
v_xor_b32 v5, 0x10060, v14
ds_read_b64_tr_b16 v[32:33], v2 offset:0
ds_read_b64_tr_b16 v[34:35], v2 offset:512
ds_read_b64_tr_b16 v[36:37], v3 offset:0
ds_read_b64_tr_b16 v[38:39], v3 offset:512
ds_read_b64_tr_b16 v[40:41], v4 offset:0
ds_read_b64_tr_b16 v[42:43], v4 offset:512
ds_read_b64_tr_b16 v[44:45], v5 offset:0
ds_read_b64_tr_b16 v[46:47], v5 offset:512
ds_read_b64_tr_b16 v[48:49], v2 offset:4096
ds_read_b64_tr_b16 v[50:51], v2 offset:4608
ds_read_b64_tr_b16 v[52:53], v3 offset:4096
ds_read_b64_tr_b16 v[54:55], v3 offset:4608
ds_read_b64_tr_b16 v[56:57], v4 offset:4096
ds_read_b64_tr_b16 v[58:59], v4 offset:4608
ds_read_b64_tr_b16 v[60:61], v5 offset:4096
ds_read_b64_tr_b16 v[62:63], v5 offset:4608
v_dot2_f32_bf16 v28, v240, s45, v28
v_dot2_f32_bf16 v30, v240, v240, v30
v_dot2_f32_bf16 v29, v241, s45, v29
v_dot2_f32_bf16 v31, v241, v241, v31
v_dot2_f32_bf16 v28, v242, s45, v28
v_dot2_f32_bf16 v30, v242, v242, v30
v_dot2_f32_bf16 v29, v243, s45, v29
v_dot2_f32_bf16 v31, v243, v243, v31
v_dot2_f32_bf16 v28, v244, s45, v28
v_dot2_f32_bf16 v30, v244, v244, v30
v_dot2_f32_bf16 v29, v245, s45, v29
v_dot2_f32_bf16 v31, v245, v245, v31
v_dot2_f32_bf16 v28, v246, s45, v28
v_dot2_f32_bf16 v30, v246, v246, v30
v_dot2_f32_bf16 v29, v247, s45, v29
v_dot2_f32_bf16 v31, v247, v247, v31
v_dot2_f32_bf16 v28, v248, s45, v28
v_dot2_f32_bf16 v30, v248, v248, v30
v_dot2_f32_bf16 v29, v249, s45, v29
v_dot2_f32_bf16 v31, v249, v249, v31
v_dot2_f32_bf16 v28, v250, s45, v28
v_dot2_f32_bf16 v30, v250, v250, v30
v_dot2_f32_bf16 v29, v251, s45, v29
v_dot2_f32_bf16 v31, v251, v251, v31
v_dot2_f32_bf16 v28, v252, s45, v28
v_dot2_f32_bf16 v30, v252, v252, v30
v_dot2_f32_bf16 v29, v253, s45, v29
v_dot2_f32_bf16 v31, v253, v253, v31
v_dot2_f32_bf16 v28, v254, s45, v28
v_dot2_f32_bf16 v30, v254, v254, v30
v_dot2_f32_bf16 v29, v255, s45, v29
v_dot2_f32_bf16 v31, v255, v255, v31
s_nop 1
v_add_f32 v28, v28, v29
v_add_f32 v30, v30, v31
s_nop 1
v_permlane32_swap_b32 v28, v30
v_add_f32 v28, v28, v30
v_mov_b32 v30, v28
s_nop 1
v_permlane32_swap_b32 v28, v30
v_mul_f32 v10, 0x3b000000, v28
v_mul_f32 v11, 0x3b000000, v30
v_cvt_pk_bf16_f32 v29, -v10, -v10
v_lshlrev_b32 v8, 16, v29
ds_write_b64 v13, v[10:11]
s_mov_b32 s46, 0xffff0000
s_mov_b32 s44, 0x3f80
s_mov_b32 s45, 0x3f800000
v_dot2_f32_bf16 v16, v128, s44, v8
v_dot2_f32_bf16 v17, v128, s45, v8
v_dot2_f32_bf16 v18, v129, s44, v8
v_dot2_f32_bf16 v19, v129, s45, v8
v_dot2_f32_bf16 v20, v130, s44, v8
v_dot2_f32_bf16 v21, v130, s45, v8
v_dot2_f32_bf16 v22, v131, s44, v8
v_dot2_f32_bf16 v23, v131, s45, v8
v_cvt_pk_bf16_f32 v128, v16, v17
v_cvt_pk_bf16_f32 v129, v18, v19
v_cvt_pk_bf16_f32 v130, v20, v21
v_cvt_pk_bf16_f32 v131, v22, v23
v_dot2_f32_bf16 v16, v132, s44, v8
v_dot2_f32_bf16 v17, v132, s45, v8
v_dot2_f32_bf16 v18, v133, s44, v8
v_dot2_f32_bf16 v19, v133, s45, v8
v_dot2_f32_bf16 v20, v134, s44, v8
v_dot2_f32_bf16 v21, v134, s45, v8
v_dot2_f32_bf16 v22, v135, s44, v8
v_dot2_f32_bf16 v23, v135, s45, v8
v_cvt_pk_bf16_f32 v132, v16, v17
v_cvt_pk_bf16_f32 v133, v18, v19
v_cvt_pk_bf16_f32 v134, v20, v21
v_cvt_pk_bf16_f32 v135, v22, v23
v_dot2_f32_bf16 v16, v136, s44, v8
v_dot2_f32_bf16 v17, v136, s45, v8
v_dot2_f32_bf16 v18, v137, s44, v8
v_dot2_f32_bf16 v19, v137, s45, v8
v_dot2_f32_bf16 v20, v138, s44, v8
v_dot2_f32_bf16 v21, v138, s45, v8
v_dot2_f32_bf16 v22, v139, s44, v8
v_dot2_f32_bf16 v23, v139, s45, v8
v_cvt_pk_bf16_f32 v136, v16, v17
v_cvt_pk_bf16_f32 v137, v18, v19
v_cvt_pk_bf16_f32 v138, v20, v21
v_cvt_pk_bf16_f32 v139, v22, v23
v_dot2_f32_bf16 v16, v140, s44, v8
v_dot2_f32_bf16 v17, v140, s45, v8
v_dot2_f32_bf16 v18, v141, s44, v8
v_dot2_f32_bf16 v19, v141, s45, v8
v_dot2_f32_bf16 v20, v142, s44, v8
v_dot2_f32_bf16 v21, v142, s45, v8
v_dot2_f32_bf16 v22, v143, s44, v8
v_dot2_f32_bf16 v23, v143, s45, v8
v_cvt_pk_bf16_f32 v140, v16, v17
v_cvt_pk_bf16_f32 v141, v18, v19
v_cvt_pk_bf16_f32 v142, v20, v21
v_cvt_pk_bf16_f32 v143, v22, v23
v_dot2_f32_bf16 v16, v144, s44, v8
v_dot2_f32_bf16 v17, v144, s45, v8
v_dot2_f32_bf16 v18, v145, s44, v8
v_dot2_f32_bf16 v19, v145, s45, v8
v_dot2_f32_bf16 v20, v146, s44, v8
v_dot2_f32_bf16 v21, v146, s45, v8
v_dot2_f32_bf16 v22, v147, s44, v8
v_dot2_f32_bf16 v23, v147, s45, v8
v_cvt_pk_bf16_f32 v144, v16, v17
v_cvt_pk_bf16_f32 v145, v18, v19
v_cvt_pk_bf16_f32 v146, v20, v21
v_cvt_pk_bf16_f32 v147, v22, v23
v_dot2_f32_bf16 v16, v148, s44, v8
v_dot2_f32_bf16 v17, v148, s45, v8
v_dot2_f32_bf16 v18, v149, s44, v8
v_dot2_f32_bf16 v19, v149, s45, v8
v_dot2_f32_bf16 v20, v150, s44, v8
v_dot2_f32_bf16 v21, v150, s45, v8
v_dot2_f32_bf16 v22, v151, s44, v8
v_dot2_f32_bf16 v23, v151, s45, v8
v_cvt_pk_bf16_f32 v148, v16, v17
v_cvt_pk_bf16_f32 v149, v18, v19
v_cvt_pk_bf16_f32 v150, v20, v21
v_cvt_pk_bf16_f32 v151, v22, v23
v_dot2_f32_bf16 v16, v152, s44, v8
v_dot2_f32_bf16 v17, v152, s45, v8
v_dot2_f32_bf16 v18, v153, s44, v8
v_dot2_f32_bf16 v19, v153, s45, v8
v_dot2_f32_bf16 v20, v154, s44, v8
v_dot2_f32_bf16 v21, v154, s45, v8
v_dot2_f32_bf16 v22, v155, s44, v8
v_dot2_f32_bf16 v23, v155, s45, v8
v_cvt_pk_bf16_f32 v152, v16, v17
v_cvt_pk_bf16_f32 v153, v18, v19
v_cvt_pk_bf16_f32 v154, v20, v21
v_cvt_pk_bf16_f32 v155, v22, v23
v_dot2_f32_bf16 v16, v156, s44, v8
v_dot2_f32_bf16 v17, v156, s45, v8
v_dot2_f32_bf16 v18, v157, s44, v8
v_dot2_f32_bf16 v19, v157, s45, v8
v_dot2_f32_bf16 v20, v158, s44, v8
v_dot2_f32_bf16 v21, v158, s45, v8
v_dot2_f32_bf16 v22, v159, s44, v8
v_dot2_f32_bf16 v23, v159, s45, v8
v_cvt_pk_bf16_f32 v156, v16, v17
v_cvt_pk_bf16_f32 v157, v18, v19
v_cvt_pk_bf16_f32 v158, v20, v21
v_cvt_pk_bf16_f32 v159, v22, v23
v_dot2_f32_bf16 v16, v160, s44, v8
v_dot2_f32_bf16 v17, v160, s45, v8
v_dot2_f32_bf16 v18, v161, s44, v8
v_dot2_f32_bf16 v19, v161, s45, v8
v_dot2_f32_bf16 v20, v162, s44, v8
v_dot2_f32_bf16 v21, v162, s45, v8
v_dot2_f32_bf16 v22, v163, s44, v8
v_dot2_f32_bf16 v23, v163, s45, v8
v_cvt_pk_bf16_f32 v160, v16, v17
v_cvt_pk_bf16_f32 v161, v18, v19
v_cvt_pk_bf16_f32 v162, v20, v21
v_cvt_pk_bf16_f32 v163, v22, v23
v_dot2_f32_bf16 v16, v164, s44, v8
v_dot2_f32_bf16 v17, v164, s45, v8
v_dot2_f32_bf16 v18, v165, s44, v8
v_dot2_f32_bf16 v19, v165, s45, v8
v_dot2_f32_bf16 v20, v166, s44, v8
v_dot2_f32_bf16 v21, v166, s45, v8
v_dot2_f32_bf16 v22, v167, s44, v8
v_dot2_f32_bf16 v23, v167, s45, v8
v_cvt_pk_bf16_f32 v164, v16, v17
v_cvt_pk_bf16_f32 v165, v18, v19
v_cvt_pk_bf16_f32 v166, v20, v21
v_cvt_pk_bf16_f32 v167, v22, v23
v_dot2_f32_bf16 v16, v168, s44, v8
v_dot2_f32_bf16 v17, v168, s45, v8
v_dot2_f32_bf16 v18, v169, s44, v8
v_dot2_f32_bf16 v19, v169, s45, v8
v_dot2_f32_bf16 v20, v170, s44, v8
v_dot2_f32_bf16 v21, v170, s45, v8
v_dot2_f32_bf16 v22, v171, s44, v8
v_dot2_f32_bf16 v23, v171, s45, v8
v_cvt_pk_bf16_f32 v168, v16, v17
v_cvt_pk_bf16_f32 v169, v18, v19
v_cvt_pk_bf16_f32 v170, v20, v21
v_cvt_pk_bf16_f32 v171, v22, v23
v_dot2_f32_bf16 v16, v172, s44, v8
v_dot2_f32_bf16 v17, v172, s45, v8
v_dot2_f32_bf16 v18, v173, s44, v8
v_dot2_f32_bf16 v19, v173, s45, v8
v_dot2_f32_bf16 v20, v174, s44, v8
v_dot2_f32_bf16 v21, v174, s45, v8
v_dot2_f32_bf16 v22, v175, s44, v8
v_dot2_f32_bf16 v23, v175, s45, v8
v_cvt_pk_bf16_f32 v172, v16, v17
v_cvt_pk_bf16_f32 v173, v18, v19
v_cvt_pk_bf16_f32 v174, v20, v21
v_cvt_pk_bf16_f32 v175, v22, v23
s_waitcnt lgkmcnt(9)
v_mfma_f32_32x32x16_bf16 v[64:79], v[32:35], v[128:131], 0
ds_read_b64_tr_b16 v[32:33], v2 offset:8192
ds_read_b64_tr_b16 v[34:35], v2 offset:8704
v_lshlrev_b32 v16, 16, v176
v_and_b32 v17, s46, v176
v_lshlrev_b32 v18, 16, v177
v_and_b32 v19, s46, v177
v_mfma_f32_32x32x16_bf16 v[80:95], v[36:39], v[128:131], 0
ds_read_b64_tr_b16 v[36:37], v3 offset:8192
ds_read_b64_tr_b16 v[38:39], v3 offset:8704
v_add_f32 v16, v16, v8
v_add_f32 v17, v17, v8
v_add_f32 v18, v18, v8
v_add_f32 v19, v19, v8
v_mfma_f32_32x32x16_bf16 v[96:111], v[40:43], v[128:131], 0
ds_read_b64_tr_b16 v[40:41], v4 offset:8192
ds_read_b64_tr_b16 v[42:43], v4 offset:8704
v_cvt_pk_bf16_f32 v176, v16, v17
v_cvt_pk_bf16_f32 v177, v18, v19
v_lshlrev_b32 v20, 16, v178
v_and_b32 v21, s46, v178
v_mfma_f32_32x32x16_bf16 v[112:127], v[44:47], v[128:131], 0
ds_read_b64_tr_b16 v[44:45], v5 offset:8192
ds_read_b64_tr_b16 v[46:47], v5 offset:8704
v_lshlrev_b32 v22, 16, v179
v_and_b32 v23, s46, v179
v_add_f32 v20, v20, v8
s_waitcnt lgkmcnt(9)
v_mfma_f32_32x32x16_bf16 v[64:79], v[48:51], v[132:135], v[64:79]
ds_read_b64_tr_b16 v[48:49], v2 offset:12288
ds_read_b64_tr_b16 v[50:51], v2 offset:12800
v_add_f32 v21, v21, v8
v_add_f32 v22, v22, v8
v_add_f32 v23, v23, v8
v_cvt_pk_bf16_f32 v178, v20, v21
v_mfma_f32_32x32x16_bf16 v[80:95], v[52:55], v[132:135], v[80:95]
ds_read_b64_tr_b16 v[52:53], v3 offset:12288
ds_read_b64_tr_b16 v[54:55], v3 offset:12800
v_cvt_pk_bf16_f32 v179, v22, v23
v_lshlrev_b32 v16, 16, v180
v_and_b32 v17, s46, v180
v_lshlrev_b32 v18, 16, v181
v_mfma_f32_32x32x16_bf16 v[96:111], v[56:59], v[132:135], v[96:111]
ds_read_b64_tr_b16 v[56:57], v4 offset:12288
ds_read_b64_tr_b16 v[58:59], v4 offset:12800
v_and_b32 v19, s46, v181
v_add_f32 v16, v16, v8
v_add_f32 v17, v17, v8
v_add_f32 v18, v18, v8
v_mfma_f32_32x32x16_bf16 v[112:127], v[60:63], v[132:135], v[112:127]
ds_read_b64_tr_b16 v[60:61], v5 offset:12288
ds_read_b64_tr_b16 v[62:63], v5 offset:12800
v_add_f32 v19, v19, v8
v_cvt_pk_bf16_f32 v180, v16, v17
v_cvt_pk_bf16_f32 v181, v18, v19
s_waitcnt lgkmcnt(8)
v_mfma_f32_32x32x16_bf16 v[64:79], v[32:35], v[136:139], v[64:79]
s_barrier
ds_read_b64_tr_b16 v[32:33], v2 offset:16384
ds_read_b64_tr_b16 v[34:35], v2 offset:16896
v_lshlrev_b32 v20, 16, v182
v_and_b32 v21, s46, v182
v_lshlrev_b32 v22, 16, v183
v_mfma_f32_32x32x16_bf16 v[80:95], v[36:39], v[136:139], v[80:95]
ds_read_b64_tr_b16 v[36:37], v3 offset:16384
ds_read_b64_tr_b16 v[38:39], v3 offset:16896
v_and_b32 v23, s46, v183
v_add_f32 v20, v20, v8
v_add_f32 v21, v21, v8
v_add_f32 v22, v22, v8
v_mfma_f32_32x32x16_bf16 v[96:111], v[40:43], v[136:139], v[96:111]
ds_read_b64_tr_b16 v[40:41], v4 offset:16384
ds_read_b64_tr_b16 v[42:43], v4 offset:16896
v_add_f32 v23, v23, v8
v_cvt_pk_bf16_f32 v182, v20, v21
v_cvt_pk_bf16_f32 v183, v22, v23
v_lshlrev_b32 v16, 16, v184
v_mfma_f32_32x32x16_bf16 v[112:127], v[44:47], v[136:139], v[112:127]
ds_read_b64_tr_b16 v[44:45], v5 offset:16384
ds_read_b64_tr_b16 v[46:47], v5 offset:16896
v_and_b32 v17, s46, v184
v_lshlrev_b32 v18, 16, v185
v_and_b32 v19, s46, v185
s_waitcnt lgkmcnt(8)
v_mfma_f32_32x32x16_bf16 v[64:79], v[48:51], v[140:143], v[64:79]
ds_read_b64_tr_b16 v[48:49], v2 offset:20480
ds_read_b64_tr_b16 v[50:51], v2 offset:20992
v_add_f32 v16, v16, v8
v_add_f32 v17, v17, v8
v_add_f32 v18, v18, v8
v_add_f32 v19, v19, v8
v_mfma_f32_32x32x16_bf16 v[80:95], v[52:55], v[140:143], v[80:95]
ds_read_b64_tr_b16 v[52:53], v3 offset:20480
ds_read_b64_tr_b16 v[54:55], v3 offset:20992
v_cvt_pk_bf16_f32 v184, v16, v17
v_cvt_pk_bf16_f32 v185, v18, v19
v_lshlrev_b32 v20, 16, v186
v_and_b32 v21, s46, v186
v_mfma_f32_32x32x16_bf16 v[96:111], v[56:59], v[140:143], v[96:111]
ds_read_b64_tr_b16 v[56:57], v4 offset:20480
ds_read_b64_tr_b16 v[58:59], v4 offset:20992
v_lshlrev_b32 v22, 16, v187
v_and_b32 v23, s46, v187
v_add_f32 v20, v20, v8
v_add_f32 v21, v21, v8
v_mfma_f32_32x32x16_bf16 v[112:127], v[60:63], v[140:143], v[112:127]
ds_read_b64_tr_b16 v[60:61], v5 offset:20480
ds_read_b64_tr_b16 v[62:63], v5 offset:20992
v_add_f32 v22, v22, v8
v_add_f32 v23, v23, v8
v_cvt_pk_bf16_f32 v186, v20, v21
s_waitcnt lgkmcnt(8)
v_mfma_f32_32x32x16_bf16 v[64:79], v[32:35], v[144:147], v[64:79]
ds_read_b64_tr_b16 v[32:33], v2 offset:24576
ds_read_b64_tr_b16 v[34:35], v2 offset:25088
v_cvt_pk_bf16_f32 v187, v22, v23
v_lshlrev_b32 v16, 16, v188
v_and_b32 v17, s46, v188
v_lshlrev_b32 v18, 16, v189
v_mfma_f32_32x32x16_bf16 v[80:95], v[36:39], v[144:147], v[80:95]
ds_read_b64_tr_b16 v[36:37], v3 offset:24576
ds_read_b64_tr_b16 v[38:39], v3 offset:25088
v_and_b32 v19, s46, v189
v_add_f32 v16, v16, v8
v_add_f32 v17, v17, v8
v_add_f32 v18, v18, v8
v_mfma_f32_32x32x16_bf16 v[96:111], v[40:43], v[144:147], v[96:111]
ds_read_b64_tr_b16 v[40:41], v4 offset:24576
ds_read_b64_tr_b16 v[42:43], v4 offset:25088
v_add_f32 v19, v19, v8
v_cvt_pk_bf16_f32 v188, v16, v17
v_cvt_pk_bf16_f32 v189, v18, v19
v_lshlrev_b32 v20, 16, v190
v_mfma_f32_32x32x16_bf16 v[112:127], v[44:47], v[144:147], v[112:127]
ds_read_b64_tr_b16 v[44:45], v5 offset:24576
ds_read_b64_tr_b16 v[46:47], v5 offset:25088
v_and_b32 v21, s46, v190
v_lshlrev_b32 v22, 16, v191
v_and_b32 v23, s46, v191
s_waitcnt lgkmcnt(8)
v_mfma_f32_32x32x16_bf16 v[64:79], v[48:51], v[148:151], v[64:79]
ds_read_b64_tr_b16 v[48:49], v2 offset:28672
ds_read_b64_tr_b16 v[50:51], v2 offset:29184
v_add_f32 v20, v20, v8
v_add_f32 v21, v21, v8
v_add_f32 v22, v22, v8
v_add_f32 v23, v23, v8
v_mfma_f32_32x32x16_bf16 v[80:95], v[52:55], v[148:151], v[80:95]
ds_read_b64_tr_b16 v[52:53], v3 offset:28672
ds_read_b64_tr_b16 v[54:55], v3 offset:29184
v_cvt_pk_bf16_f32 v190, v20, v21
v_cvt_pk_bf16_f32 v191, v22, v23
v_lshlrev_b32 v16, 16, v192
v_and_b32 v17, s46, v192
v_mfma_f32_32x32x16_bf16 v[96:111], v[56:59], v[148:151], v[96:111]
ds_read_b64_tr_b16 v[56:57], v4 offset:28672
ds_read_b64_tr_b16 v[58:59], v4 offset:29184
v_lshlrev_b32 v18, 16, v193
v_and_b32 v19, s46, v193
v_add_f32 v16, v16, v8
v_add_f32 v17, v17, v8
v_mfma_f32_32x32x16_bf16 v[112:127], v[60:63], v[148:151], v[112:127]
ds_read_b64_tr_b16 v[60:61], v5 offset:28672
ds_read_b64_tr_b16 v[62:63], v5 offset:29184
v_add_f32 v18, v18, v8
v_add_f32 v19, v19, v8
v_cvt_pk_bf16_f32 v192, v16, v17
s_waitcnt lgkmcnt(8)
v_mfma_f32_32x32x16_bf16 v[64:79], v[32:35], v[152:155], v[64:79]
s_barrier
ds_read_b64_tr_b16 v[32:33], v2 offset:32768
ds_read_b64_tr_b16 v[34:35], v2 offset:33280
v_cvt_pk_bf16_f32 v193, v18, v19
v_lshlrev_b32 v20, 16, v194
v_and_b32 v21, s46, v194
v_mfma_f32_32x32x16_bf16 v[80:95], v[36:39], v[152:155], v[80:95]
ds_read_b64_tr_b16 v[36:37], v3 offset:32768
ds_read_b64_tr_b16 v[38:39], v3 offset:33280
v_lshlrev_b32 v22, 16, v195
v_and_b32 v23, s46, v195
v_add_f32 v20, v20, v8
v_add_f32 v21, v21, v8
v_mfma_f32_32x32x16_bf16 v[96:111], v[40:43], v[152:155], v[96:111]
ds_read_b64_tr_b16 v[40:41], v4 offset:32768
ds_read_b64_tr_b16 v[42:43], v4 offset:33280
v_add_f32 v22, v22, v8
v_add_f32 v23, v23, v8
v_cvt_pk_bf16_f32 v194, v20, v21
v_cvt_pk_bf16_f32 v195, v22, v23
v_mfma_f32_32x32x16_bf16 v[112:127], v[44:47], v[152:155], v[112:127]
ds_read_b64_tr_b16 v[44:45], v5 offset:32768
ds_read_b64_tr_b16 v[46:47], v5 offset:33280
v_lshlrev_b32 v16, 16, v196
v_and_b32 v17, s46, v196
v_lshlrev_b32 v18, 16, v197
s_waitcnt lgkmcnt(8)
v_mfma_f32_32x32x16_bf16 v[64:79], v[48:51], v[156:159], v[64:79]
ds_read_b64_tr_b16 v[48:49], v2 offset:36864
ds_read_b64_tr_b16 v[50:51], v2 offset:37376
v_and_b32 v19, s46, v197
v_add_f32 v16, v16, v8
v_add_f32 v17, v17, v8
v_add_f32 v18, v18, v8
v_mfma_f32_32x32x16_bf16 v[80:95], v[52:55], v[156:159], v[80:95]
ds_read_b64_tr_b16 v[52:53], v3 offset:36864
ds_read_b64_tr_b16 v[54:55], v3 offset:37376
v_add_f32 v19, v19, v8
v_cvt_pk_bf16_f32 v196, v16, v17
v_cvt_pk_bf16_f32 v197, v18, v19
v_lshlrev_b32 v20, 16, v198
v_mfma_f32_32x32x16_bf16 v[96:111], v[56:59], v[156:159], v[96:111]
ds_read_b64_tr_b16 v[56:57], v4 offset:36864
ds_read_b64_tr_b16 v[58:59], v4 offset:37376
v_and_b32 v21, s46, v198
v_lshlrev_b32 v22, 16, v199
v_and_b32 v23, s46, v199
v_add_f32 v20, v20, v8
v_mfma_f32_32x32x16_bf16 v[112:127], v[60:63], v[156:159], v[112:127]
ds_read_b64_tr_b16 v[60:61], v5 offset:36864
ds_read_b64_tr_b16 v[62:63], v5 offset:37376
v_add_f32 v21, v21, v8
v_add_f32 v22, v22, v8
v_add_f32 v23, v23, v8
s_waitcnt lgkmcnt(8)
v_mfma_f32_32x32x16_bf16 v[64:79], v[32:35], v[160:163], v[64:79]
ds_read_b64_tr_b16 v[32:33], v2 offset:40960
ds_read_b64_tr_b16 v[34:35], v2 offset:41472
v_cvt_pk_bf16_f32 v198, v20, v21
v_cvt_pk_bf16_f32 v199, v22, v23
v_lshlrev_b32 v16, 16, v200
v_and_b32 v17, s46, v200
v_mfma_f32_32x32x16_bf16 v[80:95], v[36:39], v[160:163], v[80:95]
ds_read_b64_tr_b16 v[36:37], v3 offset:40960
ds_read_b64_tr_b16 v[38:39], v3 offset:41472
v_lshlrev_b32 v18, 16, v201
v_and_b32 v19, s46, v201
v_add_f32 v16, v16, v8
v_add_f32 v17, v17, v8
v_mfma_f32_32x32x16_bf16 v[96:111], v[40:43], v[160:163], v[96:111]
ds_read_b64_tr_b16 v[40:41], v4 offset:40960
ds_read_b64_tr_b16 v[42:43], v4 offset:41472
v_add_f32 v18, v18, v8
v_add_f32 v19, v19, v8
v_cvt_pk_bf16_f32 v200, v16, v17
v_cvt_pk_bf16_f32 v201, v18, v19
v_mfma_f32_32x32x16_bf16 v[112:127], v[44:47], v[160:163], v[112:127]
ds_read_b64_tr_b16 v[44:45], v5 offset:40960
ds_read_b64_tr_b16 v[46:47], v5 offset:41472
v_lshlrev_b32 v20, 16, v202
v_and_b32 v21, s46, v202
v_lshlrev_b32 v22, 16, v203
s_waitcnt lgkmcnt(8)
v_mfma_f32_32x32x16_bf16 v[64:79], v[48:51], v[164:167], v[64:79]
ds_read_b64_tr_b16 v[48:49], v2 offset:45056
ds_read_b64_tr_b16 v[50:51], v2 offset:45568
v_and_b32 v23, s46, v203
v_add_f32 v20, v20, v8
v_add_f32 v21, v21, v8
v_add_f32 v22, v22, v8
v_mfma_f32_32x32x16_bf16 v[80:95], v[52:55], v[164:167], v[80:95]
ds_read_b64_tr_b16 v[52:53], v3 offset:45056
ds_read_b64_tr_b16 v[54:55], v3 offset:45568
v_add_f32 v23, v23, v8
v_cvt_pk_bf16_f32 v202, v20, v21
v_cvt_pk_bf16_f32 v203, v22, v23
v_lshlrev_b32 v16, 16, v204
v_mfma_f32_32x32x16_bf16 v[96:111], v[56:59], v[164:167], v[96:111]
ds_read_b64_tr_b16 v[56:57], v4 offset:45056
ds_read_b64_tr_b16 v[58:59], v4 offset:45568
v_and_b32 v17, s46, v204
v_lshlrev_b32 v18, 16, v205
v_and_b32 v19, s46, v205
v_add_f32 v16, v16, v8
v_mfma_f32_32x32x16_bf16 v[112:127], v[60:63], v[164:167], v[112:127]
ds_read_b64_tr_b16 v[60:61], v5 offset:45056
ds_read_b64_tr_b16 v[62:63], v5 offset:45568
v_add_f32 v17, v17, v8
v_add_f32 v18, v18, v8
v_add_f32 v19, v19, v8
s_waitcnt lgkmcnt(8)
v_mfma_f32_32x32x16_bf16 v[64:79], v[32:35], v[168:171], v[64:79]
s_barrier
ds_read_b64_tr_b16 v[32:33], v2 offset:49152
ds_read_b64_tr_b16 v[34:35], v2 offset:49664
v_cvt_pk_bf16_f32 v204, v16, v17
v_cvt_pk_bf16_f32 v205, v18, v19
v_lshlrev_b32 v20, 16, v206
v_mfma_f32_32x32x16_bf16 v[80:95], v[36:39], v[168:171], v[80:95]
ds_read_b64_tr_b16 v[36:37], v3 offset:49152
ds_read_b64_tr_b16 v[38:39], v3 offset:49664
v_and_b32 v21, s46, v206
v_lshlrev_b32 v22, 16, v207
v_and_b32 v23, s46, v207
v_add_f32 v20, v20, v8
v_mfma_f32_32x32x16_bf16 v[96:111], v[40:43], v[168:171], v[96:111]
ds_read_b64_tr_b16 v[40:41], v4 offset:49152
ds_read_b64_tr_b16 v[42:43], v4 offset:49664
v_add_f32 v21, v21, v8
v_add_f32 v22, v22, v8
v_add_f32 v23, v23, v8
v_cvt_pk_bf16_f32 v206, v20, v21
v_mfma_f32_32x32x16_bf16 v[112:127], v[44:47], v[168:171], v[112:127]
ds_read_b64_tr_b16 v[44:45], v5 offset:49152
ds_read_b64_tr_b16 v[46:47], v5 offset:49664
v_cvt_pk_bf16_f32 v207, v22, v23
v_lshlrev_b32 v16, 16, v208
v_and_b32 v17, s46, v208
s_waitcnt lgkmcnt(8)
v_mfma_f32_32x32x16_bf16 v[64:79], v[48:51], v[172:175], v[64:79]
ds_read_b64_tr_b16 v[48:49], v2 offset:53248
ds_read_b64_tr_b16 v[50:51], v2 offset:53760
v_lshlrev_b32 v18, 16, v209
v_and_b32 v19, s46, v209
v_add_f32 v16, v16, v8
v_add_f32 v17, v17, v8
v_mfma_f32_32x32x16_bf16 v[80:95], v[52:55], v[172:175], v[80:95]
ds_read_b64_tr_b16 v[52:53], v3 offset:53248
ds_read_b64_tr_b16 v[54:55], v3 offset:53760
v_add_f32 v18, v18, v8
v_add_f32 v19, v19, v8
v_cvt_pk_bf16_f32 v208, v16, v17
v_cvt_pk_bf16_f32 v209, v18, v19
v_mfma_f32_32x32x16_bf16 v[96:111], v[56:59], v[172:175], v[96:111]
ds_read_b64_tr_b16 v[56:57], v4 offset:53248
ds_read_b64_tr_b16 v[58:59], v4 offset:53760
v_lshlrev_b32 v20, 16, v210
v_and_b32 v21, s46, v210
v_lshlrev_b32 v22, 16, v211
v_and_b32 v23, s46, v211
v_mfma_f32_32x32x16_bf16 v[112:127], v[60:63], v[172:175], v[112:127]
ds_read_b64_tr_b16 v[60:61], v5 offset:53248
ds_read_b64_tr_b16 v[62:63], v5 offset:53760
v_add_f32 v20, v20, v8
v_add_f32 v21, v21, v8
v_add_f32 v22, v22, v8
s_waitcnt lgkmcnt(8)
v_mfma_f32_32x32x16_bf16 v[64:79], v[32:35], v[176:179], v[64:79]
ds_read_b64_tr_b16 v[32:33], v2 offset:57344
ds_read_b64_tr_b16 v[34:35], v2 offset:57856
v_add_f32 v23, v23, v8
v_cvt_pk_bf16_f32 v210, v20, v21
v_cvt_pk_bf16_f32 v211, v22, v23
v_lshlrev_b32 v16, 16, v212
v_mfma_f32_32x32x16_bf16 v[80:95], v[36:39], v[176:179], v[80:95]
ds_read_b64_tr_b16 v[36:37], v3 offset:57344
ds_read_b64_tr_b16 v[38:39], v3 offset:57856
v_and_b32 v17, s46, v212
v_lshlrev_b32 v18, 16, v213
v_and_b32 v19, s46, v213
v_add_f32 v16, v16, v8
v_mfma_f32_32x32x16_bf16 v[96:111], v[40:43], v[176:179], v[96:111]
ds_read_b64_tr_b16 v[40:41], v4 offset:57344
ds_read_b64_tr_b16 v[42:43], v4 offset:57856
v_add_f32 v17, v17, v8
v_add_f32 v18, v18, v8
v_add_f32 v19, v19, v8
v_cvt_pk_bf16_f32 v212, v16, v17
v_mfma_f32_32x32x16_bf16 v[112:127], v[44:47], v[176:179], v[112:127]
ds_read_b64_tr_b16 v[44:45], v5 offset:57344
ds_read_b64_tr_b16 v[46:47], v5 offset:57856
v_cvt_pk_bf16_f32 v213, v18, v19
v_lshlrev_b32 v20, 16, v214
v_and_b32 v21, s46, v214
s_waitcnt lgkmcnt(8)
v_mfma_f32_32x32x16_bf16 v[64:79], v[48:51], v[180:183], v[64:79]
ds_read_b64_tr_b16 v[48:49], v2 offset:61440
ds_read_b64_tr_b16 v[50:51], v2 offset:61952
v_lshlrev_b32 v22, 16, v215
v_and_b32 v23, s46, v215
v_add_f32 v20, v20, v8
v_add_f32 v21, v21, v8
v_mfma_f32_32x32x16_bf16 v[80:95], v[52:55], v[180:183], v[80:95]
ds_read_b64_tr_b16 v[52:53], v3 offset:61440
ds_read_b64_tr_b16 v[54:55], v3 offset:61952
v_add_f32 v22, v22, v8
v_add_f32 v23, v23, v8
v_cvt_pk_bf16_f32 v214, v20, v21
v_cvt_pk_bf16_f32 v215, v22, v23
v_mfma_f32_32x32x16_bf16 v[96:111], v[56:59], v[180:183], v[96:111]
ds_read_b64_tr_b16 v[56:57], v4 offset:61440
ds_read_b64_tr_b16 v[58:59], v4 offset:61952
v_lshlrev_b32 v16, 16, v216
v_and_b32 v17, s46, v216
v_lshlrev_b32 v18, 16, v217
v_and_b32 v19, s46, v217
v_mfma_f32_32x32x16_bf16 v[112:127], v[60:63], v[180:183], v[112:127]
ds_read_b64_tr_b16 v[60:61], v5 offset:61440
ds_read_b64_tr_b16 v[62:63], v5 offset:61952
v_add_f32 v16, v16, v8
v_add_f32 v17, v17, v8
v_add_f32 v18, v18, v8
s_waitcnt lgkmcnt(8)
v_mfma_f32_32x32x16_bf16 v[64:79], v[32:35], v[184:187], v[64:79]
s_barrier
v_xor_b32 v2, 0x20000, v14
v_xor_b32 v3, 0x20020, v14
v_xor_b32 v4, 0x20040, v14
v_xor_b32 v5, 0x20060, v14
ds_read_b64_tr_b16 v[32:33], v2 offset:0
ds_read_b64_tr_b16 v[34:35], v2 offset:512
v_mfma_f32_32x32x16_bf16 v[80:95], v[36:39], v[184:187], v[80:95]
ds_read_b64_tr_b16 v[36:37], v3 offset:0
ds_read_b64_tr_b16 v[38:39], v3 offset:512
v_add_f32 v19, v19, v8
v_cvt_pk_bf16_f32 v216, v16, v17
v_cvt_pk_bf16_f32 v217, v18, v19
v_lshlrev_b32 v20, 16, v218
v_mfma_f32_32x32x16_bf16 v[96:111], v[40:43], v[184:187], v[96:111]
ds_read_b64_tr_b16 v[40:41], v4 offset:0
ds_read_b64_tr_b16 v[42:43], v4 offset:512
v_and_b32 v21, s46, v218
v_lshlrev_b32 v22, 16, v219
v_and_b32 v23, s46, v219
v_add_f32 v20, v20, v8
v_mfma_f32_32x32x16_bf16 v[112:127], v[44:47], v[184:187], v[112:127]
ds_read_b64_tr_b16 v[44:45], v5 offset:0
ds_read_b64_tr_b16 v[46:47], v5 offset:512
v_add_f32 v21, v21, v8
v_add_f32 v22, v22, v8
v_add_f32 v23, v23, v8
s_waitcnt lgkmcnt(8)
v_mfma_f32_32x32x16_bf16 v[64:79], v[48:51], v[188:191], v[64:79]
ds_read_b64_tr_b16 v[48:49], v2 offset:4096
ds_read_b64_tr_b16 v[50:51], v2 offset:4608
v_cvt_pk_bf16_f32 v218, v20, v21
v_cvt_pk_bf16_f32 v219, v22, v23
v_lshlrev_b32 v16, 16, v220
v_and_b32 v17, s46, v220
v_mfma_f32_32x32x16_bf16 v[80:95], v[52:55], v[188:191], v[80:95]
ds_read_b64_tr_b16 v[52:53], v3 offset:4096
ds_read_b64_tr_b16 v[54:55], v3 offset:4608
v_lshlrev_b32 v18, 16, v221
v_and_b32 v19, s46, v221
v_add_f32 v16, v16, v8
v_add_f32 v17, v17, v8
v_mfma_f32_32x32x16_bf16 v[96:111], v[56:59], v[188:191], v[96:111]
ds_read_b64_tr_b16 v[56:57], v4 offset:4096
ds_read_b64_tr_b16 v[58:59], v4 offset:4608
v_add_f32 v18, v18, v8
v_add_f32 v19, v19, v8
v_cvt_pk_bf16_f32 v220, v16, v17
v_cvt_pk_bf16_f32 v221, v18, v19
v_mfma_f32_32x32x16_bf16 v[112:127], v[60:63], v[188:191], v[112:127]
ds_read_b64_tr_b16 v[60:61], v5 offset:4096
ds_read_b64_tr_b16 v[62:63], v5 offset:4608
v_lshlrev_b32 v20, 16, v222
v_and_b32 v21, s46, v222
v_lshlrev_b32 v22, 16, v223
s_waitcnt lgkmcnt(8)
v_mfma_f32_32x32x16_bf16 v[64:79], v[32:35], v[192:195], v[64:79]
ds_read_b64_tr_b16 v[32:33], v2 offset:8192
ds_read_b64_tr_b16 v[34:35], v2 offset:8704
v_and_b32 v23, s46, v223
v_add_f32 v20, v20, v8
v_add_f32 v21, v21, v8
v_add_f32 v22, v22, v8
v_mfma_f32_32x32x16_bf16 v[80:95], v[36:39], v[192:195], v[80:95]
ds_read_b64_tr_b16 v[36:37], v3 offset:8192
ds_read_b64_tr_b16 v[38:39], v3 offset:8704
v_add_f32 v23, v23, v8
v_cvt_pk_bf16_f32 v222, v20, v21
v_cvt_pk_bf16_f32 v223, v22, v23
v_lshlrev_b32 v16, 16, v224
v_mfma_f32_32x32x16_bf16 v[96:111], v[40:43], v[192:195], v[96:111]
ds_read_b64_tr_b16 v[40:41], v4 offset:8192
ds_read_b64_tr_b16 v[42:43], v4 offset:8704
v_and_b32 v17, s46, v224
v_lshlrev_b32 v18, 16, v225
v_and_b32 v19, s46, v225
v_add_f32 v16, v16, v8
v_mfma_f32_32x32x16_bf16 v[112:127], v[44:47], v[192:195], v[112:127]
ds_read_b64_tr_b16 v[44:45], v5 offset:8192
ds_read_b64_tr_b16 v[46:47], v5 offset:8704
v_add_f32 v17, v17, v8
v_add_f32 v18, v18, v8
v_add_f32 v19, v19, v8
s_waitcnt lgkmcnt(8)
v_mfma_f32_32x32x16_bf16 v[64:79], v[48:51], v[196:199], v[64:79]
ds_read_b64_tr_b16 v[48:49], v2 offset:12288
ds_read_b64_tr_b16 v[50:51], v2 offset:12800
v_cvt_pk_bf16_f32 v224, v16, v17
v_cvt_pk_bf16_f32 v225, v18, v19
v_lshlrev_b32 v20, 16, v226
v_and_b32 v21, s46, v226
v_mfma_f32_32x32x16_bf16 v[80:95], v[52:55], v[196:199], v[80:95]
ds_read_b64_tr_b16 v[52:53], v3 offset:12288
ds_read_b64_tr_b16 v[54:55], v3 offset:12800
v_lshlrev_b32 v22, 16, v227
v_and_b32 v23, s46, v227
v_add_f32 v20, v20, v8
v_add_f32 v21, v21, v8
v_mfma_f32_32x32x16_bf16 v[96:111], v[56:59], v[196:199], v[96:111]
ds_read_b64_tr_b16 v[56:57], v4 offset:12288
ds_read_b64_tr_b16 v[58:59], v4 offset:12800
v_add_f32 v22, v22, v8
v_add_f32 v23, v23, v8
v_cvt_pk_bf16_f32 v226, v20, v21
v_cvt_pk_bf16_f32 v227, v22, v23
v_mfma_f32_32x32x16_bf16 v[112:127], v[60:63], v[196:199], v[112:127]
ds_read_b64_tr_b16 v[60:61], v5 offset:12288
ds_read_b64_tr_b16 v[62:63], v5 offset:12800
v_lshlrev_b32 v16, 16, v228
v_and_b32 v17, s46, v228
v_lshlrev_b32 v18, 16, v229
s_waitcnt lgkmcnt(8)
v_mfma_f32_32x32x16_bf16 v[64:79], v[32:35], v[200:203], v[64:79]
s_barrier
ds_read_b64_tr_b16 v[32:33], v2 offset:16384
ds_read_b64_tr_b16 v[34:35], v2 offset:16896
v_and_b32 v19, s46, v229
v_add_f32 v16, v16, v8
v_add_f32 v17, v17, v8
v_mfma_f32_32x32x16_bf16 v[80:95], v[36:39], v[200:203], v[80:95]
ds_read_b64_tr_b16 v[36:37], v3 offset:16384
ds_read_b64_tr_b16 v[38:39], v3 offset:16896
v_add_f32 v18, v18, v8
v_add_f32 v19, v19, v8
v_cvt_pk_bf16_f32 v228, v16, v17
v_cvt_pk_bf16_f32 v229, v18, v19
v_mfma_f32_32x32x16_bf16 v[96:111], v[40:43], v[200:203], v[96:111]
ds_read_b64_tr_b16 v[40:41], v4 offset:16384
ds_read_b64_tr_b16 v[42:43], v4 offset:16896
v_lshlrev_b32 v20, 16, v230
v_and_b32 v21, s46, v230
v_lshlrev_b32 v22, 16, v231
v_and_b32 v23, s46, v231
v_mfma_f32_32x32x16_bf16 v[112:127], v[44:47], v[200:203], v[112:127]
ds_read_b64_tr_b16 v[44:45], v5 offset:16384
ds_read_b64_tr_b16 v[46:47], v5 offset:16896
v_add_f32 v20, v20, v8
v_add_f32 v21, v21, v8
v_add_f32 v22, v22, v8
s_waitcnt lgkmcnt(8)
v_mfma_f32_32x32x16_bf16 v[64:79], v[48:51], v[204:207], v[64:79]
ds_read_b64_tr_b16 v[48:49], v2 offset:20480
ds_read_b64_tr_b16 v[50:51], v2 offset:20992
v_add_f32 v23, v23, v8
v_cvt_pk_bf16_f32 v230, v20, v21
v_cvt_pk_bf16_f32 v231, v22, v23
v_lshlrev_b32 v16, 16, v232
v_mfma_f32_32x32x16_bf16 v[80:95], v[52:55], v[204:207], v[80:95]
ds_read_b64_tr_b16 v[52:53], v3 offset:20480
ds_read_b64_tr_b16 v[54:55], v3 offset:20992
v_and_b32 v17, s46, v232
v_lshlrev_b32 v18, 16, v233
v_and_b32 v19, s46, v233
v_add_f32 v16, v16, v8
v_mfma_f32_32x32x16_bf16 v[96:111], v[56:59], v[204:207], v[96:111]
ds_read_b64_tr_b16 v[56:57], v4 offset:20480
ds_read_b64_tr_b16 v[58:59], v4 offset:20992
v_add_f32 v17, v17, v8
v_add_f32 v18, v18, v8
v_add_f32 v19, v19, v8
v_cvt_pk_bf16_f32 v232, v16, v17
v_mfma_f32_32x32x16_bf16 v[112:127], v[60:63], v[204:207], v[112:127]
ds_read_b64_tr_b16 v[60:61], v5 offset:20480
ds_read_b64_tr_b16 v[62:63], v5 offset:20992
v_cvt_pk_bf16_f32 v233, v18, v19
v_lshlrev_b32 v20, 16, v234
v_and_b32 v21, s46, v234
s_waitcnt lgkmcnt(8)
v_mfma_f32_32x32x16_bf16 v[64:79], v[32:35], v[208:211], v[64:79]
ds_read_b64_tr_b16 v[32:33], v2 offset:24576
ds_read_b64_tr_b16 v[34:35], v2 offset:25088
v_lshlrev_b32 v22, 16, v235
v_and_b32 v23, s46, v235
v_add_f32 v20, v20, v8
v_add_f32 v21, v21, v8
v_mfma_f32_32x32x16_bf16 v[80:95], v[36:39], v[208:211], v[80:95]
ds_read_b64_tr_b16 v[36:37], v3 offset:24576
ds_read_b64_tr_b16 v[38:39], v3 offset:25088
v_add_f32 v22, v22, v8
v_add_f32 v23, v23, v8
v_cvt_pk_bf16_f32 v234, v20, v21
v_cvt_pk_bf16_f32 v235, v22, v23
v_mfma_f32_32x32x16_bf16 v[96:111], v[40:43], v[208:211], v[96:111]
ds_read_b64_tr_b16 v[40:41], v4 offset:24576
ds_read_b64_tr_b16 v[42:43], v4 offset:25088
v_lshlrev_b32 v16, 16, v236
v_and_b32 v17, s46, v236
v_lshlrev_b32 v18, 16, v237
v_and_b32 v19, s46, v237
v_mfma_f32_32x32x16_bf16 v[112:127], v[44:47], v[208:211], v[112:127]
ds_read_b64_tr_b16 v[44:45], v5 offset:24576
ds_read_b64_tr_b16 v[46:47], v5 offset:25088
v_add_f32 v16, v16, v8
v_add_f32 v17, v17, v8
v_add_f32 v18, v18, v8
s_waitcnt lgkmcnt(8)
v_mfma_f32_32x32x16_bf16 v[64:79], v[48:51], v[212:215], v[64:79]
ds_read_b64_tr_b16 v[48:49], v2 offset:28672
ds_read_b64_tr_b16 v[50:51], v2 offset:29184
v_add_f32 v19, v19, v8
v_cvt_pk_bf16_f32 v236, v16, v17
v_cvt_pk_bf16_f32 v237, v18, v19
v_lshlrev_b32 v20, 16, v238
v_mfma_f32_32x32x16_bf16 v[80:95], v[52:55], v[212:215], v[80:95]
ds_read_b64_tr_b16 v[52:53], v3 offset:28672
ds_read_b64_tr_b16 v[54:55], v3 offset:29184
v_and_b32 v21, s46, v238
v_lshlrev_b32 v22, 16, v239
v_and_b32 v23, s46, v239
v_add_f32 v20, v20, v8
v_mfma_f32_32x32x16_bf16 v[96:111], v[56:59], v[212:215], v[96:111]
ds_read_b64_tr_b16 v[56:57], v4 offset:28672
ds_read_b64_tr_b16 v[58:59], v4 offset:29184
v_add_f32 v21, v21, v8
v_add_f32 v22, v22, v8
v_add_f32 v23, v23, v8
v_cvt_pk_bf16_f32 v238, v20, v21
v_mfma_f32_32x32x16_bf16 v[112:127], v[60:63], v[212:215], v[112:127]
ds_read_b64_tr_b16 v[60:61], v5 offset:28672
ds_read_b64_tr_b16 v[62:63], v5 offset:29184
v_cvt_pk_bf16_f32 v239, v22, v23
v_lshlrev_b32 v16, 16, v240
v_and_b32 v17, s46, v240
s_waitcnt lgkmcnt(8)
v_mfma_f32_32x32x16_bf16 v[64:79], v[32:35], v[216:219], v[64:79]
s_barrier
v_xor_b32 v2, 0x10000, v14
v_xor_b32 v3, 0x10020, v14
v_xor_b32 v4, 0x10040, v14
v_xor_b32 v5, 0x10060, v14
ds_read_b64_tr_b16 v[32:33], v2 offset:0
ds_read_b64_tr_b16 v[34:35], v2 offset:512
v_mfma_f32_32x32x16_bf16 v[80:95], v[36:39], v[216:219], v[80:95]
ds_read_b64_tr_b16 v[36:37], v3 offset:0
ds_read_b64_tr_b16 v[38:39], v3 offset:512
v_lshlrev_b32 v18, 16, v241
v_and_b32 v19, s46, v241
v_add_f32 v16, v16, v8
v_add_f32 v17, v17, v8
v_mfma_f32_32x32x16_bf16 v[96:111], v[40:43], v[216:219], v[96:111]
ds_read_b64_tr_b16 v[40:41], v4 offset:0
ds_read_b64_tr_b16 v[42:43], v4 offset:512
v_add_f32 v18, v18, v8
v_add_f32 v19, v19, v8
v_cvt_pk_bf16_f32 v240, v16, v17
v_cvt_pk_bf16_f32 v241, v18, v19
v_mfma_f32_32x32x16_bf16 v[112:127], v[44:47], v[216:219], v[112:127]
ds_read_b64_tr_b16 v[44:45], v5 offset:0
ds_read_b64_tr_b16 v[46:47], v5 offset:512
v_lshlrev_b32 v20, 16, v242
v_and_b32 v21, s46, v242
v_lshlrev_b32 v22, 16, v243
s_waitcnt lgkmcnt(8)
v_mfma_f32_32x32x16_bf16 v[64:79], v[48:51], v[220:223], v[64:79]
ds_read_b64_tr_b16 v[48:49], v2 offset:4096
ds_read_b64_tr_b16 v[50:51], v2 offset:4608
v_and_b32 v23, s46, v243
v_add_f32 v20, v20, v8
v_add_f32 v21, v21, v8
v_add_f32 v22, v22, v8
v_mfma_f32_32x32x16_bf16 v[80:95], v[52:55], v[220:223], v[80:95]
ds_read_b64_tr_b16 v[52:53], v3 offset:4096
ds_read_b64_tr_b16 v[54:55], v3 offset:4608
v_add_f32 v23, v23, v8
v_cvt_pk_bf16_f32 v242, v20, v21
v_cvt_pk_bf16_f32 v243, v22, v23
v_lshlrev_b32 v16, 16, v244
v_mfma_f32_32x32x16_bf16 v[96:111], v[56:59], v[220:223], v[96:111]
ds_read_b64_tr_b16 v[56:57], v4 offset:4096
ds_read_b64_tr_b16 v[58:59], v4 offset:4608
v_and_b32 v17, s46, v244
v_lshlrev_b32 v18, 16, v245
v_and_b32 v19, s46, v245
v_add_f32 v16, v16, v8
v_mfma_f32_32x32x16_bf16 v[112:127], v[60:63], v[220:223], v[112:127]
ds_read_b64_tr_b16 v[60:61], v5 offset:4096
ds_read_b64_tr_b16 v[62:63], v5 offset:4608
v_add_f32 v17, v17, v8
v_add_f32 v18, v18, v8
v_add_f32 v19, v19, v8
s_waitcnt lgkmcnt(8)
v_mfma_f32_32x32x16_bf16 v[64:79], v[32:35], v[224:227], v[64:79]
ds_read_b64_tr_b16 v[32:33], v2 offset:8192
ds_read_b64_tr_b16 v[34:35], v2 offset:8704
v_cvt_pk_bf16_f32 v244, v16, v17
v_cvt_pk_bf16_f32 v245, v18, v19
v_lshlrev_b32 v20, 16, v246
v_and_b32 v21, s46, v246
v_mfma_f32_32x32x16_bf16 v[80:95], v[36:39], v[224:227], v[80:95]
ds_read_b64_tr_b16 v[36:37], v3 offset:8192
ds_read_b64_tr_b16 v[38:39], v3 offset:8704
v_lshlrev_b32 v22, 16, v247
v_and_b32 v23, s46, v247
v_add_f32 v20, v20, v8
v_add_f32 v21, v21, v8
v_mfma_f32_32x32x16_bf16 v[96:111], v[40:43], v[224:227], v[96:111]
ds_read_b64_tr_b16 v[40:41], v4 offset:8192
ds_read_b64_tr_b16 v[42:43], v4 offset:8704
v_add_f32 v22, v22, v8
v_add_f32 v23, v23, v8
v_cvt_pk_bf16_f32 v246, v20, v21
v_cvt_pk_bf16_f32 v247, v22, v23
v_mfma_f32_32x32x16_bf16 v[112:127], v[44:47], v[224:227], v[112:127]
ds_read_b64_tr_b16 v[44:45], v5 offset:8192
ds_read_b64_tr_b16 v[46:47], v5 offset:8704
v_lshlrev_b32 v16, 16, v248
v_and_b32 v17, s46, v248
v_lshlrev_b32 v18, 16, v249
s_waitcnt lgkmcnt(8)
v_mfma_f32_32x32x16_bf16 v[64:79], v[48:51], v[228:231], v[64:79]
ds_read_b64_tr_b16 v[48:49], v2 offset:12288
ds_read_b64_tr_b16 v[50:51], v2 offset:12800
v_and_b32 v19, s46, v249
v_add_f32 v16, v16, v8
v_add_f32 v17, v17, v8
v_add_f32 v18, v18, v8
v_mfma_f32_32x32x16_bf16 v[80:95], v[52:55], v[228:231], v[80:95]
ds_read_b64_tr_b16 v[52:53], v3 offset:12288
ds_read_b64_tr_b16 v[54:55], v3 offset:12800
v_add_f32 v19, v19, v8
v_cvt_pk_bf16_f32 v248, v16, v17
v_cvt_pk_bf16_f32 v249, v18, v19
v_lshlrev_b32 v20, 16, v250
v_mfma_f32_32x32x16_bf16 v[96:111], v[56:59], v[228:231], v[96:111]
ds_read_b64_tr_b16 v[56:57], v4 offset:12288
ds_read_b64_tr_b16 v[58:59], v4 offset:12800
v_and_b32 v21, s46, v250
v_lshlrev_b32 v22, 16, v251
v_and_b32 v23, s46, v251
v_add_f32 v20, v20, v8
v_mfma_f32_32x32x16_bf16 v[112:127], v[60:63], v[228:231], v[112:127]
ds_read_b64_tr_b16 v[60:61], v5 offset:12288
ds_read_b64_tr_b16 v[62:63], v5 offset:12800
v_add_f32 v21, v21, v8
v_add_f32 v22, v22, v8
v_add_f32 v23, v23, v8
s_waitcnt lgkmcnt(8)
v_mfma_f32_32x32x16_bf16 v[64:79], v[32:35], v[232:235], v[64:79]
s_barrier
ds_read_b64_tr_b16 v[32:33], v2 offset:16384
ds_read_b64_tr_b16 v[34:35], v2 offset:16896
v_cvt_pk_bf16_f32 v250, v20, v21
v_cvt_pk_bf16_f32 v251, v22, v23
v_lshlrev_b32 v16, 16, v252
v_mfma_f32_32x32x16_bf16 v[80:95], v[36:39], v[232:235], v[80:95]
ds_read_b64_tr_b16 v[36:37], v2 offset:20480
ds_read_b64_tr_b16 v[38:39], v2 offset:20992
v_and_b32 v17, s46, v252
v_lshlrev_b32 v18, 16, v253
v_and_b32 v19, s46, v253
v_add_f32 v16, v16, v8
v_mfma_f32_32x32x16_bf16 v[96:111], v[40:43], v[232:235], v[96:111]
ds_read_b64_tr_b16 v[40:41], v2 offset:24576
ds_read_b64_tr_b16 v[42:43], v2 offset:25088
v_add_f32 v17, v17, v8
v_add_f32 v18, v18, v8
v_add_f32 v19, v19, v8
v_cvt_pk_bf16_f32 v252, v16, v17
v_mfma_f32_32x32x16_bf16 v[112:127], v[44:47], v[232:235], v[112:127]
ds_read_b64_tr_b16 v[44:45], v2 offset:28672
ds_read_b64_tr_b16 v[46:47], v2 offset:29184
v_cvt_pk_bf16_f32 v253, v18, v19
v_lshlrev_b32 v20, 16, v254
v_and_b32 v21, s46, v254
s_waitcnt lgkmcnt(8)
v_mfma_f32_32x32x16_bf16 v[64:79], v[48:51], v[236:239], v[64:79]
ds_read_b64_tr_b16 v[48:49], v3 offset:16384
ds_read_b64_tr_b16 v[50:51], v3 offset:16896
v_lshlrev_b32 v22, 16, v255
v_and_b32 v23, s46, v255
v_add_f32 v20, v20, v8
v_add_f32 v21, v21, v8
v_mfma_f32_32x32x16_bf16 v[80:95], v[52:55], v[236:239], v[80:95]
ds_read_b64_tr_b16 v[52:53], v3 offset:20480
ds_read_b64_tr_b16 v[54:55], v3 offset:20992
v_add_f32 v22, v22, v8
v_add_f32 v23, v23, v8
v_cvt_pk_bf16_f32 v254, v20, v21
v_cvt_pk_bf16_f32 v255, v22, v23
v_mfma_f32_32x32x16_bf16 v[96:111], v[56:59], v[236:239], v[96:111]
ds_read_b64_tr_b16 v[56:57], v3 offset:24576
ds_read_b64_tr_b16 v[58:59], v3 offset:25088
v_mfma_f32_32x32x16_bf16 v[112:127], v[60:63], v[236:239], v[112:127]
ds_read_b64_tr_b16 v[60:61], v3 offset:28672
ds_read_b64_tr_b16 v[62:63], v3 offset:29184
s_waitcnt lgkmcnt(8)
v_mfma_f32_32x32x16_bf16 v[64:79], v[32:35], v[240:243], v[64:79]
ds_read_b64_tr_b16 v[32:33], v4 offset:16384
ds_read_b64_tr_b16 v[34:35], v4 offset:16896
v_mfma_f32_32x32x16_bf16 v[64:79], v[36:39], v[244:247], v[64:79]
ds_read_b64_tr_b16 v[36:37], v4 offset:20480
ds_read_b64_tr_b16 v[38:39], v4 offset:20992
v_mfma_f32_32x32x16_bf16 v[64:79], v[40:43], v[248:251], v[64:79]
ds_read_b64_tr_b16 v[40:41], v4 offset:24576
ds_read_b64_tr_b16 v[42:43], v4 offset:25088
v_mfma_f32_32x32x16_bf16 v[64:79], v[44:47], v[252:255], v[64:79]
ds_read_b64_tr_b16 v[44:45], v4 offset:28672
ds_read_b64_tr_b16 v[46:47], v4 offset:29184
s_waitcnt lgkmcnt(8)
v_mfma_f32_32x32x16_bf16 v[80:95], v[48:51], v[240:243], v[80:95]
ds_read_b64_tr_b16 v[48:49], v5 offset:16384
ds_read_b64_tr_b16 v[50:51], v5 offset:16896
v_mfma_f32_32x32x16_bf16 v[80:95], v[52:55], v[244:247], v[80:95]
ds_read_b64_tr_b16 v[52:53], v5 offset:20480
ds_read_b64_tr_b16 v[54:55], v5 offset:20992
v_mfma_f32_32x32x16_bf16 v[80:95], v[56:59], v[248:251], v[80:95]
ds_read_b64_tr_b16 v[56:57], v5 offset:24576
ds_read_b64_tr_b16 v[58:59], v5 offset:25088
v_cvt_pk_bf16_f32 v16, v64, v65
v_cvt_pk_bf16_f32 v17, v66, v67
v_mfma_f32_32x32x16_bf16 v[80:95], v[60:63], v[252:255], v[80:95]
ds_write_addtid_b32 v16 offset:0
ds_write_addtid_b32 v17 offset:256
ds_read_b64_tr_b16 v[60:61], v5 offset:28672
ds_read_b64_tr_b16 v[62:63], v5 offset:29184
v_cvt_pk_bf16_f32 v18, v68, v69
v_cvt_pk_bf16_f32 v19, v70, v71
s_waitcnt lgkmcnt(10)
v_mfma_f32_32x32x16_bf16 v[96:111], v[32:35], v[240:243], v[96:111]
ds_write_addtid_b32 v18 offset:512
ds_write_addtid_b32 v19 offset:768
s_barrier
ds_read_b64_tr_b16 v[32:33], v2 offset:32768
ds_read_b64_tr_b16 v[34:35], v2 offset:33280
v_cvt_pk_bf16_f32 v20, v72, v73
v_cvt_pk_bf16_f32 v21, v74, v75
v_mfma_f32_32x32x16_bf16 v[96:111], v[36:39], v[244:247], v[96:111]
ds_write_addtid_b32 v20 offset:1024
ds_write_addtid_b32 v21 offset:1280
ds_read_b64_tr_b16 v[36:37], v2 offset:36864
ds_read_b64_tr_b16 v[38:39], v2 offset:37376
v_cvt_pk_bf16_f32 v22, v76, v77
v_cvt_pk_bf16_f32 v23, v78, v79
v_mfma_f32_32x32x16_bf16 v[96:111], v[40:43], v[248:251], v[96:111]
ds_write_addtid_b32 v22 offset:1536
ds_write_addtid_b32 v23 offset:1792
ds_read_b64_tr_b16 v[40:41], v2 offset:40960
ds_read_b64_tr_b16 v[42:43], v2 offset:41472
v_cvt_pk_bf16_f32 v24, v80, v81
v_cvt_pk_bf16_f32 v25, v82, v83
v_mfma_f32_32x32x16_bf16 v[96:111], v[44:47], v[252:255], v[96:111]
ds_write_addtid_b32 v24 offset:2048
ds_write_addtid_b32 v25 offset:2304
ds_read_b64_tr_b16 v[44:45], v2 offset:45056
ds_read_b64_tr_b16 v[46:47], v2 offset:45568
v_cvt_pk_bf16_f32 v26, v84, v85
v_cvt_pk_bf16_f32 v27, v86, v87
s_waitcnt lgkmcnt(15)
v_mfma_f32_32x32x16_bf16 v[112:127], v[48:51], v[240:243], v[112:127]
ds_write_addtid_b32 v26 offset:2560
ds_write_addtid_b32 v27 offset:2816
ds_read_b64_tr_b16 v[48:49], v3 offset:32768
ds_read_b64_tr_b16 v[50:51], v3 offset:33280
v_cvt_pk_bf16_f32 v28, v88, v89
v_cvt_pk_bf16_f32 v29, v90, v91
v_mfma_f32_32x32x16_bf16 v[112:127], v[52:55], v[244:247], v[112:127]
ds_write_addtid_b32 v28 offset:3072
ds_write_addtid_b32 v29 offset:3328
ds_read_b64_tr_b16 v[52:53], v3 offset:36864
ds_read_b64_tr_b16 v[54:55], v3 offset:37376
v_cvt_pk_bf16_f32 v30, v92, v93
v_cvt_pk_bf16_f32 v31, v94, v95
v_mfma_f32_32x32x16_bf16 v[112:127], v[56:59], v[248:251], v[112:127]
ds_write_addtid_b32 v30 offset:3584
ds_write_addtid_b32 v31 offset:3840
ds_read_b64_tr_b16 v[56:57], v3 offset:40960
ds_read_b64_tr_b16 v[58:59], v3 offset:41472
v_cvt_pk_bf16_f32 v16, v96, v97
v_cvt_pk_bf16_f32 v17, v98, v99
v_mfma_f32_32x32x16_bf16 v[112:127], v[60:63], v[252:255], v[112:127]
ds_write_addtid_b32 v16 offset:4096
ds_write_addtid_b32 v17 offset:4352
ds_read_b64_tr_b16 v[60:61], v3 offset:45056
ds_read_b64_tr_b16 v[62:63], v3 offset:45568
v_cvt_pk_bf16_f32 v18, v100, v101
v_cvt_pk_bf16_f32 v19, v102, v103
s_waitcnt lgkmcnt(15)
v_mfma_f32_32x32x16_bf16 v[64:79], v[32:35], v[128:131], 0
ds_write_addtid_b32 v18 offset:4608
ds_write_addtid_b32 v19 offset:4864
ds_read_b64_tr_b16 v[32:33], v4 offset:32768
ds_read_b64_tr_b16 v[34:35], v4 offset:33280
v_cvt_pk_bf16_f32 v20, v104, v105
v_cvt_pk_bf16_f32 v21, v106, v107
v_mfma_f32_32x32x16_bf16 v[64:79], v[36:39], v[132:135], v[64:79]
ds_write_addtid_b32 v20 offset:5120
ds_write_addtid_b32 v21 offset:5376
ds_read_b64_tr_b16 v[36:37], v4 offset:36864
ds_read_b64_tr_b16 v[38:39], v4 offset:37376
v_cvt_pk_bf16_f32 v22, v108, v109
v_cvt_pk_bf16_f32 v23, v110, v111
v_mfma_f32_32x32x16_bf16 v[64:79], v[40:43], v[136:139], v[64:79]
ds_write_addtid_b32 v22 offset:5632
ds_write_addtid_b32 v23 offset:5888
ds_read_b64_tr_b16 v[40:41], v4 offset:40960
ds_read_b64_tr_b16 v[42:43], v4 offset:41472
v_cvt_pk_bf16_f32 v24, v112, v113
v_cvt_pk_bf16_f32 v25, v114, v115
v_mfma_f32_32x32x16_bf16 v[64:79], v[44:47], v[140:143], v[64:79]
ds_write_addtid_b32 v24 offset:6144
ds_write_addtid_b32 v25 offset:6400
ds_read_b64_tr_b16 v[44:45], v4 offset:45056
ds_read_b64_tr_b16 v[46:47], v4 offset:45568
v_cvt_pk_bf16_f32 v26, v116, v117
v_cvt_pk_bf16_f32 v27, v118, v119
s_waitcnt lgkmcnt(15)
v_mfma_f32_32x32x16_bf16 v[80:95], v[48:51], v[128:131], 0
ds_write_addtid_b32 v26 offset:6656
ds_write_addtid_b32 v27 offset:6912
ds_read_b64_tr_b16 v[48:49], v5 offset:32768
ds_read_b64_tr_b16 v[50:51], v5 offset:33280
v_cvt_pk_bf16_f32 v28, v120, v121
v_cvt_pk_bf16_f32 v29, v122, v123
v_mfma_f32_32x32x16_bf16 v[80:95], v[52:55], v[132:135], v[80:95]
ds_write_addtid_b32 v28 offset:7168
ds_write_addtid_b32 v29 offset:7424
ds_read_b64_tr_b16 v[52:53], v5 offset:36864
ds_read_b64_tr_b16 v[54:55], v5 offset:37376
v_cvt_pk_bf16_f32 v30, v124, v125
v_cvt_pk_bf16_f32 v31, v126, v127
v_mfma_f32_32x32x16_bf16 v[80:95], v[56:59], v[136:139], v[80:95]
ds_write_addtid_b32 v30 offset:7680
ds_write_addtid_b32 v31 offset:7936
ds_read_b64_tr_b16 v[56:57], v5 offset:40960
ds_read_b64_tr_b16 v[58:59], v5 offset:41472
v_mfma_f32_32x32x16_bf16 v[80:95], v[60:63], v[140:143], v[80:95]
ds_read_b64_tr_b16 v[60:61], v5 offset:45056
ds_read_b64_tr_b16 v[62:63], v5 offset:45568
s_waitcnt lgkmcnt(14)
v_mfma_f32_32x32x16_bf16 v[96:111], v[32:35], v[128:131], 0
s_waitcnt lgkmcnt(4)
s_barrier
ds_read_b64_tr_b16 v[32:33], v2 offset:49152
ds_read_b64_tr_b16 v[34:35], v2 offset:49664
v_mfma_f32_32x32x16_bf16 v[96:111], v[36:39], v[132:135], v[96:111]
ds_read_b64_tr_b16 v[36:37], v3 offset:49152
ds_read_b64_tr_b16 v[38:39], v3 offset:49664
v_mfma_f32_32x32x16_bf16 v[96:111], v[40:43], v[136:139], v[96:111]
ds_read_b64_tr_b16 v[40:41], v4 offset:49152
ds_read_b64_tr_b16 v[42:43], v4 offset:49664
v_mfma_f32_32x32x16_bf16 v[96:111], v[44:47], v[140:143], v[96:111]
ds_read_b64_tr_b16 v[44:45], v5 offset:49152
ds_read_b64_tr_b16 v[46:47], v5 offset:49664
s_waitcnt lgkmcnt(8)
v_mfma_f32_32x32x16_bf16 v[112:127], v[48:51], v[128:131], 0
ds_read_b64_tr_b16 v[48:49], v2 offset:53248
ds_read_b64_tr_b16 v[50:51], v2 offset:53760
v_mfma_f32_32x32x16_bf16 v[112:127], v[52:55], v[132:135], v[112:127]
ds_read_b64_tr_b16 v[52:53], v3 offset:53248
ds_read_b64_tr_b16 v[54:55], v3 offset:53760
v_mfma_f32_32x32x16_bf16 v[112:127], v[56:59], v[136:139], v[112:127]
ds_read_b64_tr_b16 v[56:57], v4 offset:53248
ds_read_b64_tr_b16 v[58:59], v4 offset:53760
v_mfma_f32_32x32x16_bf16 v[112:127], v[60:63], v[140:143], v[112:127]
ds_read_b64_tr_b16 v[60:61], v5 offset:53248
ds_read_b64_tr_b16 v[62:63], v5 offset:53760
s_waitcnt lgkmcnt(8)
v_mfma_f32_32x32x16_bf16 v[64:79], v[32:35], v[144:147], v[64:79]
ds_read_b64_tr_b16 v[32:33], v2 offset:57344
ds_read_b64_tr_b16 v[34:35], v2 offset:57856
v_mfma_f32_32x32x16_bf16 v[80:95], v[36:39], v[144:147], v[80:95]
ds_read_b64_tr_b16 v[36:37], v3 offset:57344
ds_read_b64_tr_b16 v[38:39], v3 offset:57856
v_mfma_f32_32x32x16_bf16 v[96:111], v[40:43], v[144:147], v[96:111]
ds_read_b64_tr_b16 v[40:41], v4 offset:57344
ds_read_b64_tr_b16 v[42:43], v4 offset:57856
v_mfma_f32_32x32x16_bf16 v[112:127], v[44:47], v[144:147], v[112:127]
ds_read_b64_tr_b16 v[44:45], v5 offset:57344
ds_read_b64_tr_b16 v[46:47], v5 offset:57856
s_waitcnt lgkmcnt(8)
v_mfma_f32_32x32x16_bf16 v[64:79], v[48:51], v[148:151], v[64:79]
ds_read_b64_tr_b16 v[48:49], v2 offset:61440
ds_read_b64_tr_b16 v[50:51], v2 offset:61952
v_mfma_f32_32x32x16_bf16 v[80:95], v[52:55], v[148:151], v[80:95]
ds_read_b64_tr_b16 v[52:53], v3 offset:61440
ds_read_b64_tr_b16 v[54:55], v3 offset:61952
v_mfma_f32_32x32x16_bf16 v[96:111], v[56:59], v[148:151], v[96:111]
ds_read_b64_tr_b16 v[56:57], v4 offset:61440
ds_read_b64_tr_b16 v[58:59], v4 offset:61952
v_mfma_f32_32x32x16_bf16 v[112:127], v[60:63], v[148:151], v[112:127]
ds_read_b64_tr_b16 v[60:61], v5 offset:61440
ds_read_b64_tr_b16 v[62:63], v5 offset:61952
s_waitcnt lgkmcnt(8)
v_mfma_f32_32x32x16_bf16 v[64:79], v[32:35], v[152:155], v[64:79]
s_barrier
v_xor_b32 v2, 0x20000, v14
v_xor_b32 v3, 0x20020, v14
v_xor_b32 v4, 0x20040, v14
v_xor_b32 v5, 0x20060, v14
ds_read_b64_tr_b16 v[32:33], v2 offset:0
ds_read_b64_tr_b16 v[34:35], v2 offset:512
v_mfma_f32_32x32x16_bf16 v[80:95], v[36:39], v[152:155], v[80:95]
ds_read_b64_tr_b16 v[36:37], v3 offset:0
ds_read_b64_tr_b16 v[38:39], v3 offset:512
v_mfma_f32_32x32x16_bf16 v[96:111], v[40:43], v[152:155], v[96:111]
ds_read_b64_tr_b16 v[40:41], v4 offset:0
ds_read_b64_tr_b16 v[42:43], v4 offset:512
v_mfma_f32_32x32x16_bf16 v[112:127], v[44:47], v[152:155], v[112:127]
ds_read_b64_tr_b16 v[44:45], v5 offset:0
ds_read_b64_tr_b16 v[46:47], v5 offset:512
s_waitcnt lgkmcnt(8)
v_mfma_f32_32x32x16_bf16 v[64:79], v[48:51], v[156:159], v[64:79]
ds_read_b64_tr_b16 v[48:49], v2 offset:4096
ds_read_b64_tr_b16 v[50:51], v2 offset:4608
v_mfma_f32_32x32x16_bf16 v[80:95], v[52:55], v[156:159], v[80:95]
ds_read_b64_tr_b16 v[52:53], v3 offset:4096
ds_read_b64_tr_b16 v[54:55], v3 offset:4608
v_mfma_f32_32x32x16_bf16 v[96:111], v[56:59], v[156:159], v[96:111]
ds_read_b64_tr_b16 v[56:57], v4 offset:4096
ds_read_b64_tr_b16 v[58:59], v4 offset:4608
v_mfma_f32_32x32x16_bf16 v[112:127], v[60:63], v[156:159], v[112:127]
ds_read_b64_tr_b16 v[60:61], v5 offset:4096
ds_read_b64_tr_b16 v[62:63], v5 offset:4608
s_waitcnt lgkmcnt(8)
v_mfma_f32_32x32x16_bf16 v[64:79], v[32:35], v[160:163], v[64:79]
ds_read_b64_tr_b16 v[32:33], v2 offset:8192
ds_read_b64_tr_b16 v[34:35], v2 offset:8704
v_mfma_f32_32x32x16_bf16 v[80:95], v[36:39], v[160:163], v[80:95]
ds_read_b64_tr_b16 v[36:37], v3 offset:8192
ds_read_b64_tr_b16 v[38:39], v3 offset:8704
v_mfma_f32_32x32x16_bf16 v[96:111], v[40:43], v[160:163], v[96:111]
ds_read_b64_tr_b16 v[40:41], v4 offset:8192
ds_read_b64_tr_b16 v[42:43], v4 offset:8704
v_mfma_f32_32x32x16_bf16 v[112:127], v[44:47], v[160:163], v[112:127]
ds_read_b64_tr_b16 v[44:45], v5 offset:8192
ds_read_b64_tr_b16 v[46:47], v5 offset:8704
s_waitcnt lgkmcnt(8)
v_mfma_f32_32x32x16_bf16 v[64:79], v[48:51], v[164:167], v[64:79]
ds_read_b64_tr_b16 v[48:49], v2 offset:12288
ds_read_b64_tr_b16 v[50:51], v2 offset:12800
v_mfma_f32_32x32x16_bf16 v[80:95], v[52:55], v[164:167], v[80:95]
ds_read_b64_tr_b16 v[52:53], v3 offset:12288
ds_read_b64_tr_b16 v[54:55], v3 offset:12800
v_mfma_f32_32x32x16_bf16 v[96:111], v[56:59], v[164:167], v[96:111]
ds_read_b64_tr_b16 v[56:57], v4 offset:12288
ds_read_b64_tr_b16 v[58:59], v4 offset:12800
v_mfma_f32_32x32x16_bf16 v[112:127], v[60:63], v[164:167], v[112:127]
ds_read_b64_tr_b16 v[60:61], v5 offset:12288
ds_read_b64_tr_b16 v[62:63], v5 offset:12800
s_waitcnt lgkmcnt(8)
v_mfma_f32_32x32x16_bf16 v[64:79], v[32:35], v[168:171], v[64:79]
s_barrier
ds_read_b64_tr_b16 v[32:33], v2 offset:16384
ds_read_b64_tr_b16 v[34:35], v2 offset:16896
v_mfma_f32_32x32x16_bf16 v[80:95], v[36:39], v[168:171], v[80:95]
ds_read_b64_tr_b16 v[36:37], v3 offset:16384
ds_read_b64_tr_b16 v[38:39], v3 offset:16896
v_mfma_f32_32x32x16_bf16 v[96:111], v[40:43], v[168:171], v[96:111]
ds_read_b64_tr_b16 v[40:41], v4 offset:16384
ds_read_b64_tr_b16 v[42:43], v4 offset:16896
v_mfma_f32_32x32x16_bf16 v[112:127], v[44:47], v[168:171], v[112:127]
ds_read_b64_tr_b16 v[44:45], v5 offset:16384
ds_read_b64_tr_b16 v[46:47], v5 offset:16896
s_waitcnt lgkmcnt(8)
v_mfma_f32_32x32x16_bf16 v[64:79], v[48:51], v[172:175], v[64:79]
ds_read_b64_tr_b16 v[48:49], v2 offset:20480
ds_read_b64_tr_b16 v[50:51], v2 offset:20992
v_mfma_f32_32x32x16_bf16 v[80:95], v[52:55], v[172:175], v[80:95]
ds_read_b64_tr_b16 v[52:53], v3 offset:20480
ds_read_b64_tr_b16 v[54:55], v3 offset:20992
v_mfma_f32_32x32x16_bf16 v[96:111], v[56:59], v[172:175], v[96:111]
ds_read_b64_tr_b16 v[56:57], v4 offset:20480
ds_read_b64_tr_b16 v[58:59], v4 offset:20992
v_mfma_f32_32x32x16_bf16 v[112:127], v[60:63], v[172:175], v[112:127]
ds_read_b64_tr_b16 v[60:61], v5 offset:20480
ds_read_b64_tr_b16 v[62:63], v5 offset:20992
s_waitcnt lgkmcnt(8)
v_mfma_f32_32x32x16_bf16 v[64:79], v[32:35], v[176:179], v[64:79]
ds_read_b64_tr_b16 v[32:33], v2 offset:24576
ds_read_b64_tr_b16 v[34:35], v2 offset:25088
v_mfma_f32_32x32x16_bf16 v[80:95], v[36:39], v[176:179], v[80:95]
ds_read_b64_tr_b16 v[36:37], v3 offset:24576
ds_read_b64_tr_b16 v[38:39], v3 offset:25088
v_mfma_f32_32x32x16_bf16 v[96:111], v[40:43], v[176:179], v[96:111]
ds_read_b64_tr_b16 v[40:41], v4 offset:24576
ds_read_b64_tr_b16 v[42:43], v4 offset:25088
v_mfma_f32_32x32x16_bf16 v[112:127], v[44:47], v[176:179], v[112:127]
ds_read_b64_tr_b16 v[44:45], v5 offset:24576
ds_read_b64_tr_b16 v[46:47], v5 offset:25088
s_waitcnt lgkmcnt(8)
v_mfma_f32_32x32x16_bf16 v[64:79], v[48:51], v[180:183], v[64:79]
ds_read_b64_tr_b16 v[48:49], v2 offset:28672
ds_read_b64_tr_b16 v[50:51], v2 offset:29184
v_mfma_f32_32x32x16_bf16 v[80:95], v[52:55], v[180:183], v[80:95]
ds_read_b64_tr_b16 v[52:53], v3 offset:28672
ds_read_b64_tr_b16 v[54:55], v3 offset:29184
v_mfma_f32_32x32x16_bf16 v[96:111], v[56:59], v[180:183], v[96:111]
ds_read_b64_tr_b16 v[56:57], v4 offset:28672
ds_read_b64_tr_b16 v[58:59], v4 offset:29184
v_mfma_f32_32x32x16_bf16 v[112:127], v[60:63], v[180:183], v[112:127]
ds_read_b64_tr_b16 v[60:61], v5 offset:28672
ds_read_b64_tr_b16 v[62:63], v5 offset:29184
s_waitcnt lgkmcnt(8)
v_mfma_f32_32x32x16_bf16 v[64:79], v[32:35], v[184:187], v[64:79]
s_barrier
v_xor_b32 v2, 0x10000, v14
v_xor_b32 v3, 0x10020, v14
v_xor_b32 v4, 0x10040, v14
v_xor_b32 v5, 0x10060, v14
ds_read_b64_tr_b16 v[32:33], v2 offset:0
ds_read_b64_tr_b16 v[34:35], v2 offset:512
v_fma_f32 v10, -v10, v10, v11
v_max_f32 v10, 0, v10
v_mfma_f32_32x32x16_bf16 v[80:95], v[36:39], v[184:187], v[80:95]
ds_read_b64_tr_b16 v[36:37], v3 offset:0
ds_read_b64_tr_b16 v[38:39], v3 offset:512
v_cvt_pk_bf16_f32 v10, v10, v10
v_lshlrev_b32 v10, 16, v10
v_mfma_f32_32x32x16_bf16 v[96:111], v[40:43], v[184:187], v[96:111]
ds_read_b64_tr_b16 v[40:41], v4 offset:0
ds_read_b64_tr_b16 v[42:43], v4 offset:512
v_add_f32 v10, 0x3727c5ac, v10
v_cvt_pk_bf16_f32 v10, v10, v10
v_mfma_f32_32x32x16_bf16 v[112:127], v[44:47], v[184:187], v[112:127]
ds_read_b64_tr_b16 v[44:45], v5 offset:0
ds_read_b64_tr_b16 v[46:47], v5 offset:512
v_lshlrev_b32 v10, 16, v10
v_sqrt_f32 v10, v10
s_waitcnt lgkmcnt(8)
v_mfma_f32_32x32x16_bf16 v[64:79], v[48:51], v[188:191], v[64:79]
ds_read_b64_tr_b16 v[48:49], v2 offset:4096
ds_read_b64_tr_b16 v[50:51], v2 offset:4608
v_cvt_pk_bf16_f32 v10, v10, v10
v_lshlrev_b32 v10, 16, v10
v_mfma_f32_32x32x16_bf16 v[80:95], v[52:55], v[188:191], v[80:95]
ds_read_b64_tr_b16 v[52:53], v3 offset:4096
ds_read_b64_tr_b16 v[54:55], v3 offset:4608
v_rcp_f32 v11, v10
v_mul_f32 v15, v10, v10
v_mfma_f32_32x32x16_bf16 v[96:111], v[56:59], v[188:191], v[96:111]
ds_read_b64_tr_b16 v[56:57], v4 offset:4096
ds_read_b64_tr_b16 v[58:59], v4 offset:4608
v_mul_f32 v13, 0xbfb8aa3b, v11
v_mul_f32 v0, 0x3fb8aa3b, v11
v_mfma_f32_32x32x16_bf16 v[112:127], v[60:63], v[188:191], v[112:127]
ds_read_b64_tr_b16 v[60:61], v5 offset:4096
ds_read_b64_tr_b16 v[62:63], v5 offset:4608
v_lshlrev_b32 v9, 4, v1
v_lshrrev_b32 v12, 3, v1
s_waitcnt lgkmcnt(8)
v_mfma_f32_32x32x16_bf16 v[64:79], v[32:35], v[192:195], v[64:79]
ds_read_b64_tr_b16 v[32:33], v2 offset:8192
ds_read_b64_tr_b16 v[34:35], v2 offset:8704
v_lshlrev_b32 v12, 18, v12
v_add_u32 v12, v12, v1
v_mfma_f32_32x32x16_bf16 v[80:95], v[36:39], v[192:195], v[80:95]
ds_read_b64_tr_b16 v[36:37], v3 offset:8192
ds_read_b64_tr_b16 v[38:39], v3 offset:8704
v_lshlrev_b32 v12, 8, v12
s_lshl_b32 s55, s5, 2
v_mfma_f32_32x32x16_bf16 v[96:111], v[40:43], v[192:195], v[96:111]
ds_read_b64_tr_b16 v[40:41], v4 offset:8192
ds_read_b64_tr_b16 v[42:43], v4 offset:8704
s_add_u32 s55, s55, s4
s_mul_i32 s55, s55, 147456
v_mfma_f32_32x32x16_bf16 v[112:127], v[44:47], v[192:195], v[112:127]
ds_read_b64_tr_b16 v[44:45], v5 offset:8192
ds_read_b64_tr_b16 v[46:47], v5 offset:8704
s_lshl_b32 s57, s6, 13
s_add_u32 s57, s57, s55
s_waitcnt lgkmcnt(8)
v_mfma_f32_32x32x16_bf16 v[64:79], v[48:51], v[196:199], v[64:79]
ds_read_b64_tr_b16 v[48:49], v2 offset:12288
ds_read_b64_tr_b16 v[50:51], v2 offset:12800
s_lshl_b32 s56, s5, 1
s_lshr_b32 s44, s4, 1
v_mfma_f32_32x32x16_bf16 v[80:95], v[52:55], v[196:199], v[80:95]
ds_read_b64_tr_b16 v[52:53], v3 offset:12288
ds_read_b64_tr_b16 v[54:55], v3 offset:12800
s_add_u32 s56, s56, s44
s_lshl_b32 s56, s56, 6
v_mfma_f32_32x32x16_bf16 v[96:111], v[56:59], v[196:199], v[96:111]
ds_read_b64_tr_b16 v[56:57], v4 offset:12288
ds_read_b64_tr_b16 v[58:59], v4 offset:12800
s_add_u32 s56, s56, s6
s_lshl_b32 s56, s56, 3
v_mfma_f32_32x32x16_bf16 v[112:127], v[60:63], v[196:199], v[112:127]
ds_read_b64_tr_b16 v[60:61], v5 offset:12288
ds_read_b64_tr_b16 v[62:63], v5 offset:12800
s_and_b32 s44, s4, 1
s_add_u32 s56, s56, s44
s_waitcnt lgkmcnt(8)
v_mfma_f32_32x32x16_bf16 v[64:79], v[32:35], v[200:203], v[64:79]
s_barrier
ds_read_b64_tr_b16 v[32:33], v2 offset:16384
ds_read_b64_tr_b16 v[34:35], v2 offset:16896
s_lshl_b32 s56, s56, 2
s_add_u32 s56, s56, 10092568
v_mfma_f32_32x32x16_bf16 v[80:95], v[36:39], v[200:203], v[80:95]
ds_read_b64_tr_b16 v[36:37], v3 offset:16384
ds_read_b64_tr_b16 v[38:39], v3 offset:16896
s_and_b32 s37, s2, 7
s_lshr_b32 s38, s2, 3
v_mfma_f32_32x32x16_bf16 v[96:111], v[40:43], v[200:203], v[96:111]
ds_read_b64_tr_b16 v[40:41], v4 offset:16384
ds_read_b64_tr_b16 v[42:43], v4 offset:16896
s_lshl_b32 s48, s5, 1
s_bfe_u32 s39, s37, 0x10001
v_mfma_f32_32x32x16_bf16 v[112:127], v[44:47], v[200:203], v[112:127]
ds_read_b64_tr_b16 v[44:45], v5 offset:16384
ds_read_b64_tr_b16 v[46:47], v5 offset:16896
s_add_u32 s48, s48, s39
s_lshr_b32 s39, s38, 2
s_waitcnt lgkmcnt(8)
v_mfma_f32_32x32x16_bf16 v[64:79], v[48:51], v[204:207], v[64:79]
ds_read_b64_tr_b16 v[48:49], v2 offset:20480
ds_read_b64_tr_b16 v[50:51], v2 offset:20992
s_and_b32 s49, s37, 1
s_lshl_b32 s49, s49, 2
v_mfma_f32_32x32x16_bf16 v[80:95], v[52:55], v[204:207], v[80:95]
ds_read_b64_tr_b16 v[52:53], v3 offset:20480
ds_read_b64_tr_b16 v[54:55], v3 offset:20992
s_and_b32 s38, s38, 3
s_add_u32 s49, s49, s38
v_mfma_f32_32x32x16_bf16 v[96:111], v[56:59], v[204:207], v[96:111]
ds_read_b64_tr_b16 v[56:57], v4 offset:20480
ds_read_b64_tr_b16 v[58:59], v4 offset:20992
s_add_u32 s39, s4, s39
s_and_b32 s39, s39, 3
v_mfma_f32_32x32x16_bf16 v[112:127], v[60:63], v[204:207], v[112:127]
ds_read_b64_tr_b16 v[60:61], v5 offset:20480
ds_read_b64_tr_b16 v[62:63], v5 offset:20992
v_and_b32 v16, 7, v1
v_bfe_u32 v17, v1, 4, 1
s_waitcnt lgkmcnt(8)
v_mfma_f32_32x32x16_bf16 v[64:79], v[32:35], v[208:211], v[64:79]
ds_read_b64_tr_b16 v[32:33], v2 offset:24576
ds_read_b64_tr_b16 v[34:35], v2 offset:25088
v_lshlrev_b32 v17, 2, v17
v_xor_b32 v16, v16, v17
v_mfma_f32_32x32x16_bf16 v[80:95], v[36:39], v[208:211], v[80:95]
ds_read_b64_tr_b16 v[36:37], v3 offset:24576
ds_read_b64_tr_b16 v[38:39], v3 offset:25088
v_lshrrev_b32 v17, 3, v1
v_lshlrev_b32 v17, 10, v17
v_mfma_f32_32x32x16_bf16 v[96:111], v[40:43], v[208:211], v[96:111]
ds_read_b64_tr_b16 v[40:41], v4 offset:24576
ds_read_b64_tr_b16 v[42:43], v4 offset:25088
v_lshl_add_u32 v16, v16, 4, v17
s_lshl_b32 s37, s49, 7
v_mfma_f32_32x32x16_bf16 v[112:127], v[44:47], v[208:211], v[112:127]
ds_read_b64_tr_b16 v[44:45], v5 offset:24576
ds_read_b64_tr_b16 v[46:47], v5 offset:25088
v_add_u32 v8, s37, v16
v_lshlrev_b32 v9, 4, v1
s_waitcnt lgkmcnt(8)
v_mfma_f32_32x32x16_bf16 v[64:79], v[48:51], v[212:215], v[64:79]
ds_read_b64_tr_b16 v[48:49], v2 offset:28672
ds_read_b64_tr_b16 v[50:51], v2 offset:29184
s_lshl_b32 s52, s4, 14
s_add_u32 s52, s52, 65536
v_mfma_f32_32x32x16_bf16 v[80:95], v[52:55], v[212:215], v[80:95]
ds_read_b64_tr_b16 v[52:53], v3 offset:28672
ds_read_b64_tr_b16 v[54:55], v3 offset:29184
s_cmp_eq_u32 s4, 0
s_cselect_b32 s52, 147456, s52
v_mfma_f32_32x32x16_bf16 v[96:111], v[56:59], v[212:215], v[96:111]
ds_read_b64_tr_b16 v[56:57], v4 offset:28672
ds_read_b64_tr_b16 v[58:59], v4 offset:29184
v_bfe_u32 v16, v1, 4, 1
v_bfe_u32 v17, v1, 3, 1
v_mfma_f32_32x32x16_bf16 v[112:127], v[60:63], v[212:215], v[112:127]
ds_read_b64_tr_b16 v[60:61], v5 offset:28672
ds_read_b64_tr_b16 v[62:63], v5 offset:29184
v_lshl_add_u32 v16, v17, 1, v16
v_lshlrev_b32 v16, 5, v16
s_waitcnt lgkmcnt(8)
v_mfma_f32_32x32x16_bf16 v[64:79], v[32:35], v[216:219], v[64:79]
s_barrier
ds_read_b64_tr_b16 v[32:33], v2 offset:32768
ds_read_b64_tr_b16 v[34:35], v2 offset:33280
v_and_b32 v17, 3, v1
v_lshl_add_u32 v16, v17, 3, v16
v_mfma_f32_32x32x16_bf16 v[80:95], v[36:39], v[216:219], v[80:95]
ds_read_b64_tr_b16 v[36:37], v3 offset:32768
ds_read_b64_tr_b16 v[38:39], v3 offset:33280
v_bfe_u32 v17, v1, 2, 2
v_lshl_add_u32 v16, v17, 7, v16
v_mfma_f32_32x32x16_bf16 v[96:111], v[40:43], v[216:219], v[96:111]
ds_read_b64_tr_b16 v[40:41], v4 offset:32768
ds_read_b64_tr_b16 v[42:43], v4 offset:33280
v_lshrrev_b32 v17, 5, v1
v_lshl_add_u32 v16, v17, 9, v16
v_mfma_f32_32x32x16_bf16 v[112:127], v[44:47], v[216:219], v[112:127]
ds_read_b64_tr_b16 v[44:45], v5 offset:32768
ds_read_b64_tr_b16 v[46:47], v5 offset:33280
v_add_u32 v10, s52, v16
s_mul_i32 s37, s48, 294912
s_waitcnt lgkmcnt(8)
v_mfma_f32_32x32x16_bf16 v[64:79], v[48:51], v[220:223], v[64:79]
ds_read_b64_tr_b16 v[48:49], v2 offset:36864
ds_read_b64_tr_b16 v[50:51], v2 offset:37376
s_lshl_b32 s0, s39, 14
s_lshl_b32 s54, s0, 4
v_mfma_f32_32x32x16_bf16 v[80:95], v[52:55], v[220:223], v[80:95]
ds_read_b64_tr_b16 v[52:53], v3 offset:36864
ds_read_b64_tr_b16 v[54:55], v3 offset:37376
s_add_u32 s0, s0, s37
s_lshl_b32 s1, s39, 13
v_mfma_f32_32x32x16_bf16 v[96:111], v[56:59], v[220:223], v[96:111]
ds_read_b64_tr_b16 v[56:57], v4 offset:36864
ds_read_b64_tr_b16 v[58:59], v4 offset:37376
s_lshl_b32 s60, s1, 4
s_add_u32 s1, s1, s37
v_mfma_f32_32x32x16_bf16 v[112:127], v[60:63], v[220:223], v[112:127]
ds_read_b64_tr_b16 v[60:61], v5 offset:36864
ds_read_b64_tr_b16 v[62:63], v5 offset:37376
s_lshl_b32 s46, s39, 12
s_lshl_b32 s61, s46, 4
s_waitcnt lgkmcnt(8)
v_mfma_f32_32x32x16_bf16 v[64:79], v[32:35], v[224:227], v[64:79]
ds_read_b64_tr_b16 v[32:33], v2 offset:40960
ds_read_b64_tr_b16 v[34:35], v2 offset:41472
s_add_u32 s46, s46, s37
s_lshl_b32 s50, s48, 3
v_mfma_f32_32x32x16_bf16 v[80:95], v[36:39], v[224:227], v[80:95]
ds_read_b64_tr_b16 v[36:37], v3 offset:40960
ds_read_b64_tr_b16 v[38:39], v3 offset:41472
s_add_u32 s50, s50, s49
s_lshl_b32 s50, s50, 2
v_mfma_f32_32x32x16_bf16 v[96:111], v[40:43], v[224:227], v[96:111]
ds_read_b64_tr_b16 v[40:41], v4 offset:40960
ds_read_b64_tr_b16 v[42:43], v4 offset:41472
s_add_u32 s50, s50, s39
s_lshl_b32 s50, s50, 6
v_mfma_f32_32x32x16_bf16 v[112:127], v[44:47], v[224:227], v[112:127]
ds_read_b64_tr_b16 v[44:45], v5 offset:40960
ds_read_b64_tr_b16 v[46:47], v5 offset:41472
s_add_u32 s50, s50, 10092544
s_add_u32 s50, s20, s50
s_addc_u32 s51, s21, 0
s_waitcnt lgkmcnt(8)
v_mfma_f32_32x32x16_bf16 v[64:79], v[48:51], v[228:231], v[64:79]
ds_read_b64_tr_b16 v[48:49], v2 offset:45056
ds_read_b64_tr_b16 v[50:51], v2 offset:45568
s_lshl_b32 s14, s6, 4
s_add_u32 s14, s14, s5
v_mfma_f32_32x32x16_bf16 v[80:95], v[52:55], v[228:231], v[80:95]
ds_read_b64_tr_b16 v[52:53], v3 offset:45056
ds_read_b64_tr_b16 v[54:55], v3 offset:45568
s_lshl_b32 s14, s14, 7
s_add_u32 s14, s14, 10027008
v_mfma_f32_32x32x16_bf16 v[96:111], v[56:59], v[228:231], v[96:111]
ds_read_b64_tr_b16 v[56:57], v4 offset:45056
ds_read_b64_tr_b16 v[58:59], v4 offset:45568
s_add_u32 s14, s20, s14
s_addc_u32 s15, s21, 0
v_mfma_f32_32x32x16_bf16 v[112:127], v[60:63], v[228:231], v[112:127]
ds_read_b64_tr_b16 v[60:61], v5 offset:45056
ds_read_b64_tr_b16 v[62:63], v5 offset:45568
s_lshr_b32 s16, s4, 1
s_and_b32 s17, s4, 1
s_waitcnt lgkmcnt(8)
v_mfma_f32_32x32x16_bf16 v[64:79], v[32:35], v[232:235], v[64:79]
s_barrier
ds_read_b64_tr_b16 v[32:33], v2 offset:49152
ds_read_b64_tr_b16 v[34:35], v2 offset:49664
s_lshl_b32 s18, s6, 1
s_add_u32 s18, s18, s16
v_mfma_f32_32x32x16_bf16 v[80:95], v[36:39], v[232:235], v[80:95]
ds_read_b64_tr_b16 v[36:37], v2 offset:53248
ds_read_b64_tr_b16 v[38:39], v2 offset:53760
s_lshl_b32 s19, s18, 15
s_lshl_b32 s12, s17, 10
v_mfma_f32_32x32x16_bf16 v[96:111], v[40:43], v[232:235], v[96:111]
ds_read_b64_tr_b16 v[40:41], v2 offset:57344
ds_read_b64_tr_b16 v[42:43], v2 offset:57856
s_add_u32 s19, s19, s12
s_add_u32 s19, s19, 9437184
v_mfma_f32_32x32x16_bf16 v[112:127], v[44:47], v[232:235], v[112:127]
ds_read_b64_tr_b16 v[44:45], v2 offset:61440
ds_read_b64_tr_b16 v[46:47], v2 offset:61952
s_lshl_b32 s18, s18, 11
s_lshl_b32 s17, s17, 4
s_waitcnt lgkmcnt(8)
v_mfma_f32_32x32x16_bf16 v[64:79], v[48:51], v[236:239], v[64:79]
ds_read_b64_tr_b16 v[48:49], v3 offset:49152
ds_read_b64_tr_b16 v[50:51], v3 offset:49664
s_add_u32 s18, s18, s17
s_add_u32 s18, s18, 9961472
v_mfma_f32_32x32x16_bf16 v[80:95], v[52:55], v[236:239], v[80:95]
ds_read_b64_tr_b16 v[52:53], v3 offset:53248
ds_read_b64_tr_b16 v[54:55], v3 offset:53760
s_lshl_b32 s16, s16, 12
s_add_u32 s16, s16, s12
v_mfma_f32_32x32x16_bf16 v[96:111], v[56:59], v[236:239], v[96:111]
ds_read_b64_tr_b16 v[56:57], v3 offset:57344
ds_read_b64_tr_b16 v[58:59], v3 offset:57856
s_add_u32 s16, s16, 131072
s_lshl_b32 s17, s4, 8
v_mfma_f32_32x32x16_bf16 v[112:127], v[60:63], v[236:239], v[112:127]
ds_read_b64_tr_b16 v[60:61], v3 offset:61440
ds_read_b64_tr_b16 v[62:63], v3 offset:61952
s_add_u32 s17, s17, 141312
s_waitcnt lgkmcnt(8)
v_mfma_f32_32x32x16_bf16 v[64:79], v[32:35], v[240:243], v[64:79]
ds_read_b64_tr_b16 v[32:33], v4 offset:49152
ds_read_b64_tr_b16 v[34:35], v4 offset:49664
v_mfma_f32_32x32x16_bf16 v[64:79], v[36:39], v[244:247], v[64:79]
ds_read_b64_tr_b16 v[36:37], v4 offset:53248
ds_read_b64_tr_b16 v[38:39], v4 offset:53760
v_mfma_f32_32x32x16_bf16 v[64:79], v[40:43], v[248:251], v[64:79]
ds_read_b64_tr_b16 v[40:41], v4 offset:57344
ds_read_b64_tr_b16 v[42:43], v4 offset:57856
v_mfma_f32_32x32x16_bf16 v[64:79], v[44:47], v[252:255], v[64:79]
ds_read_b64_tr_b16 v[44:45], v4 offset:61440
ds_read_b64_tr_b16 v[46:47], v4 offset:61952
s_waitcnt lgkmcnt(8)
v_mfma_f32_32x32x16_bf16 v[80:95], v[48:51], v[240:243], v[80:95]
ds_read_b64_tr_b16 v[48:49], v5 offset:49152
ds_read_b64_tr_b16 v[50:51], v5 offset:49664
v_mfma_f32_32x32x16_bf16 v[80:95], v[52:55], v[244:247], v[80:95]
ds_read_b64_tr_b16 v[52:53], v5 offset:53248
ds_read_b64_tr_b16 v[54:55], v5 offset:53760
s_lshl_b32 s44, s4, 12
s_add_u32 m0, s44, 16384
v_mfma_f32_32x32x16_bf16 v[80:95], v[56:59], v[248:251], v[80:95]
ds_read_b64_tr_b16 v[56:57], v5 offset:57344
ds_read_b64_tr_b16 v[58:59], v5 offset:57856
v_cvt_pk_bf16_f32 v16, v64, v65
v_cvt_pk_bf16_f32 v17, v66, v67
v_mfma_f32_32x32x16_bf16 v[80:95], v[60:63], v[252:255], v[80:95]
ds_write_addtid_b32 v16 offset:49152
ds_read_b64_tr_b16 v[60:61], v5 offset:61440
ds_read_b64_tr_b16 v[62:63], v5 offset:61952
v_cvt_pk_bf16_f32 v18, v68, v69
v_cvt_pk_bf16_f32 v19, v70, v71
s_waitcnt lgkmcnt(9)
v_mfma_f32_32x32x16_bf16 v[96:111], v[32:35], v[240:243], v[96:111]
ds_write_addtid_b32 v17 offset:49408
s_barrier
v_xor_b32 v2, 0x20000, v6
v_xor_b32 v3, 0x20040, v6
ds_read_b64_tr_b16 v[32:33], v2 offset:0
ds_read_b64_tr_b16 v[34:35], v2 offset:512
v_cvt_pk_bf16_f32 v20, v72, v73
v_cvt_pk_bf16_f32 v21, v74, v75
v_mfma_f32_32x32x16_bf16 v[96:111], v[36:39], v[244:247], v[96:111]
ds_write_addtid_b32 v18 offset:49664
ds_read_b64_tr_b16 v[36:37], v2 offset:2048
ds_read_b64_tr_b16 v[38:39], v2 offset:2560
v_cvt_pk_bf16_f32 v22, v76, v77
v_cvt_pk_bf16_f32 v23, v78, v79
v_mfma_f32_32x32x16_bf16 v[96:111], v[40:43], v[248:251], v[96:111]
ds_write_addtid_b32 v19 offset:49920
ds_read_b64_tr_b16 v[40:41], v2 offset:4096
ds_read_b64_tr_b16 v[42:43], v2 offset:4608
v_cvt_pk_bf16_f32 v24, v80, v81
v_cvt_pk_bf16_f32 v25, v82, v83
v_mfma_f32_32x32x16_bf16 v[96:111], v[44:47], v[252:255], v[96:111]
ds_write_addtid_b32 v20 offset:50176
ds_read_b64_tr_b16 v[44:45], v2 offset:6144
ds_read_b64_tr_b16 v[46:47], v2 offset:6656
v_cvt_pk_bf16_f32 v26, v84, v85
v_cvt_pk_bf16_f32 v27, v86, v87
s_waitcnt lgkmcnt(12)
v_mfma_f32_32x32x16_bf16 v[112:127], v[48:51], v[240:243], v[112:127]
ds_write_addtid_b32 v21 offset:50432
ds_read_b64_tr_b16 v[48:49], v3 offset:0
ds_read_b64_tr_b16 v[50:51], v3 offset:512
v_cvt_pk_bf16_f32 v28, v88, v89
v_cvt_pk_bf16_f32 v29, v90, v91
v_mfma_f32_32x32x16_bf16 v[112:127], v[52:55], v[244:247], v[112:127]
ds_write_addtid_b32 v22 offset:50688
ds_read_b64_tr_b16 v[52:53], v3 offset:2048
ds_read_b64_tr_b16 v[54:55], v3 offset:2560
v_cvt_pk_bf16_f32 v30, v92, v93
v_cvt_pk_bf16_f32 v31, v94, v95
v_mfma_f32_32x32x16_bf16 v[112:127], v[56:59], v[248:251], v[112:127]
ds_write_addtid_b32 v23 offset:50944
ds_read_b64_tr_b16 v[56:57], v3 offset:4096
ds_read_b64_tr_b16 v[58:59], v3 offset:4608
v_mfma_f32_32x32x16_bf16 v[112:127], v[60:63], v[252:255], v[112:127]
ds_write_addtid_b32 v24 offset:51200
ds_read_b64_tr_b16 v[60:61], v3 offset:6144
ds_read_b64_tr_b16 v[62:63], v3 offset:6656
s_waitcnt lgkmcnt(12)
v_mfma_f32_32x32x16_bf16 v[64:79], v[32:35], v[128:131], 0
ds_write_addtid_b32 v25 offset:51456
ds_read_b64_tr_b16 v[32:33], v2 offset:8192
ds_read_b64_tr_b16 v[34:35], v2 offset:8704
v_mfma_f32_32x32x16_bf16 v[64:79], v[36:39], v[132:135], v[64:79]
ds_write_addtid_b32 v26 offset:51712
ds_read_b64_tr_b16 v[36:37], v3 offset:8192
ds_read_b64_tr_b16 v[38:39], v3 offset:8704
v_mfma_f32_32x32x16_bf16 v[64:79], v[40:43], v[136:139], v[64:79]
ds_write_addtid_b32 v27 offset:51968
ds_read_b64_tr_b16 v[40:41], v2 offset:10240
ds_read_b64_tr_b16 v[42:43], v2 offset:10752
v_mfma_f32_32x32x16_bf16 v[64:79], v[44:47], v[140:143], v[64:79]
ds_write_addtid_b32 v28 offset:52224
ds_read_b64_tr_b16 v[44:45], v3 offset:10240
ds_read_b64_tr_b16 v[46:47], v3 offset:10752
s_waitcnt lgkmcnt(12)
v_mfma_f32_32x32x16_bf16 v[80:95], v[48:51], v[128:131], 0
ds_write_addtid_b32 v29 offset:52480
ds_read_b64_tr_b16 v[48:49], v2 offset:12288
ds_read_b64_tr_b16 v[50:51], v2 offset:12800
v_mfma_f32_32x32x16_bf16 v[80:95], v[52:55], v[132:135], v[80:95]
ds_write_addtid_b32 v30 offset:52736
ds_read_b64_tr_b16 v[52:53], v3 offset:12288
ds_read_b64_tr_b16 v[54:55], v3 offset:12800
v_mfma_f32_32x32x16_bf16 v[80:95], v[56:59], v[136:139], v[80:95]
ds_write_addtid_b32 v31 offset:52992
ds_read_b64_tr_b16 v[56:57], v2 offset:14336
ds_read_b64_tr_b16 v[58:59], v2 offset:14848
v_mfma_f32_32x32x16_bf16 v[80:95], v[60:63], v[140:143], v[80:95]
ds_read_b64_tr_b16 v[60:61], v3 offset:14336
ds_read_b64_tr_b16 v[62:63], v3 offset:14848
s_lshl_b32 s47, s4, 14
v_mul_f32 v16, v13, v96
v_mul_f32 v17, v13, v97
v_mul_f32 v18, v13, v98
s_waitcnt lgkmcnt(11)
v_mfma_f32_32x32x16_bf16 v[64:79], v[32:35], v[144:147], v[64:79]
s_waitcnt lgkmcnt(4)
s_barrier
ds_read_b64_tr_b16 v[32:33], v2 offset:16384
ds_read_b64_tr_b16 v[34:35], v2 offset:16896
v_mul_f32 v19, v13, v99
v_exp_f32 v16, v16
v_mfma_f32_32x32x16_bf16 v[80:95], v[36:39], v[144:147], v[80:95]
ds_read_b64_tr_b16 v[36:37], v3 offset:16384
ds_read_b64_tr_b16 v[38:39], v3 offset:16896
s_add_u32 s62, s54, 0
s_add_u32 m0, s47, 0
s_add_u32 s63, s62, 7168
v_mfma_f32_32x32x16_bf16 v[64:79], v[40:43], v[148:151], v[64:79]
ds_read_b64_tr_b16 v[40:41], v2 offset:18432
ds_read_b64_tr_b16 v[42:43], v2 offset:18944
buffer_load_dwordx4 v8, s[64:67], s62 offen lds
v_exp_f32 v17, v17
v_mfma_f32_32x32x16_bf16 v[80:95], v[44:47], v[148:151], v[80:95]
ds_read_b64_tr_b16 v[44:45], v3 offset:18432
ds_read_b64_tr_b16 v[46:47], v3 offset:18944
buffer_load_dwordx4 v8, s[64:67], s63 offen offset:1024 lds
v_exp_f32 v18, v18
s_waitcnt lgkmcnt(8)
v_mfma_f32_32x32x16_bf16 v[64:79], v[48:51], v[152:155], v[64:79]
ds_read_b64_tr_b16 v[48:49], v2 offset:20480
ds_read_b64_tr_b16 v[50:51], v2 offset:20992
s_add_u32 s62, s54, 16384
s_add_u32 m0, s47, 2048
s_add_u32 s63, s62, 7168
v_mfma_f32_32x32x16_bf16 v[80:95], v[52:55], v[152:155], v[80:95]
ds_read_b64_tr_b16 v[52:53], v3 offset:20480
ds_read_b64_tr_b16 v[54:55], v3 offset:20992
buffer_load_dwordx4 v8, s[64:67], s62 offen lds
v_exp_f32 v19, v19
v_mul_f32 v96, v96, v104
v_mfma_f32_32x32x16_bf16 v[64:79], v[56:59], v[156:159], v[64:79]
ds_read_b64_tr_b16 v[56:57], v2 offset:22528
ds_read_b64_tr_b16 v[58:59], v2 offset:23040
buffer_load_dwordx4 v8, s[64:67], s63 offen offset:1024 lds
v_mul_f32 v97, v97, v105
v_mul_f32 v98, v98, v106
v_mul_f32 v99, v99, v107
v_mfma_f32_32x32x16_bf16 v[80:95], v[60:63], v[156:159], v[80:95]
ds_read_b64_tr_b16 v[60:61], v3 offset:22528
ds_read_b64_tr_b16 v[62:63], v3 offset:23040
s_add_u32 s62, s54, 32768
s_add_u32 m0, s47, 4096
s_add_u32 s63, s62, 7168
s_waitcnt lgkmcnt(8)
v_mfma_f32_32x32x16_bf16 v[64:79], v[32:35], v[160:163], v[64:79]
ds_read_b64_tr_b16 v[32:33], v2 offset:24576
ds_read_b64_tr_b16 v[34:35], v2 offset:25088
buffer_load_dwordx4 v8, s[64:67], s62 offen lds
v_fma_f32 v16, v16, v15, v15
v_fma_f32 v17, v17, v15, v15
v_fma_f32 v18, v18, v15, v15
v_mfma_f32_32x32x16_bf16 v[80:95], v[36:39], v[160:163], v[80:95]
ds_read_b64_tr_b16 v[36:37], v3 offset:24576
ds_read_b64_tr_b16 v[38:39], v3 offset:25088
buffer_load_dwordx4 v8, s[64:67], s63 offen offset:1024 lds
v_fma_f32 v19, v19, v15, v15
v_rcp_f32 v16, v16
v_mfma_f32_32x32x16_bf16 v[64:79], v[40:43], v[164:167], v[64:79]
ds_read_b64_tr_b16 v[40:41], v2 offset:26624
ds_read_b64_tr_b16 v[42:43], v2 offset:27136
s_add_u32 s62, s54, 49152
s_add_u32 m0, s47, 6144
s_add_u32 s63, s62, 7168
v_mfma_f32_32x32x16_bf16 v[80:95], v[44:47], v[164:167], v[80:95]
ds_read_b64_tr_b16 v[44:45], v3 offset:26624
ds_read_b64_tr_b16 v[46:47], v3 offset:27136
buffer_load_dwordx4 v8, s[64:67], s62 offen lds
v_rcp_f32 v17, v17
s_waitcnt lgkmcnt(8)
v_mfma_f32_32x32x16_bf16 v[64:79], v[48:51], v[168:171], v[64:79]
ds_read_b64_tr_b16 v[48:49], v2 offset:28672
ds_read_b64_tr_b16 v[50:51], v2 offset:29184
buffer_load_dwordx4 v8, s[64:67], s63 offen offset:1024 lds
v_rcp_f32 v18, v18
v_mfma_f32_32x32x16_bf16 v[80:95], v[52:55], v[168:171], v[80:95]
ds_read_b64_tr_b16 v[52:53], v3 offset:28672
ds_read_b64_tr_b16 v[54:55], v3 offset:29184
s_add_u32 s62, s54, 131072
s_add_u32 m0, s47, 8192
s_add_u32 s63, s62, 7168
v_mfma_f32_32x32x16_bf16 v[64:79], v[56:59], v[172:175], v[64:79]
ds_read_b64_tr_b16 v[56:57], v2 offset:30720
ds_read_b64_tr_b16 v[58:59], v2 offset:31232
buffer_load_dwordx4 v8, s[64:67], s62 offen lds
v_rcp_f32 v19, v19
v_mul_f32 v96, v96, v16
v_mfma_f32_32x32x16_bf16 v[80:95], v[60:63], v[172:175], v[80:95]
ds_read_b64_tr_b16 v[60:61], v3 offset:30720
ds_read_b64_tr_b16 v[62:63], v3 offset:31232
buffer_load_dwordx4 v8, s[64:67], s63 offen offset:1024 lds
v_mul_f32 v97, v97, v17
v_mul_f32 v98, v98, v18
s_waitcnt lgkmcnt(8)
v_mfma_f32_32x32x16_bf16 v[64:79], v[32:35], v[176:179], v[64:79]
s_barrier
v_xor_b32 v2, 0x10000, v6
v_xor_b32 v3, 0x10040, v6
ds_read_b64_tr_b16 v[32:33], v2 offset:16384
ds_read_b64_tr_b16 v[34:35], v2 offset:16896
s_add_u32 s62, s54, 147456
s_add_u32 m0, s47, 10240
s_add_u32 s63, s62, 7168
v_mfma_f32_32x32x16_bf16 v[80:95], v[36:39], v[176:179], v[80:95]
ds_read_b64_tr_b16 v[36:37], v3 offset:16384
ds_read_b64_tr_b16 v[38:39], v3 offset:16896
buffer_load_dwordx4 v8, s[64:67], s62 offen lds
v_mul_f32 v99, v99, v19
v_cvt_pk_bf16_f32 v20, v96, v97
v_cvt_pk_bf16_f32 v21, v98, v99
v_mfma_f32_32x32x16_bf16 v[64:79], v[40:43], v[180:183], v[64:79]
ds_read_b64_tr_b16 v[40:41], v2 offset:18432
ds_read_b64_tr_b16 v[42:43], v2 offset:18944
buffer_load_dwordx4 v8, s[64:67], s63 offen offset:1024 lds
v_mul_f32 v16, v13, v100
v_mul_f32 v17, v13, v101
v_mul_f32 v18, v13, v102
v_mfma_f32_32x32x16_bf16 v[80:95], v[44:47], v[180:183], v[80:95]
ds_read_b64_tr_b16 v[44:45], v3 offset:18432
ds_read_b64_tr_b16 v[46:47], v3 offset:18944
s_add_u32 s62, s54, 163840
s_add_u32 m0, s47, 12288
s_add_u32 s63, s62, 7168
s_waitcnt lgkmcnt(8)
v_mfma_f32_32x32x16_bf16 v[64:79], v[48:51], v[184:187], v[64:79]
ds_read_b64_tr_b16 v[48:49], v2 offset:20480
ds_read_b64_tr_b16 v[50:51], v2 offset:20992
buffer_load_dwordx4 v8, s[64:67], s62 offen lds
v_mul_f32 v19, v13, v103
v_exp_f32 v16, v16
v_mfma_f32_32x32x16_bf16 v[80:95], v[52:55], v[184:187], v[80:95]
ds_read_b64_tr_b16 v[52:53], v3 offset:20480
ds_read_b64_tr_b16 v[54:55], v3 offset:20992
buffer_load_dwordx4 v8, s[64:67], s63 offen offset:1024 lds
v_exp_f32 v17, v17
v_mfma_f32_32x32x16_bf16 v[64:79], v[56:59], v[188:191], v[64:79]
ds_read_b64_tr_b16 v[56:57], v2 offset:22528
ds_read_b64_tr_b16 v[58:59], v2 offset:23040
s_add_u32 s62, s54, 180224
s_add_u32 m0, s47, 14336
s_add_u32 s63, s62, 7168
v_mfma_f32_32x32x16_bf16 v[80:95], v[60:63], v[188:191], v[80:95]
ds_read_b64_tr_b16 v[60:61], v3 offset:22528
ds_read_b64_tr_b16 v[62:63], v3 offset:23040
buffer_load_dwordx4 v8, s[64:67], s62 offen lds
v_exp_f32 v18, v18
s_waitcnt lgkmcnt(8)
v_mfma_f32_32x32x16_bf16 v[64:79], v[32:35], v[192:195], v[64:79]
ds_read_b64_tr_b16 v[32:33], v2 offset:24576
ds_read_b64_tr_b16 v[34:35], v2 offset:25088
buffer_load_dwordx4 v8, s[64:67], s63 offen offset:1024 lds
v_exp_f32 v19, v19
v_mul_f32 v100, v100, v108
v_mfma_f32_32x32x16_bf16 v[80:95], v[36:39], v[192:195], v[80:95]
ds_read_b64_tr_b16 v[36:37], v3 offset:24576
ds_read_b64_tr_b16 v[38:39], v3 offset:25088
v_mul_f32 v101, v101, v109
v_mul_f32 v102, v102, v110
v_mul_f32 v103, v103, v111
v_fma_f32 v16, v16, v15, v15
v_mfma_f32_32x32x16_bf16 v[64:79], v[40:43], v[196:199], v[64:79]
ds_read_b64_tr_b16 v[40:41], v2 offset:26624
ds_read_b64_tr_b16 v[42:43], v2 offset:27136
v_fma_f32 v17, v17, v15, v15
v_fma_f32 v18, v18, v15, v15
v_fma_f32 v19, v19, v15, v15
v_mfma_f32_32x32x16_bf16 v[80:95], v[44:47], v[196:199], v[80:95]
ds_read_b64_tr_b16 v[44:45], v3 offset:26624
ds_read_b64_tr_b16 v[46:47], v3 offset:27136
v_rcp_f32 v16, v16
s_waitcnt lgkmcnt(8)
v_mfma_f32_32x32x16_bf16 v[64:79], v[48:51], v[200:203], v[64:79]
ds_read_b64_tr_b16 v[48:49], v2 offset:28672
ds_read_b64_tr_b16 v[50:51], v2 offset:29184
v_rcp_f32 v17, v17
v_rcp_f32 v18, v18
v_mfma_f32_32x32x16_bf16 v[80:95], v[52:55], v[200:203], v[80:95]
ds_read_b64_tr_b16 v[52:53], v3 offset:28672
ds_read_b64_tr_b16 v[54:55], v3 offset:29184
v_rcp_f32 v19, v19
v_mul_f32 v100, v100, v16
v_mul_f32 v101, v101, v17
v_mfma_f32_32x32x16_bf16 v[64:79], v[56:59], v[204:207], v[64:79]
ds_read_b64_tr_b16 v[56:57], v2 offset:30720
ds_read_b64_tr_b16 v[58:59], v2 offset:31232
v_mul_f32 v102, v102, v18
v_mul_f32 v103, v103, v19
v_cvt_pk_bf16_f32 v22, v100, v101
v_cvt_pk_bf16_f32 v23, v102, v103
v_mfma_f32_32x32x16_bf16 v[80:95], v[60:63], v[204:207], v[80:95]
ds_read_b64_tr_b16 v[60:61], v3 offset:30720
ds_read_b64_tr_b16 v[62:63], v3 offset:31232
s_add_u32 s44, s57, 6144
buffer_store_dwordx4 v[20:23], v9, s[20:23], s44 offen sc1
v_mul_f32 v16, v13, v112
s_waitcnt lgkmcnt(8)
v_mfma_f32_32x32x16_bf16 v[64:79], v[32:35], v[208:211], v[64:79]
s_barrier
ds_read_b64_tr_b16 v[32:33], v2 offset:32768
ds_read_b64_tr_b16 v[34:35], v2 offset:33280
v_mul_f32 v17, v13, v113
v_mul_f32 v18, v13, v114
v_mul_f32 v19, v13, v115
v_mfma_f32_32x32x16_bf16 v[80:95], v[36:39], v[208:211], v[80:95]
ds_read_b64_tr_b16 v[36:37], v3 offset:32768
ds_read_b64_tr_b16 v[38:39], v3 offset:33280
v_exp_f32 v16, v16
v_exp_f32 v17, v17
v_mfma_f32_32x32x16_bf16 v[64:79], v[40:43], v[212:215], v[64:79]
ds_read_b64_tr_b16 v[40:41], v2 offset:34816
ds_read_b64_tr_b16 v[42:43], v2 offset:35328
v_exp_f32 v18, v18
v_exp_f32 v19, v19
v_mfma_f32_32x32x16_bf16 v[80:95], v[44:47], v[212:215], v[80:95]
ds_read_b64_tr_b16 v[44:45], v3 offset:34816
ds_read_b64_tr_b16 v[46:47], v3 offset:35328
v_mul_f32 v112, v112, v120
v_mul_f32 v113, v113, v121
v_mul_f32 v114, v114, v122
s_waitcnt lgkmcnt(8)
v_mfma_f32_32x32x16_bf16 v[64:79], v[48:51], v[216:219], v[64:79]
ds_read_b64_tr_b16 v[48:49], v2 offset:36864
ds_read_b64_tr_b16 v[50:51], v2 offset:37376
v_mul_f32 v115, v115, v123
v_fma_f32 v16, v16, v15, v15
v_fma_f32 v17, v17, v15, v15
v_fma_f32 v18, v18, v15, v15
v_mfma_f32_32x32x16_bf16 v[80:95], v[52:55], v[216:219], v[80:95]
ds_read_b64_tr_b16 v[52:53], v3 offset:36864
ds_read_b64_tr_b16 v[54:55], v3 offset:37376
v_fma_f32 v19, v19, v15, v15
v_rcp_f32 v16, v16
v_mfma_f32_32x32x16_bf16 v[64:79], v[56:59], v[220:223], v[64:79]
ds_read_b64_tr_b16 v[56:57], v2 offset:38912
ds_read_b64_tr_b16 v[58:59], v2 offset:39424
v_rcp_f32 v17, v17
v_rcp_f32 v18, v18
v_mfma_f32_32x32x16_bf16 v[80:95], v[60:63], v[220:223], v[80:95]
ds_read_b64_tr_b16 v[60:61], v3 offset:38912
ds_read_b64_tr_b16 v[62:63], v3 offset:39424
v_rcp_f32 v19, v19
v_mul_f32 v112, v112, v16
s_waitcnt lgkmcnt(8)
v_mfma_f32_32x32x16_bf16 v[64:79], v[32:35], v[224:227], v[64:79]
ds_read_b64_tr_b16 v[32:33], v2 offset:40960
ds_read_b64_tr_b16 v[34:35], v2 offset:41472
v_mul_f32 v113, v113, v17
v_mul_f32 v114, v114, v18
v_mul_f32 v115, v115, v19
v_cvt_pk_bf16_f32 v24, v112, v113
v_mfma_f32_32x32x16_bf16 v[80:95], v[36:39], v[224:227], v[80:95]
ds_read_b64_tr_b16 v[36:37], v3 offset:40960
ds_read_b64_tr_b16 v[38:39], v3 offset:41472
v_cvt_pk_bf16_f32 v25, v114, v115
v_mul_f32 v16, v13, v116
v_mul_f32 v17, v13, v117
v_mul_f32 v18, v13, v118
v_mfma_f32_32x32x16_bf16 v[64:79], v[40:43], v[228:231], v[64:79]
ds_read_b64_tr_b16 v[40:41], v2 offset:43008
ds_read_b64_tr_b16 v[42:43], v2 offset:43520
v_mul_f32 v19, v13, v119
v_exp_f32 v16, v16
v_mfma_f32_32x32x16_bf16 v[80:95], v[44:47], v[228:231], v[80:95]
ds_read_b64_tr_b16 v[44:45], v3 offset:43008
ds_read_b64_tr_b16 v[46:47], v3 offset:43520
v_exp_f32 v17, v17
s_waitcnt lgkmcnt(8)
v_mfma_f32_32x32x16_bf16 v[64:79], v[48:51], v[232:235], v[64:79]
ds_read_b64_tr_b16 v[48:49], v2 offset:45056
ds_read_b64_tr_b16 v[50:51], v2 offset:45568
v_exp_f32 v18, v18
v_exp_f32 v19, v19
v_mfma_f32_32x32x16_bf16 v[80:95], v[52:55], v[232:235], v[80:95]
ds_read_b64_tr_b16 v[52:53], v3 offset:45056
ds_read_b64_tr_b16 v[54:55], v3 offset:45568
v_mul_f32 v116, v116, v124
v_mul_f32 v117, v117, v125
v_mul_f32 v118, v118, v126
v_mul_f32 v119, v119, v127
v_mfma_f32_32x32x16_bf16 v[64:79], v[56:59], v[236:239], v[64:79]
ds_read_b64_tr_b16 v[56:57], v2 offset:47104
ds_read_b64_tr_b16 v[58:59], v2 offset:47616
v_fma_f32 v16, v16, v15, v15
v_fma_f32 v17, v17, v15, v15
v_fma_f32 v18, v18, v15, v15
v_fma_f32 v19, v19, v15, v15
v_mfma_f32_32x32x16_bf16 v[80:95], v[60:63], v[236:239], v[80:95]
ds_read_b64_tr_b16 v[60:61], v3 offset:47104
ds_read_b64_tr_b16 v[62:63], v3 offset:47616
v_rcp_f32 v16, v16
s_waitcnt lgkmcnt(8)
v_mfma_f32_32x32x16_bf16 v[64:79], v[32:35], v[240:243], v[64:79]
v_rcp_f32 v17, v17
v_rcp_f32 v18, v18
v_rcp_f32 v19, v19
v_mfma_f32_32x32x16_bf16 v[80:95], v[36:39], v[240:243], v[80:95]
v_mul_f32 v116, v116, v16
v_mul_f32 v117, v117, v17
v_mul_f32 v118, v118, v18
v_mul_f32 v119, v119, v19
v_cvt_pk_bf16_f32 v26, v116, v117
v_cvt_pk_bf16_f32 v27, v118, v119
v_mfma_f32_32x32x16_bf16 v[64:79], v[40:43], v[244:247], v[64:79]
s_add_u32 s44, s57, 7168
buffer_store_dwordx4 v[24:27], v9, s[20:23], s44 offen sc1
v_mfma_f32_32x32x16_bf16 v[80:95], v[44:47], v[244:247], v[80:95]
s_waitcnt lgkmcnt(0)
v_mfma_f32_32x32x16_bf16 v[64:79], v[48:51], v[248:251], v[64:79]
v_mfma_f32_32x32x16_bf16 v[80:95], v[52:55], v[248:251], v[80:95]
v_mfma_f32_32x32x16_bf16 v[64:79], v[56:59], v[252:255], v[64:79]
v_mfma_f32_32x32x16_bf16 v[80:95], v[60:63], v[252:255], v[80:95]
s_load_dwordx16 s[28:43], s[14:15], 0 glc
s_waitcnt vmcnt(2)
s_barrier
v_xor_b32 v2, 64, v10
s_mov_b32 s45, 139264
v_lshrrev_b32 v16, 5, v1
v_bfe_u32 v17, v1, 2, 2
v_and_b32 v18, 3, v1
v_lshlrev_b32 v16, 7, v16
v_lshl_add_u32 v16, v17, 5, v16
v_lshl_add_u32 v16, v18, 3, v16
v_add_u32 v16, s45, v16
ds_read_b64_tr_b16 v[48:49], v16 offset:0
ds_read_b64_tr_b16 v[50:51], v16 offset:256
ds_read_b64_tr_b16 v[52:53], v16 offset:512
ds_read_b64_tr_b16 v[54:55], v16 offset:768
ds_read_b64_tr_b16 v[56:57], v16 offset:1024
ds_read_b64_tr_b16 v[58:59], v16 offset:1280
ds_read_b64_tr_b16 v[60:61], v16 offset:1536
ds_read_b64_tr_b16 v[62:63], v16 offset:1792
v_bfe_u32 v17, v1, 4, 1
v_mul_u32_u24 v17, 0x8000, v17
v_lshl_add_u32 v17, v17, 16, v17
s_waitcnt lgkmcnt(0)
v_xor_b32 v48, v17, v48
v_xor_b32 v49, v17, v49
v_xor_b32 v50, v17, v50
v_xor_b32 v51, v17, v51
v_xor_b32 v52, v17, v52
v_xor_b32 v53, v17, v53
v_xor_b32 v54, v17, v54
v_xor_b32 v55, v17, v55
v_xor_b32 v56, v17, v56
v_xor_b32 v57, v17, v57
v_xor_b32 v58, v17, v58
v_xor_b32 v59, v17, v59
v_xor_b32 v60, v17, v60
v_xor_b32 v61, v17, v61
v_xor_b32 v62, v17, v62
v_xor_b32 v63, v17, v63
v_cvt_pk_bf16_f32 v32, v64, v65
v_cvt_pk_bf16_f32 v33, v66, v67
v_cvt_pk_bf16_f32 v34, v68, v69
v_cvt_pk_bf16_f32 v35, v70, v71
v_cvt_pk_bf16_f32 v36, v72, v73
v_cvt_pk_bf16_f32 v37, v74, v75
v_cvt_pk_bf16_f32 v38, v76, v77
v_cvt_pk_bf16_f32 v39, v78, v79
v_cvt_pk_bf16_f32 v40, v80, v81
v_cvt_pk_bf16_f32 v41, v82, v83
v_cvt_pk_bf16_f32 v42, v84, v85
v_cvt_pk_bf16_f32 v43, v86, v87
v_cvt_pk_bf16_f32 v44, v88, v89
v_cvt_pk_bf16_f32 v45, v90, v91
v_cvt_pk_bf16_f32 v46, v92, v93
v_cvt_pk_bf16_f32 v47, v94, v95
v_mfma_f32_32x32x16_bf16 v[64:79], v[48:51], v[32:35], 0
v_mfma_f32_32x32x16_bf16 v[80:95], v[52:55], v[36:39], 0
v_mfma_f32_32x32x16_bf16 v[96:111], v[56:59], v[40:43], 0
v_mfma_f32_32x32x16_bf16 v[112:127], v[60:63], v[44:47], 0
s_waitcnt vmcnt(0)
v_mov_b32 v7, 1
buffer_store_dword v7, v12, s[20:23], s56 offen sc1
s_lshl_b32 s57, s6, 12
s_add_u32 s57, s57, s55
s_nop 3
v_max3_f32 v16, v64, v65, v66
v_max3_f32 v18, v80, v81, v82
v_max3_f32 v17, v72, v73, v74
v_max3_f32 v19, v88, v89, v90
v_max3_f32 v16, v16, v67, v68
v_max3_f32 v18, v18, v83, v84
v_max3_f32 v17, v17, v75, v76
v_max3_f32 v19, v19, v91, v92
v_max3_f32 v16, v16, v69, v70
v_max3_f32 v18, v18, v85, v86
v_max3_f32 v17, v17, v77, v78
v_max3_f32 v19, v19, v93, v94
v_max_f32 v16, v16, v71
v_max_f32 v18, v18, v87
v_max_f32 v17, v17, v79
v_max_f32 v19, v19, v95
s_nop 0
v_permlane32_swap_b32 v16, v17
v_permlane32_swap_b32 v18, v19
v_max_f32 v16, v16, v17
v_max_f32 v18, v18, v19
v_mul_f32 v16, v16, v0
v_mul_f32 v18, v18, v0
v_mov_b32 v17, v16
v_mov_b32 v19, v18
s_nop 0
v_permlane32_swap_b32 v16, v17
v_permlane32_swap_b32 v18, v19
v_fma_f32 v64, v64, v0, -v16
v_fma_f32 v80, v80, v0, -v18
v_fma_f32 v65, v65, v0, -v16
v_fma_f32 v81, v81, v0, -v18
v_fma_f32 v66, v66, v0, -v16
v_fma_f32 v82, v82, v0, -v18
v_fma_f32 v67, v67, v0, -v16
v_fma_f32 v83, v83, v0, -v18
v_fma_f32 v68, v68, v0, -v16
v_fma_f32 v84, v84, v0, -v18
v_fma_f32 v69, v69, v0, -v16
v_fma_f32 v85, v85, v0, -v18
v_fma_f32 v70, v70, v0, -v16
v_fma_f32 v86, v86, v0, -v18
v_fma_f32 v71, v71, v0, -v16
v_fma_f32 v87, v87, v0, -v18
v_fma_f32 v72, v72, v0, -v17
v_fma_f32 v88, v88, v0, -v19
v_fma_f32 v73, v73, v0, -v17
v_fma_f32 v89, v89, v0, -v19
v_fma_f32 v74, v74, v0, -v17
v_fma_f32 v90, v90, v0, -v19
v_fma_f32 v75, v75, v0, -v17
v_fma_f32 v91, v91, v0, -v19
v_fma_f32 v76, v76, v0, -v17
v_fma_f32 v92, v92, v0, -v19
v_fma_f32 v77, v77, v0, -v17
v_fma_f32 v93, v93, v0, -v19
v_fma_f32 v78, v78, v0, -v17
v_fma_f32 v94, v94, v0, -v19
v_fma_f32 v79, v79, v0, -v17
v_fma_f32 v95, v95, v0, -v19
v_exp_f32 v64, v64
v_exp_f32 v80, v80
v_exp_f32 v65, v65
v_exp_f32 v81, v81
v_exp_f32 v66, v66
v_exp_f32 v82, v82
v_exp_f32 v67, v67
v_exp_f32 v83, v83
v_exp_f32 v68, v68
v_exp_f32 v84, v84
v_exp_f32 v69, v69
v_exp_f32 v85, v85
v_exp_f32 v70, v70
v_exp_f32 v86, v86
v_exp_f32 v71, v71
v_exp_f32 v87, v87
v_exp_f32 v72, v72
v_exp_f32 v88, v88
v_exp_f32 v73, v73
v_exp_f32 v89, v89
v_exp_f32 v74, v74
v_exp_f32 v90, v90
v_exp_f32 v75, v75
v_exp_f32 v91, v91
v_exp_f32 v76, v76
v_exp_f32 v92, v92
v_exp_f32 v77, v77
v_exp_f32 v93, v93
v_exp_f32 v78, v78
v_exp_f32 v94, v94
v_exp_f32 v79, v79
v_exp_f32 v95, v95
v_add_f32 v16, v64, v65
v_add_f32 v18, v80, v81
v_add_f32 v17, v72, v73
v_add_f32 v19, v88, v89
v_add_f32 v16, v16, v66
v_add_f32 v18, v18, v82
v_add_f32 v17, v17, v74
v_add_f32 v19, v19, v90
v_add_f32 v16, v16, v67
v_add_f32 v18, v18, v83
v_add_f32 v17, v17, v75
v_add_f32 v19, v19, v91
v_add_f32 v16, v16, v68
v_add_f32 v18, v18, v84
v_add_f32 v17, v17, v76
v_add_f32 v19, v19, v92
v_add_f32 v16, v16, v69
v_add_f32 v18, v18, v85
v_add_f32 v17, v17, v77
v_add_f32 v19, v19, v93
v_add_f32 v16, v16, v70
v_add_f32 v18, v18, v86
v_add_f32 v17, v17, v78
v_add_f32 v19, v19, v94
v_add_f32 v16, v16, v71
v_add_f32 v18, v18, v87
v_add_f32 v17, v17, v79
v_add_f32 v19, v19, v95
s_nop 0
v_permlane32_swap_b32 v16, v17
v_permlane32_swap_b32 v18, v19
v_add_f32 v16, v16, v17
v_add_f32 v18, v18, v19
v_rcp_f32 v16, v16
v_rcp_f32 v18, v18
v_mov_b32 v17, v16
v_mov_b32 v19, v18
s_nop 0
v_permlane32_swap_b32 v16, v17
v_permlane32_swap_b32 v18, v19
v_mul_f32 v64, v64, v16
v_mul_f32 v80, v80, v18
v_mul_f32 v65, v65, v16
v_mul_f32 v81, v81, v18
v_mul_f32 v66, v66, v16
v_mul_f32 v82, v82, v18
v_mul_f32 v67, v67, v16
v_mul_f32 v83, v83, v18
v_mul_f32 v68, v68, v16
v_mul_f32 v84, v84, v18
v_mul_f32 v69, v69, v16
v_mul_f32 v85, v85, v18
v_mul_f32 v70, v70, v16
v_mul_f32 v86, v86, v18
v_mul_f32 v71, v71, v16
v_mul_f32 v87, v87, v18
v_mul_f32 v72, v72, v17
v_mul_f32 v88, v88, v19
v_mul_f32 v73, v73, v17
v_mul_f32 v89, v89, v19
v_mul_f32 v74, v74, v17
v_mul_f32 v90, v90, v19
v_mul_f32 v75, v75, v17
v_mul_f32 v91, v91, v19
v_mul_f32 v76, v76, v17
v_mul_f32 v92, v92, v19
v_mul_f32 v77, v77, v17
v_mul_f32 v93, v93, v19
v_mul_f32 v78, v78, v17
v_mul_f32 v94, v94, v19
v_mul_f32 v79, v79, v17
v_mul_f32 v95, v95, v19
v_cvt_pk_bf16_f32 v32, v64, v65
v_cvt_pk_bf16_f32 v40, v80, v81
v_cvt_pk_bf16_f32 v33, v66, v67
v_cvt_pk_bf16_f32 v41, v82, v83
v_cvt_pk_bf16_f32 v34, v68, v69
v_cvt_pk_bf16_f32 v42, v84, v85
v_cvt_pk_bf16_f32 v35, v70, v71
v_cvt_pk_bf16_f32 v43, v86, v87
v_cvt_pk_bf16_f32 v36, v72, v73
v_cvt_pk_bf16_f32 v44, v88, v89
v_cvt_pk_bf16_f32 v37, v74, v75
v_cvt_pk_bf16_f32 v45, v90, v91
v_cvt_pk_bf16_f32 v38, v76, v77
v_cvt_pk_bf16_f32 v46, v92, v93
v_cvt_pk_bf16_f32 v39, v78, v79
v_cvt_pk_bf16_f32 v47, v94, v95
v_and_b32 v4, 15, v1
v_lshrrev_b32 v5, 4, v1
v_lshlrev_b32 v4, 7, v4
v_lshl_add_u32 v4, v5, 5, v4
s_waitcnt lgkmcnt(0)
s_and_b32 s13, s28, s29
s_and_b32 s13, s13, s30
s_and_b32 s13, s13, s31
s_and_b32 s13, s13, s32
s_and_b32 s13, s13, s33
s_and_b32 s13, s13, s34
s_and_b32 s13, s13, s35
s_and_b32 s13, s13, s36
s_and_b32 s13, s13, s37
s_and_b32 s13, s13, s38
s_and_b32 s13, s13, s39
s_and_b32 s13, s13, s40
s_and_b32 s13, s13, s41
s_and_b32 s13, s13, s42
s_and_b32 s13, s13, s43
s_or_b32 s12, s28, s29
s_or_b32 s12, s12, s30
s_or_b32 s12, s12, s31
s_or_b32 s12, s12, s32
s_or_b32 s12, s12, s33
s_or_b32 s12, s12, s34
s_or_b32 s12, s12, s35
s_or_b32 s12, s12, s36
s_or_b32 s12, s12, s37
s_or_b32 s12, s12, s38
s_or_b32 s12, s12, s39
s_or_b32 s12, s12, s40
s_or_b32 s12, s12, s41
s_or_b32 s12, s12, s42
s_or_b32 s12, s12, s43
s_xor_b32 s12, s12, s13
s_xor_b32 s13, s13, 1
s_or_b32 s12, s12, s13
s_cmp_eq_u32 s12, 0
s_cbranch_scc1 L_poll_kv_ok
s_mov_b32 s58, 0
L_poll_kv:
s_load_dwordx16 s[28:43], s[14:15], 0 glc
s_waitcnt lgkmcnt(0)
s_and_b32 s13, s28, s29
s_and_b32 s13, s13, s30
s_and_b32 s13, s13, s31
s_and_b32 s13, s13, s32
s_and_b32 s13, s13, s33
s_and_b32 s13, s13, s34
s_and_b32 s13, s13, s35
s_and_b32 s13, s13, s36
s_and_b32 s13, s13, s37
s_and_b32 s13, s13, s38
s_and_b32 s13, s13, s39
s_and_b32 s13, s13, s40
s_and_b32 s13, s13, s41
s_and_b32 s13, s13, s42
s_and_b32 s13, s13, s43
s_or_b32 s12, s28, s29
s_or_b32 s12, s12, s30
s_or_b32 s12, s12, s31
s_or_b32 s12, s12, s32
s_or_b32 s12, s12, s33
s_or_b32 s12, s12, s34
s_or_b32 s12, s12, s35
s_or_b32 s12, s12, s36
s_or_b32 s12, s12, s37
s_or_b32 s12, s12, s38
s_or_b32 s12, s12, s39
s_or_b32 s12, s12, s40
s_or_b32 s12, s12, s41
s_or_b32 s12, s12, s42
s_or_b32 s12, s12, s43
s_xor_b32 s12, s12, s13
s_xor_b32 s13, s13, 1
s_or_b32 s12, s12, s13
s_cmp_eq_u32 s12, 0
s_cbranch_scc1 L_poll_kv_ok
s_sleep 1
s_add_u32 s58, s58, 1
s_cmp_lt_u32 s58, 0x20000
s_cbranch_scc1 L_poll_kv
L_poll_kv_ok:
buffer_load_dwordx4 v[192:195], v4, s[20:23], s18 offen sc1
buffer_load_dwordx4 v[128:131], v9, s[20:23], s19 offen offset:0 sc1
buffer_load_dwordx4 v[132:135], v9, s[20:23], s19 offen offset:2048 sc1
s_add_u32 s19, s19, 4096
buffer_load_dwordx4 v[136:139], v9, s[20:23], s19 offen offset:0 sc1
buffer_load_dwordx4 v[140:143], v9, s[20:23], s19 offen offset:2048 sc1
s_add_u32 s19, s19, 4096
buffer_load_dwordx4 v[144:147], v9, s[20:23], s19 offen offset:0 sc1
buffer_load_dwordx4 v[148:151], v9, s[20:23], s19 offen offset:2048 sc1
s_add_u32 s19, s19, 4096
buffer_load_dwordx4 v[152:155], v9, s[20:23], s19 offen offset:0 sc1
buffer_load_dwordx4 v[156:159], v9, s[20:23], s19 offen offset:2048 sc1
s_add_u32 s19, s19, 4096
buffer_load_dwordx4 v[160:163], v9, s[20:23], s19 offen offset:0 sc1
buffer_load_dwordx4 v[164:167], v9, s[20:23], s19 offen offset:2048 sc1
s_add_u32 s19, s19, 4096
buffer_load_dwordx4 v[168:171], v9, s[20:23], s19 offen offset:0 sc1
buffer_load_dwordx4 v[172:175], v9, s[20:23], s19 offen offset:2048 sc1
s_add_u32 s19, s19, 4096
buffer_load_dwordx4 v[176:179], v9, s[20:23], s19 offen offset:0 sc1
buffer_load_dwordx4 v[180:183], v9, s[20:23], s19 offen offset:2048 sc1
s_add_u32 s19, s19, 4096
buffer_load_dwordx4 v[184:187], v9, s[20:23], s19 offen offset:0 sc1
buffer_load_dwordx4 v[188:191], v9, s[20:23], s19 offen offset:2048 sc1
v_max3_f32 v16, v96, v97, v98
v_max3_f32 v18, v112, v113, v114
v_max3_f32 v17, v104, v105, v106
v_max3_f32 v19, v120, v121, v122
v_max3_f32 v16, v16, v99, v100
v_max3_f32 v18, v18, v115, v116
v_max3_f32 v17, v17, v107, v108
v_max3_f32 v19, v19, v123, v124
v_max3_f32 v16, v16, v101, v102
v_max3_f32 v18, v18, v117, v118
v_max3_f32 v17, v17, v109, v110
v_max3_f32 v19, v19, v125, v126
v_max_f32 v16, v16, v103
v_max_f32 v18, v18, v119
v_max_f32 v17, v17, v111
v_max_f32 v19, v19, v127
s_nop 0
v_permlane32_swap_b32 v16, v17
v_permlane32_swap_b32 v18, v19
v_max_f32 v16, v16, v17
v_max_f32 v18, v18, v19
v_mul_f32 v16, v16, v0
v_mul_f32 v18, v18, v0
v_mov_b32 v17, v16
v_mov_b32 v19, v18
s_nop 0
v_permlane32_swap_b32 v16, v17
v_permlane32_swap_b32 v18, v19
v_fma_f32 v96, v96, v0, -v16
v_fma_f32 v112, v112, v0, -v18
v_fma_f32 v97, v97, v0, -v16
v_fma_f32 v113, v113, v0, -v18
v_fma_f32 v98, v98, v0, -v16
v_fma_f32 v114, v114, v0, -v18
v_fma_f32 v99, v99, v0, -v16
v_fma_f32 v115, v115, v0, -v18
v_fma_f32 v100, v100, v0, -v16
v_fma_f32 v116, v116, v0, -v18
v_fma_f32 v101, v101, v0, -v16
v_fma_f32 v117, v117, v0, -v18
v_fma_f32 v102, v102, v0, -v16
v_fma_f32 v118, v118, v0, -v18
v_fma_f32 v103, v103, v0, -v16
v_fma_f32 v119, v119, v0, -v18
v_fma_f32 v104, v104, v0, -v17
v_fma_f32 v120, v120, v0, -v19
v_fma_f32 v105, v105, v0, -v17
v_fma_f32 v121, v121, v0, -v19
v_fma_f32 v106, v106, v0, -v17
v_fma_f32 v122, v122, v0, -v19
v_fma_f32 v107, v107, v0, -v17
v_fma_f32 v123, v123, v0, -v19
v_fma_f32 v108, v108, v0, -v17
v_fma_f32 v124, v124, v0, -v19
v_fma_f32 v109, v109, v0, -v17
v_fma_f32 v125, v125, v0, -v19
v_fma_f32 v110, v110, v0, -v17
v_fma_f32 v126, v126, v0, -v19
v_fma_f32 v111, v111, v0, -v17
v_fma_f32 v127, v127, v0, -v19
v_exp_f32 v96, v96
v_exp_f32 v112, v112
v_exp_f32 v97, v97
v_exp_f32 v113, v113
v_exp_f32 v98, v98
v_exp_f32 v114, v114
v_exp_f32 v99, v99
v_exp_f32 v115, v115
v_exp_f32 v100, v100
v_exp_f32 v116, v116
v_exp_f32 v101, v101
v_exp_f32 v117, v117
v_exp_f32 v102, v102
v_exp_f32 v118, v118
v_exp_f32 v103, v103
v_exp_f32 v119, v119
v_exp_f32 v104, v104
v_exp_f32 v120, v120
v_exp_f32 v105, v105
v_exp_f32 v121, v121
v_exp_f32 v106, v106
v_exp_f32 v122, v122
v_exp_f32 v107, v107
v_exp_f32 v123, v123
v_exp_f32 v108, v108
v_exp_f32 v124, v124
v_exp_f32 v109, v109
v_exp_f32 v125, v125
v_exp_f32 v110, v110
v_exp_f32 v126, v126
v_exp_f32 v111, v111
v_exp_f32 v127, v127
v_add_f32 v16, v96, v97
v_add_f32 v18, v112, v113
v_add_f32 v17, v104, v105
v_add_f32 v19, v120, v121
v_add_f32 v16, v16, v98
v_add_f32 v18, v18, v114
v_add_f32 v17, v17, v106
v_add_f32 v19, v19, v122
v_add_f32 v16, v16, v99
v_add_f32 v18, v18, v115
v_add_f32 v17, v17, v107
v_add_f32 v19, v19, v123
v_add_f32 v16, v16, v100
v_add_f32 v18, v18, v116
v_add_f32 v17, v17, v108
v_add_f32 v19, v19, v124
v_add_f32 v16, v16, v101
v_add_f32 v18, v18, v117
v_add_f32 v17, v17, v109
v_add_f32 v19, v19, v125
v_add_f32 v16, v16, v102
v_add_f32 v18, v18, v118
v_add_f32 v17, v17, v110
v_add_f32 v19, v19, v126
v_add_f32 v16, v16, v103
v_add_f32 v18, v18, v119
v_add_f32 v17, v17, v111
v_add_f32 v19, v19, v127
s_nop 0
v_permlane32_swap_b32 v16, v17
v_permlane32_swap_b32 v18, v19
v_add_f32 v16, v16, v17
v_add_f32 v18, v18, v19
v_rcp_f32 v16, v16
v_rcp_f32 v18, v18
v_mov_b32 v17, v16
v_mov_b32 v19, v18
s_nop 0
v_permlane32_swap_b32 v16, v17
v_permlane32_swap_b32 v18, v19
v_mul_f32 v96, v96, v16
v_mul_f32 v112, v112, v18
v_mul_f32 v97, v97, v16
v_mul_f32 v113, v113, v18
v_mul_f32 v98, v98, v16
v_mul_f32 v114, v114, v18
v_mul_f32 v99, v99, v16
v_mul_f32 v115, v115, v18
v_mul_f32 v100, v100, v16
v_mul_f32 v116, v116, v18
v_mul_f32 v101, v101, v16
v_mul_f32 v117, v117, v18
v_mul_f32 v102, v102, v16
v_mul_f32 v118, v118, v18
v_mul_f32 v103, v103, v16
v_mul_f32 v119, v119, v18
v_mul_f32 v104, v104, v17
v_mul_f32 v120, v120, v19
v_mul_f32 v105, v105, v17
v_mul_f32 v121, v121, v19
v_mul_f32 v106, v106, v17
v_mul_f32 v122, v122, v19
v_mul_f32 v107, v107, v17
v_mul_f32 v123, v123, v19
v_mul_f32 v108, v108, v17
v_mul_f32 v124, v124, v19
v_mul_f32 v109, v109, v17
v_mul_f32 v125, v125, v19
v_mul_f32 v110, v110, v17
v_mul_f32 v126, v126, v19
v_mul_f32 v111, v111, v17
v_mul_f32 v127, v127, v19
v_cvt_pk_bf16_f32 v48, v96, v97
v_cvt_pk_bf16_f32 v56, v112, v113
v_cvt_pk_bf16_f32 v49, v98, v99
v_cvt_pk_bf16_f32 v57, v114, v115
v_cvt_pk_bf16_f32 v50, v100, v101
v_cvt_pk_bf16_f32 v58, v116, v117
v_cvt_pk_bf16_f32 v51, v102, v103
v_cvt_pk_bf16_f32 v59, v118, v119
v_cvt_pk_bf16_f32 v52, v104, v105
v_cvt_pk_bf16_f32 v60, v120, v121
v_cvt_pk_bf16_f32 v53, v106, v107
v_cvt_pk_bf16_f32 v61, v122, v123
v_cvt_pk_bf16_f32 v54, v108, v109
v_cvt_pk_bf16_f32 v62, v124, v125
v_cvt_pk_bf16_f32 v55, v110, v111
v_cvt_pk_bf16_f32 v63, v126, v127
v_and_b32 v4, 31, v1
v_lshrrev_b32 v5, 5, v1
v_lshlrev_b32 v5, 2, v5
v_sub_u32 v4, v4, v5
v_mov_b32 v5, 0x3f80
v_mov_b32 v6, 0x3f800000
v_cmp_eq_u32 vcc, 0, v4
v_cmp_eq_u32 s[12:13], 1, v4
s_nop 0
v_cndmask_b32 v80, 0, v5, vcc
v_cndmask_b32 v80, v80, v6, s[12:13]
v_cmp_eq_u32 vcc, 2, v4
v_cmp_eq_u32 s[12:13], 3, v4
s_nop 0
v_cndmask_b32 v81, 0, v5, vcc
v_cndmask_b32 v81, v81, v6, s[12:13]
v_cmp_eq_u32 vcc, 8, v4
v_cmp_eq_u32 s[12:13], 9, v4
s_nop 0
v_cndmask_b32 v82, 0, v5, vcc
v_cndmask_b32 v82, v82, v6, s[12:13]
v_cmp_eq_u32 vcc, 10, v4
v_cmp_eq_u32 s[12:13], 11, v4
s_nop 0
v_cndmask_b32 v83, 0, v5, vcc
v_cndmask_b32 v83, v83, v6, s[12:13]
s_mov_b32 s19, 0xffff0000
s_waitcnt vmcnt(16)
s_waitcnt vmcnt(15)
v_mfma_f32_32x32x16_bf16 v[64:79], v[80:83], v[128:131], 0
v_lshlrev_b32 v84, 16, v192
v_and_b32 v85, s19, v192
v_lshlrev_b32 v86, 16, v193
v_and_b32 v87, s19, v193
s_waitcnt vmcnt(14)
v_mfma_f32_32x32x16_bf16 v[64:79], v[80:83], v[132:135], v[64:79]
v_lshlrev_b32 v88, 16, v194
v_and_b32 v89, s19, v194
v_lshlrev_b32 v90, 16, v195
v_and_b32 v91, s19, v195
s_waitcnt vmcnt(13)
v_mfma_f32_32x32x16_bf16 v[64:79], v[80:83], v[136:139], v[64:79]
v_add_f32_dpp v84, v84, v84 row_ror:8 row_mask:0xf bank_mask:0xf
v_add_f32_dpp v85, v85, v85 row_ror:8 row_mask:0xf bank_mask:0xf
v_add_f32_dpp v86, v86, v86 row_ror:8 row_mask:0xf bank_mask:0xf
v_add_f32_dpp v87, v87, v87 row_ror:8 row_mask:0xf bank_mask:0xf
s_waitcnt vmcnt(12)
v_mfma_f32_32x32x16_bf16 v[64:79], v[80:83], v[140:143], v[64:79]
v_add_f32_dpp v88, v88, v88 row_ror:8 row_mask:0xf bank_mask:0xf
v_add_f32_dpp v89, v89, v89 row_ror:8 row_mask:0xf bank_mask:0xf
v_add_f32_dpp v90, v90, v90 row_ror:8 row_mask:0xf bank_mask:0xf
v_add_f32_dpp v91, v91, v91 row_ror:8 row_mask:0xf bank_mask:0xf
s_waitcnt vmcnt(11)
v_mfma_f32_32x32x16_bf16 v[64:79], v[80:83], v[144:147], v[64:79]
v_add_f32_dpp v84, v84, v84 row_ror:4 row_mask:0xf bank_mask:0xf
v_add_f32_dpp v85, v85, v85 row_ror:4 row_mask:0xf bank_mask:0xf
v_add_f32_dpp v86, v86, v86 row_ror:4 row_mask:0xf bank_mask:0xf
v_add_f32_dpp v87, v87, v87 row_ror:4 row_mask:0xf bank_mask:0xf
s_waitcnt vmcnt(10)
v_mfma_f32_32x32x16_bf16 v[64:79], v[80:83], v[148:151], v[64:79]
v_add_f32_dpp v88, v88, v88 row_ror:4 row_mask:0xf bank_mask:0xf
v_add_f32_dpp v89, v89, v89 row_ror:4 row_mask:0xf bank_mask:0xf
v_add_f32_dpp v90, v90, v90 row_ror:4 row_mask:0xf bank_mask:0xf
v_add_f32_dpp v91, v91, v91 row_ror:4 row_mask:0xf bank_mask:0xf
s_waitcnt vmcnt(9)
v_mfma_f32_32x32x16_bf16 v[64:79], v[80:83], v[152:155], v[64:79]
v_add_f32_dpp v84, v84, v84 row_ror:2 row_mask:0xf bank_mask:0xf
v_add_f32_dpp v85, v85, v85 row_ror:2 row_mask:0xf bank_mask:0xf
v_add_f32_dpp v86, v86, v86 row_ror:2 row_mask:0xf bank_mask:0xf
v_add_f32_dpp v87, v87, v87 row_ror:2 row_mask:0xf bank_mask:0xf
s_waitcnt vmcnt(8)
v_mfma_f32_32x32x16_bf16 v[64:79], v[80:83], v[156:159], v[64:79]
v_add_f32_dpp v88, v88, v88 row_ror:2 row_mask:0xf bank_mask:0xf
v_add_f32_dpp v89, v89, v89 row_ror:2 row_mask:0xf bank_mask:0xf
v_add_f32_dpp v90, v90, v90 row_ror:2 row_mask:0xf bank_mask:0xf
v_add_f32_dpp v91, v91, v91 row_ror:2 row_mask:0xf bank_mask:0xf
s_waitcnt vmcnt(7)
v_mfma_f32_32x32x16_bf16 v[64:79], v[80:83], v[160:163], v[64:79]
v_add_f32_dpp v84, v84, v84 row_ror:1 row_mask:0xf bank_mask:0xf
v_add_f32_dpp v85, v85, v85 row_ror:1 row_mask:0xf bank_mask:0xf
v_add_f32_dpp v86, v86, v86 row_ror:1 row_mask:0xf bank_mask:0xf
v_add_f32_dpp v87, v87, v87 row_ror:1 row_mask:0xf bank_mask:0xf
s_waitcnt vmcnt(6)
v_mfma_f32_32x32x16_bf16 v[64:79], v[80:83], v[164:167], v[64:79]
v_add_f32_dpp v88, v88, v88 row_ror:1 row_mask:0xf bank_mask:0xf
v_add_f32_dpp v89, v89, v89 row_ror:1 row_mask:0xf bank_mask:0xf
v_add_f32_dpp v90, v90, v90 row_ror:1 row_mask:0xf bank_mask:0xf
v_add_f32_dpp v91, v91, v91 row_ror:1 row_mask:0xf bank_mask:0xf
s_waitcnt vmcnt(5)
v_mfma_f32_32x32x16_bf16 v[64:79], v[80:83], v[168:171], v[64:79]
v_cvt_pk_bf16_f32 v192, v84, v85
v_cvt_pk_bf16_f32 v193, v86, v87
v_cvt_pk_bf16_f32 v194, v88, v89
v_cvt_pk_bf16_f32 v195, v90, v91
s_waitcnt vmcnt(4)
v_mfma_f32_32x32x16_bf16 v[64:79], v[80:83], v[172:175], v[64:79]
v_bfe_u32 v4, v1, 4, 1
v_lshl_add_u32 v5, v1, 2, s17
v_cmp_eq_u32 vcc, 0, v4
v_add_u32 v4, s16, v9
s_waitcnt vmcnt(3)
v_mfma_f32_32x32x16_bf16 v[64:79], v[80:83], v[176:179], v[64:79]
v_mov_b32 v6, 1
s_waitcnt vmcnt(2)
v_mfma_f32_32x32x16_bf16 v[64:79], v[80:83], v[180:183], v[64:79]
s_waitcnt vmcnt(1)
v_mfma_f32_32x32x16_bf16 v[64:79], v[80:83], v[184:187], v[64:79]
s_waitcnt vmcnt(0)
v_mfma_f32_32x32x16_bf16 v[64:79], v[80:83], v[188:191], v[64:79]
s_nop 11
v_cvt_pk_bf16_f32 v72, v64, v65
v_cvt_pk_bf16_f32 v73, v66, v67
v_cvt_pk_bf16_f32 v74, v68, v69
v_cvt_pk_bf16_f32 v75, v70, v71
v_cndmask_b32 v64, v192, v72, vcc
v_cndmask_b32 v68, v72, v192, vcc
v_cndmask_b32 v65, v193, v73, vcc
v_cndmask_b32 v69, v73, v193, vcc
v_cndmask_b32 v66, v194, v74, vcc
v_cndmask_b32 v70, v74, v194, vcc
v_cndmask_b32 v67, v195, v75, vcc
v_cndmask_b32 v71, v75, v195, vcc
ds_write_b128 v4, v[64:67]
ds_write_b128 v4, v[68:71] offset:2048
ds_write_b32 v5, v6
v_and_b32 v5, 3, v1
v_lshlrev_b32 v5, 8, v5
v_add_u32 v5, 141312, v5
v_add_u32 v7, 131072, v9
s_mov_b32 s58, 0
L_kvx:
ds_read_b32 v6, v5
s_waitcnt lgkmcnt(0)
v_cmp_ne_u32 vcc, 1, v6
s_nop 0
s_cmp_eq_u64 vcc, 0
s_cbranch_scc1 L_kvx_ok
s_sleep 1
s_add_u32 s58, s58, 1
s_cmp_lt_u32 s58, 0x100000
s_cbranch_scc1 L_kvx
L_kvx_ok:
ds_read_b128 v[16:19], v7 offset:0
ds_read_b128 v[20:23], v7 offset:1024
ds_read_b128 v[24:27], v7 offset:2048
ds_read_b128 v[28:31], v7 offset:3072
s_waitcnt lgkmcnt(2)
v_mfma_f32_32x32x16_bf16 v[64:79], v[16:19], v[32:35], 0
v_mfma_f32_32x32x16_bf16 v[64:79], v[20:23], v[36:39], v[64:79]
s_waitcnt lgkmcnt(0)
v_mfma_f32_32x32x16_bf16 v[80:95], v[24:27], v[40:43], 0
v_mfma_f32_32x32x16_bf16 v[80:95], v[28:31], v[44:47], v[80:95]
ds_read_b128 v[16:19], v7 offset:4096
ds_read_b128 v[20:23], v7 offset:5120
ds_read_b128 v[24:27], v7 offset:6144
ds_read_b128 v[28:31], v7 offset:7168
s_waitcnt lgkmcnt(2)
v_mfma_f32_32x32x16_bf16 v[96:111], v[16:19], v[48:51], 0
v_mfma_f32_32x32x16_bf16 v[96:111], v[20:23], v[52:55], v[96:111]
s_waitcnt lgkmcnt(0)
v_mfma_f32_32x32x16_bf16 v[112:127], v[24:27], v[56:59], 0
v_mfma_f32_32x32x16_bf16 v[112:127], v[28:31], v[60:63], v[112:127]
v_add_f32 v72, 0x358637bd, v72
v_rcp_f32 v72, v72
s_nop 0
v_mul_f32 v64, v64, v72
v_mul_f32 v65, v65, v72
v_mul_f32 v66, v66, v72
v_mul_f32 v67, v67, v72
v_mul_f32 v68, v68, v72
v_mul_f32 v69, v69, v72
v_mul_f32 v70, v70, v72
v_mul_f32 v71, v71, v72
v_cvt_pk_bf16_f32 v48, v64, v65
v_cvt_pk_bf16_f32 v49, v66, v67
v_cvt_pk_bf16_f32 v50, v68, v69
v_cvt_pk_bf16_f32 v51, v70, v71
s_add_u32 s44, s57, 114688
buffer_store_dwordx4 v[48:51], v9, s[20:23], s44 offen sc1
v_add_f32 v80, 0x358637bd, v80
v_rcp_f32 v80, v80
s_nop 0
v_mul_f32 v88, v88, v80
v_mul_f32 v89, v89, v80
v_mul_f32 v90, v90, v80
v_mul_f32 v91, v91, v80
v_mul_f32 v92, v92, v80
v_mul_f32 v93, v93, v80
v_mul_f32 v94, v94, v80
v_mul_f32 v95, v95, v80
v_cvt_pk_bf16_f32 v52, v88, v89
v_cvt_pk_bf16_f32 v53, v90, v91
v_cvt_pk_bf16_f32 v54, v92, v93
v_cvt_pk_bf16_f32 v55, v94, v95
s_add_u32 s44, s57, 115712
buffer_store_dwordx4 v[52:55], v9, s[20:23], s44 offen sc1
v_add_f32 v104, 0x358637bd, v104
v_rcp_f32 v104, v104
s_nop 0
v_mul_f32 v96, v96, v104
v_mul_f32 v97, v97, v104
v_mul_f32 v98, v98, v104
v_mul_f32 v99, v99, v104
v_mul_f32 v100, v100, v104
v_mul_f32 v101, v101, v104
v_mul_f32 v102, v102, v104
v_mul_f32 v103, v103, v104
v_cvt_pk_bf16_f32 v56, v96, v97
v_cvt_pk_bf16_f32 v57, v98, v99
v_cvt_pk_bf16_f32 v58, v100, v101
v_cvt_pk_bf16_f32 v59, v102, v103
s_add_u32 s44, s57, 116736
buffer_store_dwordx4 v[56:59], v9, s[20:23], s44 offen sc1
v_add_f32 v112, 0x358637bd, v112
v_rcp_f32 v112, v112
s_nop 0
v_mul_f32 v120, v120, v112
v_mul_f32 v121, v121, v112
v_mul_f32 v122, v122, v112
v_mul_f32 v123, v123, v112
v_mul_f32 v124, v124, v112
v_mul_f32 v125, v125, v112
v_mul_f32 v126, v126, v112
v_mul_f32 v127, v127, v112
v_cvt_pk_bf16_f32 v60, v120, v121
v_cvt_pk_bf16_f32 v61, v122, v123
v_cvt_pk_bf16_f32 v62, v124, v125
v_cvt_pk_bf16_f32 v63, v126, v127
s_add_u32 s44, s57, 117760
buffer_store_dwordx4 v[60:63], v9, s[20:23], s44 offen sc1
s_load_dwordx16 s[28:43], s[50:51], 0 glc
s_add_u32 s62, s60, 1146880
s_add_u32 m0, s52, 0
s_add_u32 s63, s62, 7168
buffer_load_dwordx4 v8, s[64:67], s62 offen lds
buffer_load_dwordx4 v8, s[64:67], s63 offen offset:1024 lds
s_add_u32 s62, s60, 1163264
s_add_u32 m0, s52, 2048
s_add_u32 s63, s62, 7168
buffer_load_dwordx4 v8, s[64:67], s62 offen lds
buffer_load_dwordx4 v8, s[64:67], s63 offen offset:1024 lds
s_waitcnt vmcnt(4)
v_mov_b32 v6, 2
buffer_store_dword v6, v12, s[20:23], s56 offen sc1
s_add_u32 s62, s61, 1572864
s_add_u32 m0, s52, 4096
s_add_u32 s63, s62, 7168
buffer_load_dwordx4 v8, s[64:67], s62 offen lds
buffer_load_dwordx4 v8, s[64:67], s63 offen offset:1024 lds
s_add_u32 s62, s61, 1589248
s_add_u32 m0, s52, 6144
s_add_u32 s63, s62, 7168
buffer_load_dwordx4 v8, s[64:67], s62 offen lds
buffer_load_dwordx4 v8, s[64:67], s63 offen offset:1024 lds
s_add_u32 s62, s61, 1605632
s_add_u32 m0, s52, 8192
s_add_u32 s63, s62, 7168
buffer_load_dwordx4 v8, s[64:67], s62 offen lds
buffer_load_dwordx4 v8, s[64:67], s63 offen offset:1024 lds
s_add_u32 s62, s61, 1622016
s_add_u32 m0, s52, 10240
s_add_u32 s63, s62, 7168
buffer_load_dwordx4 v8, s[64:67], s62 offen lds
buffer_load_dwordx4 v8, s[64:67], s63 offen offset:1024 lds
s_add_u32 s62, s60, 0
s_add_u32 m0, s52, 12288
s_add_u32 s63, s62, 7168
buffer_load_dwordx4 v8, s[68:71], s62 offen lds
buffer_load_dwordx4 v8, s[68:71], s63 offen offset:1024 lds
s_add_u32 s62, s60, 16384
s_add_u32 m0, s52, 14336
s_add_u32 s63, s62, 7168
buffer_load_dwordx4 v8, s[68:71], s62 offen lds
buffer_load_dwordx4 v8, s[68:71], s63 offen offset:1024 lds
s_setprio 0
s_waitcnt lgkmcnt(0)
s_min_u32 s12, s28, s29
s_min_u32 s12, s12, s36
s_min_u32 s12, s12, s37
s_sub_u32 s13, s12, 1
s_min_u32 s12, s30, s31
s_min_u32 s12, s12, s38
s_min_u32 s12, s12, s39
s_sub_u32 s12, s12, 1
s_or_b32 s13, s13, s12
s_cmp_ge_i32 s13, 0
s_cbranch_scc1 L_pf_cQ_2_ok
s_mov_b32 s58, 0
L_pf_cQ_2:
s_load_dwordx16 s[28:43], s[50:51], 0 glc
s_waitcnt lgkmcnt(0)
s_min_u32 s12, s28, s29
s_min_u32 s12, s12, s36
s_min_u32 s12, s12, s37
s_sub_u32 s13, s12, 1
s_min_u32 s12, s30, s31
s_min_u32 s12, s12, s38
s_min_u32 s12, s12, s39
s_sub_u32 s12, s12, 1
s_or_b32 s13, s13, s12
s_cmp_ge_i32 s13, 0
s_cbranch_scc1 L_pf_cQ_2_ok
s_sleep 1
s_add_u32 s58, s58, 1
s_cmp_lt_u32 s58, 0x20000
s_cbranch_scc1 L_pf_cQ_2
L_pf_cQ_2_ok:
s_add_u32 s62, s1, 71680
s_add_u32 s63, s1, 219136
buffer_load_dwordx4 v[128:131], v9, s[20:23], s62 offen sc1
buffer_load_dwordx4 v[132:135], v9, s[20:23], s63 offen sc1
s_add_u32 s62, s1, 72704
s_add_u32 s63, s1, 220160
buffer_load_dwordx4 v[136:139], v9, s[20:23], s62 offen sc1
buffer_load_dwordx4 v[140:143], v9, s[20:23], s63 offen sc1
s_waitcnt vmcnt(19)
ds_read_b64_tr_b16 v[16:17], v10 offset:0
ds_read_b64_tr_b16 v[18:19], v10 offset:1024
ds_read_b64_tr_b16 v[20:21], v2 offset:0
ds_read_b64_tr_b16 v[22:23], v2 offset:1024
s_waitcnt vmcnt(17)
ds_read_b64_tr_b16 v[24:25], v10 offset:2048
ds_read_b64_tr_b16 v[26:27], v10 offset:3072
ds_read_b64_tr_b16 v[28:29], v2 offset:2048
ds_read_b64_tr_b16 v[30:31], v2 offset:3072
s_waitcnt lgkmcnt(4)
s_load_dwordx16 s[28:43], s[50:51], 0 glc
s_waitcnt vmcnt(2)
v_mfma_f32_32x32x16_bf16 v[192:207], v[16:19], v[128:131], 0
v_mfma_f32_32x32x16_bf16 v[224:239], v[16:19], v[132:135], 0
v_mfma_f32_32x32x16_bf16 v[208:223], v[20:23], v[128:131], 0
v_mfma_f32_32x32x16_bf16 v[240:255], v[20:23], v[132:135], 0
s_waitcnt lgkmcnt(0)
s_min_u32 s12, s30, s31
s_min_u32 s12, s12, s38
s_min_u32 s12, s12, s39
s_sub_u32 s13, s12, 2
s_cmp_ge_i32 s13, 0
s_cbranch_scc1 L_pf_cQ_3_ok
s_mov_b32 s58, 0
L_pf_cQ_3:
s_load_dwordx16 s[28:43], s[50:51], 0 glc
s_waitcnt lgkmcnt(0)
s_min_u32 s12, s30, s31
s_min_u32 s12, s12, s38
s_min_u32 s12, s12, s39
s_sub_u32 s13, s12, 2
s_cmp_ge_i32 s13, 0
s_cbranch_scc1 L_pf_cQ_3_ok
s_sleep 1
s_add_u32 s58, s58, 1
s_cmp_lt_u32 s58, 0x20000
s_cbranch_scc1 L_pf_cQ_3
L_pf_cQ_3_ok:
s_add_u32 s62, s46, 98304
s_add_u32 s63, s46, 245760
buffer_load_dwordx4 v[144:147], v9, s[20:23], s62 offen sc1
buffer_load_dwordx4 v[148:151], v9, s[20:23], s63 offen sc1
s_add_u32 s62, s46, 99328
s_add_u32 s63, s46, 246784
buffer_load_dwordx4 v[152:155], v9, s[20:23], s62 offen sc1
buffer_load_dwordx4 v[156:159], v9, s[20:23], s63 offen sc1
s_add_u32 s62, s46, 100352
s_add_u32 s63, s46, 247808
buffer_load_dwordx4 v[160:163], v9, s[20:23], s62 offen sc1
buffer_load_dwordx4 v[164:167], v9, s[20:23], s63 offen sc1
s_add_u32 s62, s46, 101376
s_add_u32 s63, s46, 248832
buffer_load_dwordx4 v[168:171], v9, s[20:23], s62 offen sc1
buffer_load_dwordx4 v[172:175], v9, s[20:23], s63 offen sc1
ds_read_b64_tr_b16 v[16:17], v10 offset:4096
ds_read_b64_tr_b16 v[18:19], v10 offset:5120
ds_read_b64_tr_b16 v[20:21], v2 offset:4096
ds_read_b64_tr_b16 v[22:23], v2 offset:5120
s_load_dwordx16 s[28:43], s[50:51], 0 glc
s_waitcnt vmcnt(8)
v_mfma_f32_32x32x16_bf16 v[192:207], v[24:27], v[136:139], v[192:207]
v_mfma_f32_32x32x16_bf16 v[224:239], v[24:27], v[140:143], v[224:239]
v_mfma_f32_32x32x16_bf16 v[208:223], v[28:31], v[136:139], v[208:223]
v_mfma_f32_32x32x16_bf16 v[240:255], v[28:31], v[140:143], v[240:255]
s_waitcnt lgkmcnt(0)
s_min_u32 s12, s34, s35
s_min_u32 s12, s12, s42
s_min_u32 s12, s12, s43
s_sub_u32 s13, s12, 2
s_cmp_ge_i32 s13, 0
s_cbranch_scc1 L_pf_cQ_4_ok
s_mov_b32 s58, 0
L_pf_cQ_4:
s_load_dwordx16 s[28:43], s[50:51], 0 glc
s_waitcnt lgkmcnt(0)
s_min_u32 s12, s34, s35
s_min_u32 s12, s12, s42
s_min_u32 s12, s12, s43
s_sub_u32 s13, s12, 2
s_cmp_ge_i32 s13, 0
s_cbranch_scc1 L_pf_cQ_4_ok
s_sleep 1
s_add_u32 s58, s58, 1
s_cmp_lt_u32 s58, 0x20000
s_cbranch_scc1 L_pf_cQ_4
L_pf_cQ_4_ok:
s_add_u32 s62, s1, 114688
s_add_u32 s63, s1, 262144
buffer_load_dwordx4 v[176:179], v9, s[20:23], s62 offen sc1
buffer_load_dwordx4 v[180:183], v9, s[20:23], s63 offen sc1
ds_read_b64_tr_b16 v[24:25], v10 offset:6144
ds_read_b64_tr_b16 v[26:27], v10 offset:7168
ds_read_b64_tr_b16 v[28:29], v2 offset:6144
ds_read_b64_tr_b16 v[30:31], v2 offset:7168
s_add_u32 s62, s60, 32768
s_add_u32 m0, s52, 0
s_add_u32 s63, s62, 7168
buffer_load_dwordx4 v8, s[68:71], s62 offen lds
buffer_load_dwordx4 v8, s[68:71], s63 offen offset:1024 lds
s_waitcnt vmcnt(10)
v_mfma_f32_32x32x16_bf16 v[192:207], v[16:19], v[144:147], v[192:207]
v_mfma_f32_32x32x16_bf16 v[224:239], v[16:19], v[148:151], v[224:239]
v_mfma_f32_32x32x16_bf16 v[208:223], v[20:23], v[144:147], v[208:223]
v_mfma_f32_32x32x16_bf16 v[240:255], v[20:23], v[148:151], v[240:255]
s_add_u32 s62, s1, 115712
s_add_u32 s63, s1, 263168
buffer_load_dwordx4 v[184:187], v9, s[20:23], s62 offen sc1
buffer_load_dwordx4 v[188:191], v9, s[20:23], s63 offen sc1
ds_read_b64_tr_b16 v[16:17], v10 offset:8192
ds_read_b64_tr_b16 v[18:19], v10 offset:9216
ds_read_b64_tr_b16 v[20:21], v2 offset:8192
ds_read_b64_tr_b16 v[22:23], v2 offset:9216
s_waitcnt lgkmcnt(4)
s_add_u32 s62, s60, 49152
s_add_u32 m0, s52, 2048
s_add_u32 s63, s62, 7168
buffer_load_dwordx4 v8, s[68:71], s62 offen lds
buffer_load_dwordx4 v8, s[68:71], s63 offen offset:1024 lds
s_waitcnt vmcnt(12)
v_mfma_f32_32x32x16_bf16 v[192:207], v[24:27], v[152:155], v[192:207]
v_mfma_f32_32x32x16_bf16 v[224:239], v[24:27], v[156:159], v[224:239]
v_mfma_f32_32x32x16_bf16 v[208:223], v[28:31], v[152:155], v[208:223]
v_mfma_f32_32x32x16_bf16 v[240:255], v[28:31], v[156:159], v[240:255]
s_add_u32 s62, s1, 116736
s_add_u32 s63, s1, 264192
buffer_load_dwordx4 v[128:131], v9, s[20:23], s62 offen sc1
buffer_load_dwordx4 v[132:135], v9, s[20:23], s63 offen sc1
ds_read_b64_tr_b16 v[24:25], v10 offset:10240
ds_read_b64_tr_b16 v[26:27], v10 offset:11264
ds_read_b64_tr_b16 v[28:29], v2 offset:10240
ds_read_b64_tr_b16 v[30:31], v2 offset:11264
s_waitcnt lgkmcnt(4)
s_add_u32 s62, s60, 65536
s_add_u32 m0, s52, 4096
s_add_u32 s63, s62, 7168
buffer_load_dwordx4 v8, s[68:71], s62 offen lds
buffer_load_dwordx4 v8, s[68:71], s63 offen offset:1024 lds
s_waitcnt vmcnt(14)
v_mfma_f32_32x32x16_bf16 v[192:207], v[16:19], v[160:163], v[192:207]
v_mfma_f32_32x32x16_bf16 v[224:239], v[16:19], v[164:167], v[224:239]
v_mfma_f32_32x32x16_bf16 v[208:223], v[20:23], v[160:163], v[208:223]
v_mfma_f32_32x32x16_bf16 v[240:255], v[20:23], v[164:167], v[240:255]
s_add_u32 s62, s1, 117760
s_add_u32 s63, s1, 265216
buffer_load_dwordx4 v[136:139], v9, s[20:23], s62 offen sc1
buffer_load_dwordx4 v[140:143], v9, s[20:23], s63 offen sc1
ds_read_b64_tr_b16 v[16:17], v10 offset:12288
ds_read_b64_tr_b16 v[18:19], v10 offset:13312
ds_read_b64_tr_b16 v[20:21], v2 offset:12288
ds_read_b64_tr_b16 v[22:23], v2 offset:13312
s_waitcnt lgkmcnt(4)
s_add_u32 s62, s60, 81920
s_add_u32 m0, s52, 6144
s_add_u32 s63, s62, 7168
buffer_load_dwordx4 v8, s[68:71], s62 offen lds
buffer_load_dwordx4 v8, s[68:71], s63 offen offset:1024 lds
s_waitcnt vmcnt(16)
v_mfma_f32_32x32x16_bf16 v[192:207], v[24:27], v[168:171], v[192:207]
v_mfma_f32_32x32x16_bf16 v[224:239], v[24:27], v[172:175], v[224:239]
v_mfma_f32_32x32x16_bf16 v[208:223], v[28:31], v[168:171], v[208:223]
v_mfma_f32_32x32x16_bf16 v[240:255], v[28:31], v[172:175], v[240:255]
s_add_u32 s62, s1, 118784
s_add_u32 s63, s1, 266240
buffer_load_dwordx4 v[144:147], v9, s[20:23], s62 offen sc1
buffer_load_dwordx4 v[148:151], v9, s[20:23], s63 offen sc1
ds_read_b64_tr_b16 v[24:25], v10 offset:14336
ds_read_b64_tr_b16 v[26:27], v10 offset:15360
ds_read_b64_tr_b16 v[28:29], v2 offset:14336
ds_read_b64_tr_b16 v[30:31], v2 offset:15360
s_waitcnt lgkmcnt(4)
s_add_u32 s62, s60, 98304
s_add_u32 m0, s52, 8192
s_add_u32 s63, s62, 7168
buffer_load_dwordx4 v8, s[68:71], s62 offen lds
buffer_load_dwordx4 v8, s[68:71], s63 offen offset:1024 lds
s_waitcnt vmcnt(18)
v_mfma_f32_32x32x16_bf16 v[192:207], v[16:19], v[176:179], v[192:207]
v_mfma_f32_32x32x16_bf16 v[224:239], v[16:19], v[180:183], v[224:239]
v_mfma_f32_32x32x16_bf16 v[208:223], v[20:23], v[176:179], v[208:223]
v_mfma_f32_32x32x16_bf16 v[240:255], v[20:23], v[180:183], v[240:255]
s_add_u32 s62, s1, 119808
s_add_u32 s63, s1, 267264
buffer_load_dwordx4 v[152:155], v9, s[20:23], s62 offen sc1
buffer_load_dwordx4 v[156:159], v9, s[20:23], s63 offen sc1
s_waitcnt vmcnt(18)
ds_read_b64_tr_b16 v[16:17], v10 offset:0
ds_read_b64_tr_b16 v[18:19], v10 offset:1024
ds_read_b64_tr_b16 v[20:21], v2 offset:0
ds_read_b64_tr_b16 v[22:23], v2 offset:1024
s_waitcnt lgkmcnt(4)
s_add_u32 s62, s60, 114688
s_add_u32 m0, s52, 10240
s_add_u32 s63, s62, 7168
buffer_load_dwordx4 v8, s[68:71], s62 offen lds
buffer_load_dwordx4 v8, s[68:71], s63 offen offset:1024 lds
s_waitcnt vmcnt(18)
v_mfma_f32_32x32x16_bf16 v[192:207], v[24:27], v[184:187], v[192:207]
v_mfma_f32_32x32x16_bf16 v[224:239], v[24:27], v[188:191], v[224:239]
v_mfma_f32_32x32x16_bf16 v[208:223], v[28:31], v[184:187], v[208:223]
v_mfma_f32_32x32x16_bf16 v[240:255], v[28:31], v[188:191], v[240:255]
s_add_u32 s62, s1, 120832
s_add_u32 s63, s1, 268288
buffer_load_dwordx4 v[160:163], v9, s[20:23], s62 offen sc1
buffer_load_dwordx4 v[164:167], v9, s[20:23], s63 offen sc1
s_waitcnt vmcnt(18)
ds_read_b64_tr_b16 v[24:25], v10 offset:2048
ds_read_b64_tr_b16 v[26:27], v10 offset:3072
ds_read_b64_tr_b16 v[28:29], v2 offset:2048
ds_read_b64_tr_b16 v[30:31], v2 offset:3072
s_waitcnt lgkmcnt(4)
s_waitcnt vmcnt(16)
v_mfma_f32_32x32x16_bf16 v[192:207], v[16:19], v[128:131], v[192:207]
v_mfma_f32_32x32x16_bf16 v[224:239], v[16:19], v[132:135], v[224:239]
v_mfma_f32_32x32x16_bf16 v[208:223], v[20:23], v[128:131], v[208:223]
v_mfma_f32_32x32x16_bf16 v[240:255], v[20:23], v[132:135], v[240:255]
s_mov_b32 s24, s100
s_mov_b32 s25, s101
s_mov_b32 s26, 0x200000
s_mov_b32 s27, 0x20000
s_lshl_b32 s44, s48, 1
s_lshr_b32 s45, s3, 2
s_add_u32 s44, s44, s45
s_lshl_b32 s44, s44, 15
s_lshl_b32 s45, s49, 7
s_add_u32 s44, s44, s45
s_lshl_b32 s45, s4, 5
s_add_u32 s44, s44, s45
v_and_b32 v6, 31, v1
v_lshlrev_b32 v6, 10, v6
v_lshrrev_b32 v7, 5, v1
v_lshl_add_u32 v6, v7, 4, v6
v_add_u32 v6, s44, v6
buffer_load_dwordx4 v[32:35], v6, s[8:11], 0 offen
s_add_u32 s62, s1, 121856
s_add_u32 s63, s1, 269312
buffer_load_dwordx4 v[168:171], v9, s[20:23], s62 offen sc1
buffer_load_dwordx4 v[172:175], v9, s[20:23], s63 offen sc1
s_waitcnt vmcnt(17)
ds_read_b64_tr_b16 v[16:17], v10 offset:4096
ds_read_b64_tr_b16 v[18:19], v10 offset:5120
ds_read_b64_tr_b16 v[20:21], v2 offset:4096
ds_read_b64_tr_b16 v[22:23], v2 offset:5120
s_waitcnt lgkmcnt(4)
s_waitcnt vmcnt(15)
v_mfma_f32_32x32x16_bf16 v[192:207], v[24:27], v[136:139], v[192:207]
v_mfma_f32_32x32x16_bf16 v[224:239], v[24:27], v[140:143], v[224:239]
v_mfma_f32_32x32x16_bf16 v[208:223], v[28:31], v[136:139], v[208:223]
v_mfma_f32_32x32x16_bf16 v[240:255], v[28:31], v[140:143], v[240:255]
s_waitcnt vmcnt(13)
ds_read_b64_tr_b16 v[24:25], v10 offset:6144
ds_read_b64_tr_b16 v[26:27], v10 offset:7168
ds_read_b64_tr_b16 v[28:29], v2 offset:6144
ds_read_b64_tr_b16 v[30:31], v2 offset:7168
s_waitcnt lgkmcnt(4)
s_waitcnt vmcnt(11)
v_mfma_f32_32x32x16_bf16 v[192:207], v[16:19], v[144:147], v[192:207]
v_mfma_f32_32x32x16_bf16 v[224:239], v[16:19], v[148:151], v[224:239]
v_mfma_f32_32x32x16_bf16 v[208:223], v[20:23], v[144:147], v[208:223]
v_mfma_f32_32x32x16_bf16 v[240:255], v[20:23], v[148:151], v[240:255]
s_waitcnt vmcnt(9)
ds_read_b64_tr_b16 v[16:17], v10 offset:8192
ds_read_b64_tr_b16 v[18:19], v10 offset:9216
ds_read_b64_tr_b16 v[20:21], v2 offset:8192
ds_read_b64_tr_b16 v[22:23], v2 offset:9216
s_waitcnt lgkmcnt(4)
s_waitcnt vmcnt(7)
v_mfma_f32_32x32x16_bf16 v[192:207], v[24:27], v[152:155], v[192:207]
v_mfma_f32_32x32x16_bf16 v[224:239], v[24:27], v[156:159], v[224:239]
v_mfma_f32_32x32x16_bf16 v[208:223], v[28:31], v[152:155], v[208:223]
v_mfma_f32_32x32x16_bf16 v[240:255], v[28:31], v[156:159], v[240:255]
s_waitcnt vmcnt(5)
ds_read_b64_tr_b16 v[24:25], v10 offset:10240
ds_read_b64_tr_b16 v[26:27], v10 offset:11264
ds_read_b64_tr_b16 v[28:29], v2 offset:10240
ds_read_b64_tr_b16 v[30:31], v2 offset:11264
s_waitcnt lgkmcnt(4)
s_waitcnt vmcnt(3)
v_mfma_f32_32x32x16_bf16 v[192:207], v[16:19], v[160:163], v[192:207]
v_mfma_f32_32x32x16_bf16 v[224:239], v[16:19], v[164:167], v[224:239]
v_mfma_f32_32x32x16_bf16 v[208:223], v[20:23], v[160:163], v[208:223]
v_mfma_f32_32x32x16_bf16 v[240:255], v[20:23], v[164:167], v[240:255]
s_waitcnt lgkmcnt(0)
s_waitcnt vmcnt(0)
v_mfma_f32_32x32x16_bf16 v[192:207], v[24:27], v[168:171], v[192:207]
v_mfma_f32_32x32x16_bf16 v[224:239], v[24:27], v[172:175], v[224:239]
v_mfma_f32_32x32x16_bf16 v[208:223], v[28:31], v[168:171], v[208:223]
v_mfma_f32_32x32x16_bf16 v[240:255], v[28:31], v[172:175], v[240:255]
s_lshl_b32 s40, s3, 11
v_lshl_add_u32 v12, v1, 2, s40
v_add_u32 v13, 0x10000, v12
s_lshl_b32 s41, s4, 14
s_add_u32 m0, s41, 16136
s_nop 0
s_nop 2
ds_write_addtid_b32 v192 offset:49400
ds_write_addtid_b32 v193 offset:49656
ds_write_addtid_b32 v194 offset:49912
ds_write_addtid_b32 v195 offset:50168
ds_write_addtid_b32 v196 offset:50424
ds_write_addtid_b32 v197 offset:50680
ds_write_addtid_b32 v198 offset:50936
ds_write_addtid_b32 v199 offset:51192
ds_write_addtid_b32 v200 offset:51448
ds_write_addtid_b32 v201 offset:51704
ds_write_addtid_b32 v202 offset:51960
ds_write_addtid_b32 v203 offset:52216
ds_write_addtid_b32 v204 offset:52472
ds_write_addtid_b32 v205 offset:52728
ds_write_addtid_b32 v206 offset:52984
ds_write_addtid_b32 v207 offset:53240
ds_write_addtid_b32 v208 offset:53496
ds_write_addtid_b32 v209 offset:53752
ds_write_addtid_b32 v210 offset:54008
ds_write_addtid_b32 v211 offset:54264
ds_write_addtid_b32 v212 offset:54520
ds_write_addtid_b32 v213 offset:54776
ds_write_addtid_b32 v214 offset:55032
ds_write_addtid_b32 v215 offset:55288
ds_write_addtid_b32 v216 offset:55544
ds_write_addtid_b32 v217 offset:55800
ds_write_addtid_b32 v218 offset:56056
ds_write_addtid_b32 v219 offset:56312
ds_write_addtid_b32 v220 offset:56568
ds_write_addtid_b32 v221 offset:56824
ds_write_addtid_b32 v222 offset:57080
ds_write_addtid_b32 v223 offset:57336
ds_write_addtid_b32 v224 offset:57592
ds_write_addtid_b32 v225 offset:57848
ds_write_addtid_b32 v226 offset:58104
ds_write_addtid_b32 v227 offset:58360
ds_write_addtid_b32 v228 offset:58616
ds_write_addtid_b32 v229 offset:58872
ds_write_addtid_b32 v230 offset:59128
ds_write_addtid_b32 v231 offset:59384
ds_write_addtid_b32 v232 offset:59640
ds_write_addtid_b32 v233 offset:59896
ds_write_addtid_b32 v234 offset:60152
ds_write_addtid_b32 v235 offset:60408
ds_write_addtid_b32 v236 offset:60664
ds_write_addtid_b32 v237 offset:60920
ds_write_addtid_b32 v238 offset:61176
ds_write_addtid_b32 v239 offset:61432
ds_write_addtid_b32 v240 offset:61688
ds_write_addtid_b32 v241 offset:61944
ds_write_addtid_b32 v242 offset:62200
ds_write_addtid_b32 v243 offset:62456
ds_write_addtid_b32 v244 offset:62712
ds_write_addtid_b32 v245 offset:62968
ds_write_addtid_b32 v246 offset:63224
ds_write_addtid_b32 v247 offset:63480
ds_write_addtid_b32 v248 offset:63736
ds_write_addtid_b32 v249 offset:63992
ds_write_addtid_b32 v250 offset:64248
ds_write_addtid_b32 v251 offset:64504
ds_write_addtid_b32 v252 offset:64760
ds_write_addtid_b32 v253 offset:65016
ds_write_addtid_b32 v254 offset:65272
ds_write_addtid_b32 v255 offset:65528
v_mov_b32 v9, 0xffff0000
v_permlane32_swap_b32 v32, v34
v_permlane32_swap_b32 v33, v35
v_lshlrev_b32 v36, 16, v32
v_and_b32 v37, v9, v32
v_lshlrev_b32 v38, 16, v33
v_and_b32 v39, v9, v33
v_lshlrev_b32 v40, 16, v34
v_and_b32 v41, v9, v34
v_lshlrev_b32 v42, 16, v35
v_and_b32 v43, v9, v35
s_waitcnt lgkmcnt(0)
s_barrier
ds_read2st64_b32 v[64:65], v12 offset0:0 offset1:1
ds_read2st64_b32 v[66:67], v12 offset0:2 offset1:3
ds_read2st64_b32 v[68:69], v12 offset0:4 offset1:5
ds_read2st64_b32 v[70:71], v12 offset0:6 offset1:7
ds_read2st64_b32 v[72:73], v12 offset0:64 offset1:65
ds_read2st64_b32 v[74:75], v12 offset0:66 offset1:67
ds_read2st64_b32 v[76:77], v12 offset0:68 offset1:69
ds_read2st64_b32 v[78:79], v12 offset0:70 offset1:71
ds_read2st64_b32 v[80:81], v12 offset0:128 offset1:129
ds_read2st64_b32 v[82:83], v12 offset0:130 offset1:131
ds_read2st64_b32 v[84:85], v12 offset0:132 offset1:133
ds_read2st64_b32 v[86:87], v12 offset0:134 offset1:135
ds_read2st64_b32 v[88:89], v12 offset0:192 offset1:193
ds_read2st64_b32 v[90:91], v12 offset0:194 offset1:195
ds_read2st64_b32 v[92:93], v12 offset0:196 offset1:197
ds_read2st64_b32 v[94:95], v12 offset0:198 offset1:199
ds_read2st64_b32 v[96:97], v13 offset0:0 offset1:1
ds_read2st64_b32 v[98:99], v13 offset0:2 offset1:3
ds_read2st64_b32 v[100:101], v13 offset0:4 offset1:5
ds_read2st64_b32 v[102:103], v13 offset0:6 offset1:7
ds_read2st64_b32 v[104:105], v13 offset0:64 offset1:65
ds_read2st64_b32 v[106:107], v13 offset0:66 offset1:67
ds_read2st64_b32 v[108:109], v13 offset0:68 offset1:69
ds_read2st64_b32 v[110:111], v13 offset0:70 offset1:71
ds_read2st64_b32 v[112:113], v13 offset0:128 offset1:129
ds_read2st64_b32 v[114:115], v13 offset0:130 offset1:131
ds_read2st64_b32 v[116:117], v13 offset0:132 offset1:133
ds_read2st64_b32 v[118:119], v13 offset0:134 offset1:135
ds_read2st64_b32 v[120:121], v13 offset0:192 offset1:193
ds_read2st64_b32 v[122:123], v13 offset0:194 offset1:195
ds_read2st64_b32 v[124:125], v13 offset0:196 offset1:197
ds_read2st64_b32 v[126:127], v13 offset0:198 offset1:199
s_waitcnt lgkmcnt(15)
v_add_f32 v36, v36, v64
v_add_f32 v37, v37, v65
v_add_f32 v38, v38, v66
v_add_f32 v39, v39, v67
v_add_f32 v40, v40, v68
v_add_f32 v41, v41, v69
v_add_f32 v42, v42, v70
v_add_f32 v43, v43, v71
v_add_f32 v36, v36, v72
v_add_f32 v37, v37, v73
v_add_f32 v38, v38, v74
v_add_f32 v39, v39, v75
v_add_f32 v40, v40, v76
v_add_f32 v41, v41, v77
v_add_f32 v42, v42, v78
v_add_f32 v43, v43, v79
v_add_f32 v36, v36, v80
v_add_f32 v37, v37, v81
v_add_f32 v38, v38, v82
v_add_f32 v39, v39, v83
v_add_f32 v40, v40, v84
v_add_f32 v41, v41, v85
v_add_f32 v42, v42, v86
v_add_f32 v43, v43, v87
v_add_f32 v36, v36, v88
v_add_f32 v37, v37, v89
v_add_f32 v38, v38, v90
v_add_f32 v39, v39, v91
v_add_f32 v40, v40, v92
v_add_f32 v41, v41, v93
v_add_f32 v42, v42, v94
v_add_f32 v43, v43, v95
s_waitcnt lgkmcnt(12)
v_add_f32 v36, v36, v96
v_add_f32 v37, v37, v97
v_add_f32 v38, v38, v98
v_add_f32 v39, v39, v99
v_add_f32 v40, v40, v100
v_add_f32 v41, v41, v101
v_add_f32 v42, v42, v102
v_add_f32 v43, v43, v103
s_waitcnt lgkmcnt(8)
v_add_f32 v36, v36, v104
v_add_f32 v37, v37, v105
v_add_f32 v38, v38, v106
v_add_f32 v39, v39, v107
v_add_f32 v40, v40, v108
v_add_f32 v41, v41, v109
v_add_f32 v42, v42, v110
v_add_f32 v43, v43, v111
s_waitcnt lgkmcnt(4)
v_add_f32 v36, v36, v112
v_add_f32 v37, v37, v113
v_add_f32 v38, v38, v114
v_add_f32 v39, v39, v115
v_add_f32 v40, v40, v116
v_add_f32 v41, v41, v117
v_add_f32 v42, v42, v118
v_add_f32 v43, v43, v119
s_waitcnt lgkmcnt(0)
v_add_f32 v36, v36, v120
v_add_f32 v37, v37, v121
v_add_f32 v38, v38, v122
v_add_f32 v39, v39, v123
v_add_f32 v40, v40, v124
v_add_f32 v41, v41, v125
v_add_f32 v42, v42, v126
v_add_f32 v43, v43, v127
v_cvt_pk_bf16_f32 v32, v36, v37
v_cvt_pk_bf16_f32 v33, v38, v39
v_cvt_pk_bf16_f32 v34, v40, v41
v_cvt_pk_bf16_f32 v35, v42, v43
s_nop 0
v_permlane32_swap_b32 v32, v34
v_permlane32_swap_b32 v33, v35
buffer_store_dwordx4 v[32:35], v6, s[24:27], 0 offen
s_endpgm
.p2align 6
L_hD:
s_mov_b32 s12, s42
s_mov_b32 s13, s43
s_mov_b32 s14, 0x180000
s_mov_b32 s15, 0x20000
s_mov_b32 s16, s50
s_mov_b32 s17, s51
s_mov_b32 s18, 0x1c0000
s_mov_b32 s19, 0x20000
s_sub_u32 s28, s52, 2048
s_subb_u32 s29, s53, 0
s_mov_b32 s30, 0x1c0800
s_mov_b32 s31, 0x20000
v_lshrrev_b32 v10, 3, v1
v_and_b32 v11, 7, v1
v_bfe_u32 v12, v1, 4, 1
s_lshl_b32 s35, s6, 7
s_add_u32 s40, s35, 1024
s_add_u32 s41, s35, 2048
s_mov_b32 s42, s41
s_lshl_b32 s43, s6, 6
s_add_u32 s43, s43, 3072
s_mul_i32 s32, s4, 98304
s_add_u32 s32, s32, s40
s_mul_i32 s33, s4, 98304
s_add_u32 s33, s33, s41
s_mul_i32 s34, s4, 57344
s_add_u32 s34, s34, s42
s_mul_i32 s35, s4, 114688
s_add_u32 s35, s35, s43
s_lshl_b32 s36, s4, 12
s_add_u32 s36, s36, 65536
v_lshlrev_b32 v13, 2, v12
v_xor_b32 v13, v13, v11
v_mul_u32_u24 v14, 3072, v10
v_lshl_add_u32 v244, v13, 4, v14
v_add_u32 v245, 23552, v244
v_add_u32 v246, 47104, v244
v_add_u32 v247, 70656, v244
s_add_u32 s53, s7, 0
s_and_b32 s53, s53, 7
s_mul_i32 s53, s53, 196608
s_add_u32 m0, s36, 0
s_add_u32 s53, s53, s32
buffer_load_dwordx4 v244, s[12:15], s53 offen offset:0 lds
buffer_load_dwordx4 v245, s[12:15], s53 offen offset:1024 lds
buffer_load_dwordx4 v246, s[12:15], s53 offen offset:2048 lds
buffer_load_dwordx4 v247, s[12:15], s53 offen offset:3072 lds
s_getpc_b64 s[62:63]
L_pc_D:
s_sub_u32 s62, s62, L_pc_D-L_code
s_subb_u32 s63, s63, 0
s_lshr_b32 s37, s2, 3
s_lshl_b32 s37, s37, 2
s_add_u32 s37, s37, s4
s_mul_i32 s37, s37, 5
v_min_u32 v14, 4, v1
v_add_u32 v14, s37, v14
v_lshlrev_b32 v14, 7, v14
v_min_u32 v14, L_code_end-L_code-4, v14
global_load_dword v255, v14, s[62:63]
v_lshlrev_b32 v13, 1, v12
v_xor_b32 v13, v13, v11
v_mul_u32_u24 v14, 3584, v10
v_lshl_add_u32 v240, v13, 4, v14
v_add_u32 v241, 27648, v240
v_xor_b32 v242, 64, v240
v_add_u32 v243, 27648, v242
v_lshrrev_b32 v10, 2, v1
v_and_b32 v11, 3, v1
v_mul_u32_u24 v14, 3584, v10
v_lshl_add_u32 v248, v11, 4, v14
v_add_u32 v250, 55296, v248
v_xor_b32 v14, 32, v248
v_add_u32 v249, 1024, v14
v_add_u32 v251, 56320, v14
s_mov_b32 s24, s58
s_mov_b32 s25, s59
s_mov_b32 s26, 0x100
s_mov_b32 s27, 0x20000
s_mov_b64 s[60:61], s[44:45]
s_mul_i32 s44, s4, 15360
v_lshl_add_u32 v6, v1, 2, s44
v_lshlrev_b32 v3, 4, v1
v_mov_b32 v9, 0xffff0000
s_lshl_b32 s55, s5, 2
s_add_u32 s55, s55, s4
s_mul_i32 s55, s55, 147456
v_lshrrev_b32 v12, 3, v1
v_lshlrev_b32 v12, 18, v12
v_add_u32 v12, v12, v1
v_lshlrev_b32 v12, 8, v12
s_lshl_b32 s47, s5, 1
s_lshr_b32 s44, s4, 1
s_add_u32 s47, s47, s44
s_lshl_b32 s47, s47, 6
s_add_u32 s47, s47, s6
s_lshl_b32 s47, s47, 3
s_and_b32 s44, s4, 1
s_add_u32 s47, s47, s44
s_lshl_b32 s47, s47, 2
s_add_u32 s47, s47, 10092544
s_lshl_b32 s37, s4, 8
s_add_u32 s37, s37, s2
s_lshl_b32 s44, s2, 11
s_add_u32 s44, s44, 10092544
s_lshl_b32 s45, s2, 9
s_add_u32 s45, s45, 10027008
s_cmp_lt_u32 s37, 32
s_cselect_b32 s44, s44, 0x7fff0000
s_cselect_b32 s45, s45, 0x7fff0000
v_and_b32 v11, 31, v1
v_lshlrev_b32 v11, 4, v11
v_mov_b32 v20, 0
v_mov_b32 v21, 0
v_mov_b32 v22, 0
v_mov_b32 v23, 0
buffer_store_dwordx4 v[20:23], v3, s[20:23], s44 offen sc1
buffer_store_dwordx4 v[20:23], v3, s[20:23], s44 offen offset:1024 sc1
buffer_store_dwordx4 v[20:23], v11, s[20:23], s45 offen sc1
s_lshl_b32 s44, s6, 11
v_add_u32 v10, s44, v3
global_load_dwordx4 v[32:35], v10, s[60:61]
global_load_dwordx4 v[36:39], v10, s[60:61] offset:1024
s_lshl_b32 s56, s6, 9
s_add_u32 s56, s56, s5
s_lshl_b32 s56, s56, 2
s_add_u32 s56, s56, 10027008
s_cmp_eq_u32 s4, 0
s_cselect_b32 s56, s56, 0x7fff0000
s_mul_i32 s57, s4, 15360
s_add_u32 s57, s57, 8192
v_add_u32 v40, s57, v3
s_and_b32 s37, s2, 7
s_lshr_b32 s38, s2, 3
s_lshl_b32 s48, s5, 1
s_bfe_u32 s39, s37, 0x10001
s_add_u32 s48, s48, s39
s_lshr_b32 s39, s38, 2
s_and_b32 s49, s37, 1
s_lshl_b32 s49, s49, 2
s_and_b32 s38, s38, 3
s_add_u32 s49, s49, s38
s_add_u32 s39, s4, s39
s_and_b32 s39, s39, 3
v_and_b32 v10, 7, v1
v_bfe_u32 v11, v1, 4, 1
v_lshlrev_b32 v11, 2, v11
v_xor_b32 v10, v10, v11
v_lshrrev_b32 v11, 3, v1
v_lshlrev_b32 v11, 10, v11
v_lshl_add_u32 v10, v10, 4, v11
s_lshl_b32 s37, s49, 7
v_add_u32 v2, s37, v10
v_lshlrev_b32 v3, 4, v1
s_lshl_b32 s52, s4, 14
v_bfe_u32 v10, v1, 4, 1
v_bfe_u32 v11, v1, 3, 1
v_lshl_add_u32 v10, v11, 1, v10
v_lshlrev_b32 v10, 5, v10
v_and_b32 v11, 3, v1
v_lshl_add_u32 v10, v11, 3, v10
v_bfe_u32 v11, v1, 2, 2
v_lshl_add_u32 v10, v11, 7, v10
v_lshrrev_b32 v11, 5, v1
v_lshl_add_u32 v10, v11, 9, v10
v_add_u32 v4, s52, v10
s_mul_i32 s37, s48, 294912
s_lshl_b32 s0, s39, 14
s_lshl_b32 s54, s0, 4
s_add_u32 s0, s0, s37
s_lshl_b32 s1, s39, 13
s_lshl_b32 s60, s1, 4
s_add_u32 s1, s1, s37
s_lshl_b32 s46, s39, 12
s_lshl_b32 s61, s46, 4
s_add_u32 s46, s46, s37
s_lshl_b32 s50, s48, 3
s_add_u32 s50, s50, s49
s_lshl_b32 s50, s50, 2
s_add_u32 s50, s50, s39
s_lshl_b32 s50, s50, 6
s_add_u32 s50, s50, 10092544
s_add_u32 s50, s20, s50
s_addc_u32 s51, s21, 0
v_xor_b32 v5, 64, v4
s_mul_i32 s59, s4, 15360
s_sub_u32 s37, s59, s52
v_add_u32 v214, s37, v4
v_xor_b32 v215, 64, v214
s_lshr_b32 s37, s4, 1
s_and_b32 s38, s4, 1
v_lshrrev_b32 v10, 5, v1
v_bfe_u32 v11, v1, 2, 2
v_lshl_add_u32 v10, v10, 2, v11
v_and_b32 v11, 3, v1
v_bfe_u32 v14, v1, 4, 1
v_mul_u32_u24 v206, 72, v10
v_lshl_add_u32 v206, v14, 5, v206
v_lshl_add_u32 v206, v11, 3, v206
s_mul_i32 s44, s4, 2304
s_add_u32 s44, s44, 6144
v_add_u32 v206, s44, v206
s_lshl_b32 s44, s37, 11
v_mov_b32 v207, s44
v_mov_b32 v210, 4096
v_cmp_eq_u32 vcc, s38, v14
s_nop 1
v_cndmask_b32 v207, v210, v207, vcc
v_lshl_add_u32 v207, v1, 2, v207
s_lshl_b32 s44, s6, 1
s_add_u32 s44, s44, s37
s_lshl_b32 s44, s44, 4
s_add_u32 s44, s44, s5
s_lshl_b32 s45, s44, 11
s_add_u32 s45, s45, 9437184
s_lshl_b32 s44, s44, 7
s_add_u32 s44, s44, 9961472
v_lshrrev_b32 v208, 4, v1
v_lshl_add_u32 v208, v208, 5, s44
v_mov_b32 v209, 0x7fffff00
v_and_b32 v210, 15, v1
v_add_u32 v211, s45, v3
v_cmp_eq_u32 s[62:63], 0, v210
s_nop 1
v_cndmask_b32 v208, v209, v208, s[62:63]
v_add_u32 v209, 16, v208
v_add_u32 v210, 1024, v211
v_cndmask_b32 v208, v208, v211, vcc
v_cndmask_b32 v209, v209, v210, vcc
s_barrier
s_add_u32 s53, s7, 2
s_and_b32 s53, s53, 7
s_mul_i32 s53, s53, 196608
s_add_u32 m0, s36, 16384
s_add_u32 s53, s53, s32
buffer_load_dwordx4 v244, s[12:15], s53 offen offset:0 lds
buffer_load_dwordx4 v245, s[12:15], s53 offen offset:1024 lds
buffer_load_dwordx4 v246, s[12:15], s53 offen offset:2048 lds
buffer_load_dwordx4 v247, s[12:15], s53 offen offset:3072 lds
s_and_b32 s45, s5, 7
s_lshl_b32 s45, s45, 2
s_add_u32 s45, s45, s4
s_mul_i32 s45, s45, 49152
s_add_u32 s45, s45, s40
v_and_b32 v10, 15, v1
v_mul_u32_u24 v10, 3072, v10
buffer_load_dword v254, v10, s[12:15], s45 offen
s_and_b32 s45, s5, 7
s_lshl_b32 s45, s45, 2
s_add_u32 s45, s45, s4
s_mul_i32 s45, s45, 49152
s_add_u32 s45, s45, s41
v_and_b32 v10, 15, v1
v_mul_u32_u24 v10, 3072, v10
buffer_load_dword v254, v10, s[12:15], s45 offen
s_waitcnt vmcnt(12)
s_barrier
s_add_u32 s53, s7, 4
s_and_b32 s53, s53, 7
s_mul_i32 s53, s53, 196608
s_add_u32 m0, s36, 32768
s_add_u32 s53, s53, s32
buffer_load_dwordx4 v244, s[12:15], s53 offen offset:0 lds
buffer_load_dwordx4 v245, s[12:15], s53 offen offset:1024 lds
buffer_load_dwordx4 v246, s[12:15], s53 offen offset:2048 lds
buffer_load_dwordx4 v247, s[12:15], s53 offen offset:3072 lds
s_add_u32 s53, s7, 6
s_and_b32 s53, s53, 7
s_mul_i32 s53, s53, 196608
s_add_u32 m0, s36, 49152
s_add_u32 s53, s53, s32
buffer_load_dwordx4 v244, s[12:15], s53 offen offset:0 lds
buffer_load_dwordx4 v245, s[12:15], s53 offen offset:1024 lds
buffer_load_dwordx4 v246, s[12:15], s53 offen offset:2048 lds
buffer_load_dwordx4 v247, s[12:15], s53 offen offset:3072 lds
s_add_u32 s53, s7, 0
s_and_b32 s53, s53, 7
s_mul_i32 s53, s53, 196608
s_add_u32 m0, s36, 65536
s_add_u32 s53, s53, s33
buffer_load_dwordx4 v244, s[12:15], s53 offen offset:0 lds
buffer_load_dwordx4 v245, s[12:15], s53 offen offset:1024 lds
buffer_load_dwordx4 v246, s[12:15], s53 offen offset:2048 lds
buffer_load_dwordx4 v247, s[12:15], s53 offen offset:3072 lds
s_waitcnt vmcnt(18)
ds_write_b128 v40, v[32:35]
ds_write_b128 v40, v[36:39] offset:1024
s_waitcnt lgkmcnt(0)
v_lshrrev_b32 v200, 5, v1
v_bfe_u32 v201, v1, 2, 2
v_and_b32 v202, 3, v1
v_lshlrev_b32 v200, 7, v200
v_lshl_add_u32 v200, v201, 5, v200
v_lshl_add_u32 v200, v202, 3, v200
v_add_u32 v200, s57, v200
ds_read_b64_tr_b16 v[16:17], v200 offset:0
ds_read_b64_tr_b16 v[18:19], v200 offset:256
ds_read_b64_tr_b16 v[20:21], v200 offset:512
ds_read_b64_tr_b16 v[22:23], v200 offset:768
ds_read_b64_tr_b16 v[24:25], v200 offset:1024
ds_read_b64_tr_b16 v[26:27], v200 offset:1280
ds_read_b64_tr_b16 v[28:29], v200 offset:1536
ds_read_b64_tr_b16 v[30:31], v200 offset:1792
v_bfe_u32 v201, v1, 4, 1
v_mul_u32_u24 v201, 0x8000, v201
v_lshl_add_u32 v201, v201, 16, v201
s_waitcnt lgkmcnt(0)
v_xor_b32 v16, v201, v16
v_xor_b32 v17, v201, v17
v_xor_b32 v18, v201, v18
v_xor_b32 v19, v201, v19
v_xor_b32 v20, v201, v20
v_xor_b32 v21, v201, v21
v_xor_b32 v22, v201, v22
v_xor_b32 v23, v201, v23
v_xor_b32 v24, v201, v24
v_xor_b32 v25, v201, v25
v_xor_b32 v26, v201, v26
v_xor_b32 v27, v201, v27
v_xor_b32 v28, v201, v28
v_xor_b32 v29, v201, v29
v_xor_b32 v30, v201, v30
v_xor_b32 v31, v201, v31
s_lshl_b32 s37, s4, 8
s_add_u32 s37, s37, s2
s_lshl_b32 s45, s2, 2
s_cmp_lt_u32 s37, 32
s_cselect_b32 s45, s45, 0x1000
v_mov_b32 v10, 0
v_mov_b32 v11, 1
buffer_store_dword v11, v10, s[24:27], s45 offen sc1
s_and_b32 s45, s5, 7
s_lshl_b32 s45, s45, 2
s_add_u32 s45, s45, s4
s_mul_i32 s45, s45, 57344
s_add_u32 s45, s45, s42
v_and_b32 v10, 15, v1
v_mul_u32_u24 v10, 3584, v10
buffer_load_dword v254, v10, s[16:19], s45 offen
buffer_load_dword v254, v10, s[28:31], s45 offen offset:2048
s_waitcnt vmcnt(17)
s_barrier
s_add_u32 s53, s7, 2
s_and_b32 s53, s53, 7
s_mul_i32 s53, s53, 196608
s_add_u32 m0, s36, 81920
s_add_u32 s53, s53, s33
buffer_load_dwordx4 v244, s[12:15], s53 offen offset:0 lds
v_and_b32 v10, 31, v1
s_lshl_b32 s44, s4, 8
s_add_u32 s44, s44, 61440
v_lshl_add_u32 v15, v10, 3, s44
ds_read_b64 v[10:11], v15
s_waitcnt lgkmcnt(0)
v_fma_f32 v14, -v10, v10, v11
v_max_f32 v14, 0, v14
v_cvt_pk_bf16_f32 v14, v14, v14
v_lshlrev_b32 v14, 16, v14
v_add_f32 v14, 0x3727c5ac, v14
buffer_load_dwordx4 v245, s[12:15], s53 offen offset:1024 lds
v_cvt_pk_bf16_f32 v14, v14, v14
v_lshlrev_b32 v14, 16, v14
v_sqrt_f32 v14, v14
s_nop 0
v_cvt_pk_bf16_f32 v14, v14, v14
v_lshlrev_b32 v14, 16, v14
v_rcp_f32 v15, v14
s_nop 0
v_mul_f32 v7, 0xbfb8aa3b, v15
v_mul_f32 v8, v14, v14
v_mul_f32 v204, 0x3fb8aa3b, v15
v_and_b32 v10, 31, v1
s_lshl_b32 s44, s4, 6
buffer_load_dwordx4 v246, s[12:15], s53 offen offset:2048 lds
s_add_u32 s44, s44, 62464
v_lshl_add_u32 v10, v10, 1, s44
ds_write_b16_d16_hi v10, v14
v_lshrrev_b32 v11, 5, v1
v_lshl_add_u32 v10, v11, 3, s44
s_waitcnt lgkmcnt(0)
ds_read_b64 v[32:33], v10 offset:0
ds_read_b64 v[34:35], v10 offset:16
ds_read_b64 v[36:37], v10 offset:32
ds_read_b64 v[38:39], v10 offset:48
s_waitcnt lgkmcnt(0)
buffer_load_dwordx4 v247, s[12:15], s53 offen offset:3072 lds
ds_write2st64_b32 v6, v32, v33 offset0:16 offset1:17
ds_write2st64_b32 v6, v34, v35 offset0:18 offset1:19
ds_write2st64_b32 v6, v36, v37 offset0:20 offset1:21
ds_write2st64_b32 v6, v38, v39 offset0:22 offset1:23
v_and_b32 v10, 31, v1
v_mul_u32_u24 v10, 72, v10
v_lshl_add_u32 v10, v11, 3, v10
s_mul_i32 s44, s4, 15360
s_add_u32 s44, s44, 6144
v_add_u32 v205, s44, v10
s_waitcnt vmcnt(15)
s_barrier
s_add_u32 s53, s7, 4
s_and_b32 s53, s53, 7
s_mul_i32 s53, s53, 196608
s_add_u32 m0, s36, 0
s_add_u32 s53, s53, s33
buffer_load_dwordx4 v244, s[12:15], s53 offen offset:0 lds
buffer_load_dwordx4 v245, s[12:15], s53 offen offset:1024 lds
buffer_load_dwordx4 v246, s[12:15], s53 offen offset:2048 lds
buffer_load_dwordx4 v247, s[12:15], s53 offen offset:3072 lds
s_waitcnt vmcnt(15)
s_barrier
v_and_b32 v212, 31, v1
v_lshlrev_b32 v212, 2, v212
buffer_load_dword v213, v212, s[24:27], 0 offen sc1
s_add_u32 s53, s7, 6
s_and_b32 s53, s53, 7
s_mul_i32 s53, s53, 196608
s_add_u32 m0, s36, 16384
s_add_u32 s53, s53, s33
buffer_load_dwordx4 v244, s[12:15], s53 offen offset:0 lds
buffer_load_dwordx4 v245, s[12:15], s53 offen offset:1024 lds
buffer_load_dwordx4 v246, s[12:15], s53 offen offset:2048 lds
buffer_load_dwordx4 v247, s[12:15], s53 offen offset:3072 lds
s_waitcnt vmcnt(16)
s_barrier
s_lshr_b32 s37, s2, 3
s_and_b32 s38, s37, 3
s_and_b32 s45, s2, 1
s_lshl_b32 s45, s45, 2
s_add_u32 s38, s38, s45
s_lshl_b32 s38, s38, 7
s_lshr_b32 s37, s37, 2
s_lshl_b32 s45, s37, 2
s_add_u32 s45, s45, s4
s_mul_i32 s45, s45, 56
s_add_u32 s45, s45, 0
s_lshl_b32 s45, s45, 10
s_add_u32 s45, s45, s38
v_min_u32 v10, 55, v1
v_lshlrev_b32 v10, 10, v10
buffer_load_dword v254, v10, s[64:67], s45 offen
s_lshl_b32 s45, s37, 2
s_add_u32 s45, s45, s4
s_lshl_b32 s45, s45, 14
s_add_u32 s45, s45, s38
v_and_b32 v10, 15, v1
v_lshlrev_b32 v10, 10, v10
buffer_load_dword v254, v10, s[68:71], s45 offen
s_waitcnt vmcnt(6)
v_cmp_ne_u32 vcc, 1, v213
s_nop 0
s_cmp_eq_u64 vcc, 0
s_cbranch_scc1 L_mk_D_ok
s_mov_b32 s58, 0
L_mk_D:
s_sleep 4
buffer_load_dword v213, v212, s[24:27], 0 offen sc1
s_waitcnt vmcnt(0)
v_cmp_ne_u32 vcc, 1, v213
s_nop 0
s_cmp_eq_u64 vcc, 0
s_cbranch_scc1 L_mk_D_ok
s_add_u32 s58, s58, 1
s_cmp_lt_u32 s58, 0x20000
s_cbranch_scc1 L_mk_D
L_mk_D_ok:
s_barrier
s_add_u32 s53, s7, 0
s_and_b32 s53, s53, 7
s_mul_i32 s53, s53, 229376
s_add_u32 m0, s36, 32768
s_add_u32 s53, s53, s34
buffer_load_dwordx4 v240, s[16:19], s53 offen offset:0 lds
ds_read2st64_b32 v[32:33], v6 offset0:24 offset1:25
ds_read2st64_b32 v[34:35], v6 offset0:26 offset1:27
buffer_load_dwordx4 v241, s[16:19], s53 offen offset:1024 lds
ds_read2st64_b32 v[36:37], v6 offset0:28 offset1:29
ds_read2st64_b32 v[38:39], v6 offset0:30 offset1:31
buffer_load_dwordx4 v242, s[28:31], s53 offen offset:2048 lds
ds_read2st64_b32 v[40:41], v6 offset0:32 offset1:33
ds_read2st64_b32 v[42:43], v6 offset0:34 offset1:35
buffer_load_dwordx4 v243, s[28:31], s53 offen offset:3072 lds
ds_read2st64_b32 v[44:45], v6 offset0:36 offset1:37
ds_read2st64_b32 v[46:47], v6 offset0:38 offset1:39
s_add_u32 s53, s7, 1
s_and_b32 s53, s53, 7
s_mul_i32 s53, s53, 229376
s_add_u32 m0, s36, 49152
s_add_u32 s53, s53, s34
buffer_load_dwordx4 v240, s[16:19], s53 offen offset:0 lds
s_waitcnt lgkmcnt(0)
s_setprio 2
buffer_load_dwordx4 v241, s[16:19], s53 offen offset:1024 lds
v_mfma_f32_32x32x16_bf16 v[48:63], v[16:19], v[32:35], 0
v_mfma_f32_32x32x16_bf16 v[64:79], v[20:23], v[36:39], 0
buffer_load_dwordx4 v242, s[28:31], s53 offen offset:2048 lds
v_mfma_f32_32x32x16_bf16 v[80:95], v[24:27], v[40:43], 0
v_mfma_f32_32x32x16_bf16 v[96:111], v[28:31], v[44:47], 0
buffer_load_dwordx4 v243, s[28:31], s53 offen offset:3072 lds
s_setprio 0
s_barrier
s_add_u32 s53, s7, 2
s_and_b32 s53, s53, 7
s_mul_i32 s53, s53, 229376
s_add_u32 m0, s36, 65536
s_add_u32 s53, s53, s34
buffer_load_dwordx4 v240, s[16:19], s53 offen offset:0 lds
v_max3_f32 v200, v48, v49, v50
v_max3_f32 v202, v64, v65, v66
v_max3_f32 v201, v56, v57, v58
v_max3_f32 v203, v72, v73, v74
v_max3_f32 v200, v200, v51, v52
v_max3_f32 v202, v202, v67, v68
v_max3_f32 v201, v201, v59, v60
v_max3_f32 v203, v203, v75, v76
v_max3_f32 v200, v200, v53, v54
v_max3_f32 v202, v202, v69, v70
v_max3_f32 v201, v201, v61, v62
v_max3_f32 v203, v203, v77, v78
v_max_f32 v200, v200, v55
v_max_f32 v202, v202, v71
v_max_f32 v201, v201, v63
v_max_f32 v203, v203, v79
buffer_load_dwordx4 v241, s[16:19], s53 offen offset:1024 lds
v_permlane32_swap_b32 v200, v201
v_permlane32_swap_b32 v202, v203
v_max_f32 v200, v200, v201
v_max_f32 v202, v202, v203
v_mul_f32 v200, v200, v204
v_mul_f32 v202, v202, v204
v_mov_b32 v201, v200
v_mov_b32 v203, v202
s_nop 0
v_permlane32_swap_b32 v200, v201
v_permlane32_swap_b32 v202, v203
v_fma_f32 v48, v48, v204, -v200
v_fma_f32 v64, v64, v204, -v202
v_fma_f32 v49, v49, v204, -v200
v_fma_f32 v65, v65, v204, -v202
v_fma_f32 v50, v50, v204, -v200
v_fma_f32 v66, v66, v204, -v202
buffer_load_dwordx4 v242, s[28:31], s53 offen offset:2048 lds
v_fma_f32 v51, v51, v204, -v200
v_fma_f32 v67, v67, v204, -v202
v_fma_f32 v52, v52, v204, -v200
v_fma_f32 v68, v68, v204, -v202
v_fma_f32 v53, v53, v204, -v200
v_fma_f32 v69, v69, v204, -v202
v_fma_f32 v54, v54, v204, -v200
v_fma_f32 v70, v70, v204, -v202
v_fma_f32 v55, v55, v204, -v200
v_fma_f32 v71, v71, v204, -v202
v_fma_f32 v56, v56, v204, -v201
v_fma_f32 v72, v72, v204, -v203
v_fma_f32 v57, v57, v204, -v201
v_fma_f32 v73, v73, v204, -v203
v_fma_f32 v58, v58, v204, -v201
v_fma_f32 v74, v74, v204, -v203
buffer_load_dwordx4 v243, s[28:31], s53 offen offset:3072 lds
v_fma_f32 v59, v59, v204, -v201
v_fma_f32 v75, v75, v204, -v203
v_fma_f32 v60, v60, v204, -v201
v_fma_f32 v76, v76, v204, -v203
v_fma_f32 v61, v61, v204, -v201
v_fma_f32 v77, v77, v204, -v203
v_fma_f32 v62, v62, v204, -v201
v_fma_f32 v78, v78, v204, -v203
v_fma_f32 v63, v63, v204, -v201
v_fma_f32 v79, v79, v204, -v203
v_exp_f32 v48, v48
v_exp_f32 v64, v64
v_exp_f32 v49, v49
v_exp_f32 v65, v65
s_waitcnt vmcnt(14)
s_barrier
s_add_u32 s53, s7, 3
s_and_b32 s53, s53, 7
s_mul_i32 s53, s53, 229376
s_add_u32 m0, s36, 81920
s_add_u32 s53, s53, s34
buffer_load_dwordx4 v240, s[16:19], s53 offen offset:0 lds
v_exp_f32 v50, v50
v_exp_f32 v66, v66
v_exp_f32 v51, v51
v_exp_f32 v67, v67
v_exp_f32 v52, v52
v_exp_f32 v68, v68
v_exp_f32 v53, v53
v_exp_f32 v69, v69
v_exp_f32 v54, v54
v_exp_f32 v70, v70
v_exp_f32 v55, v55
v_exp_f32 v71, v71
buffer_load_dwordx4 v241, s[16:19], s53 offen offset:1024 lds
v_exp_f32 v56, v56
v_exp_f32 v72, v72
v_exp_f32 v57, v57
v_exp_f32 v73, v73
v_exp_f32 v58, v58
v_exp_f32 v74, v74
v_exp_f32 v59, v59
v_exp_f32 v75, v75
v_exp_f32 v60, v60
v_exp_f32 v76, v76
v_exp_f32 v61, v61
v_exp_f32 v77, v77
buffer_load_dwordx4 v242, s[28:31], s53 offen offset:2048 lds
v_exp_f32 v62, v62
v_exp_f32 v78, v78
v_exp_f32 v63, v63
v_exp_f32 v79, v79
v_add_f32 v200, v48, v49
v_add_f32 v202, v64, v65
v_add_f32 v201, v56, v57
v_add_f32 v203, v72, v73
v_add_f32 v200, v200, v50
v_add_f32 v202, v202, v66
v_add_f32 v201, v201, v58
v_add_f32 v203, v203, v74
buffer_load_dwordx4 v243, s[28:31], s53 offen offset:3072 lds
v_add_f32 v200, v200, v51
v_add_f32 v202, v202, v67
v_add_f32 v201, v201, v59
v_add_f32 v203, v203, v75
v_add_f32 v200, v200, v52
v_add_f32 v202, v202, v68
v_add_f32 v201, v201, v60
v_add_f32 v203, v203, v76
v_add_f32 v200, v200, v53
v_add_f32 v202, v202, v69
s_waitcnt vmcnt(12)
s_barrier
s_and_b32 s45, s5, 7
s_lshl_b32 s45, s45, 2
s_add_u32 s45, s45, s4
s_mul_i32 s45, s45, 57344
s_add_u32 s45, s45, s43
v_and_b32 v10, 15, v1
v_mul_u32_u24 v10, 3584, v10
buffer_load_dword v254, v10, s[16:19], s45 offen
buffer_load_dword v254, v10, s[28:31], s45 offen offset:2048
v_add_f32 v201, v201, v61
v_add_f32 v203, v203, v77
v_add_f32 v200, v200, v54
v_add_f32 v202, v202, v70
v_add_f32 v201, v201, v62
v_add_f32 v203, v203, v78
v_add_f32 v200, v200, v55
v_add_f32 v202, v202, v71
v_add_f32 v201, v201, v63
v_add_f32 v203, v203, v79
s_nop 0
v_permlane32_swap_b32 v200, v201
v_permlane32_swap_b32 v202, v203
v_add_f32 v200, v200, v201
v_add_f32 v202, v202, v203
v_rcp_f32 v200, v200
v_rcp_f32 v202, v202
v_mul_f32 v200, v200, v15
v_mul_f32 v202, v202, v15
v_mov_b32 v201, v200
v_mov_b32 v203, v202
s_nop 0
v_permlane32_swap_b32 v200, v201
v_permlane32_swap_b32 v202, v203
v_mul_f32 v48, v48, v200
v_mul_f32 v64, v64, v202
v_mul_f32 v49, v49, v200
v_mul_f32 v65, v65, v202
v_mul_f32 v50, v50, v200
v_mul_f32 v66, v66, v202
v_mul_f32 v51, v51, v200
v_mul_f32 v67, v67, v202
v_mul_f32 v52, v52, v200
v_mul_f32 v68, v68, v202
v_mul_f32 v53, v53, v200
v_mul_f32 v69, v69, v202
v_mul_f32 v54, v54, v200
v_mul_f32 v70, v70, v202
v_mul_f32 v55, v55, v200
v_mul_f32 v71, v71, v202
v_mul_f32 v56, v56, v201
v_mul_f32 v72, v72, v203
v_mul_f32 v57, v57, v201
v_mul_f32 v73, v73, v203
v_mul_f32 v58, v58, v201
v_mul_f32 v74, v74, v203
v_mul_f32 v59, v59, v201
v_mul_f32 v75, v75, v203
v_mul_f32 v60, v60, v201
v_mul_f32 v76, v76, v203
v_mul_f32 v61, v61, v201
v_mul_f32 v77, v77, v203
v_mul_f32 v62, v62, v201
v_mul_f32 v78, v78, v203
v_mul_f32 v63, v63, v201
v_mul_f32 v79, v79, v203
v_cvt_pk_bf16_f32 v48, v48, v49
v_cvt_pk_bf16_f32 v64, v64, v65
v_cvt_pk_bf16_f32 v49, v50, v51
v_cvt_pk_bf16_f32 v65, v66, v67
v_cvt_pk_bf16_f32 v50, v52, v53
v_cvt_pk_bf16_f32 v66, v68, v69
v_cvt_pk_bf16_f32 v51, v54, v55
v_cvt_pk_bf16_f32 v67, v70, v71
v_cvt_pk_bf16_f32 v52, v56, v57
v_cvt_pk_bf16_f32 v68, v72, v73
v_cvt_pk_bf16_f32 v53, v58, v59
v_cvt_pk_bf16_f32 v69, v74, v75
v_cvt_pk_bf16_f32 v54, v60, v61
v_cvt_pk_bf16_f32 v70, v76, v77
v_cvt_pk_bf16_f32 v55, v62, v63
v_cvt_pk_bf16_f32 v71, v78, v79
ds_write_b64 v205, v[48:49] offset:0
s_waitcnt vmcnt(10)
s_barrier
s_add_u32 s53, s7, 4
s_and_b32 s53, s53, 7
s_mul_i32 s53, s53, 229376
s_add_u32 m0, s36, 0
s_add_u32 s53, s53, s34
buffer_load_dwordx4 v240, s[16:19], s53 offen offset:0 lds
v_max3_f32 v200, v80, v81, v82
v_max3_f32 v202, v96, v97, v98
v_max3_f32 v201, v88, v89, v90
v_max3_f32 v203, v104, v105, v106
v_max3_f32 v200, v200, v83, v84
v_max3_f32 v202, v202, v99, v100
buffer_load_dwordx4 v241, s[16:19], s53 offen offset:1024 lds
v_max3_f32 v201, v201, v91, v92
v_max3_f32 v203, v203, v107, v108
v_max3_f32 v200, v200, v85, v86
v_max3_f32 v202, v202, v101, v102
v_max3_f32 v201, v201, v93, v94
v_max3_f32 v203, v203, v109, v110
buffer_load_dwordx4 v242, s[28:31], s53 offen offset:2048 lds
v_max_f32 v200, v200, v87
v_max_f32 v202, v202, v103
v_max_f32 v201, v201, v95
v_max_f32 v203, v203, v111
s_nop 0
v_permlane32_swap_b32 v200, v201
v_permlane32_swap_b32 v202, v203
buffer_load_dwordx4 v243, s[28:31], s53 offen offset:3072 lds
v_max_f32 v200, v200, v201
ds_write_b64 v205, v[50:51] offset:16
v_max_f32 v202, v202, v203
v_mul_f32 v200, v200, v204
v_mul_f32 v202, v202, v204
v_mov_b32 v201, v200
s_add_u32 s53, s7, 5
s_and_b32 s53, s53, 7
s_mul_i32 s53, s53, 229376
s_add_u32 m0, s36, 16384
s_add_u32 s53, s53, s34
buffer_load_dwordx4 v240, s[16:19], s53 offen offset:0 lds
v_mov_b32 v203, v202
v_permlane32_swap_b32 v200, v201
s_nop 0
v_permlane32_swap_b32 v202, v203
v_fma_f32 v80, v80, v204, -v200
v_fma_f32 v96, v96, v204, -v202
v_fma_f32 v81, v81, v204, -v200
buffer_load_dwordx4 v241, s[16:19], s53 offen offset:1024 lds
v_fma_f32 v97, v97, v204, -v202
v_fma_f32 v82, v82, v204, -v200
v_fma_f32 v98, v98, v204, -v202
v_fma_f32 v83, v83, v204, -v200
v_fma_f32 v99, v99, v204, -v202
v_fma_f32 v84, v84, v204, -v200
buffer_load_dwordx4 v242, s[28:31], s53 offen offset:2048 lds
v_fma_f32 v100, v100, v204, -v202
v_fma_f32 v85, v85, v204, -v200
v_fma_f32 v101, v101, v204, -v202
ds_write_b64 v205, v[52:53] offset:32
v_fma_f32 v86, v86, v204, -v200
buffer_load_dwordx4 v243, s[28:31], s53 offen offset:3072 lds
s_waitcnt vmcnt(14)
s_barrier
s_add_u32 s53, s7, 6
s_and_b32 s53, s53, 7
s_mul_i32 s53, s53, 229376
s_add_u32 m0, s36, 32768
s_add_u32 s53, s53, s34
buffer_load_dwordx4 v240, s[16:19], s53 offen offset:0 lds
v_fma_f32 v102, v102, v204, -v202
v_fma_f32 v87, v87, v204, -v200
v_fma_f32 v103, v103, v204, -v202
v_fma_f32 v88, v88, v204, -v201
v_fma_f32 v104, v104, v204, -v203
v_fma_f32 v89, v89, v204, -v201
v_fma_f32 v105, v105, v204, -v203
v_fma_f32 v90, v90, v204, -v201
v_fma_f32 v106, v106, v204, -v203
v_fma_f32 v91, v91, v204, -v201
v_fma_f32 v107, v107, v204, -v203
buffer_load_dwordx4 v241, s[16:19], s53 offen offset:1024 lds
v_fma_f32 v92, v92, v204, -v201
v_fma_f32 v108, v108, v204, -v203
v_fma_f32 v93, v93, v204, -v201
v_fma_f32 v109, v109, v204, -v203
v_fma_f32 v94, v94, v204, -v201
v_fma_f32 v110, v110, v204, -v203
v_fma_f32 v95, v95, v204, -v201
ds_write_b64 v205, v[54:55] offset:48
v_fma_f32 v111, v111, v204, -v203
v_exp_f32 v80, v80
v_exp_f32 v96, v96
buffer_load_dwordx4 v242, s[28:31], s53 offen offset:2048 lds
v_exp_f32 v81, v81
v_exp_f32 v97, v97
v_exp_f32 v82, v82
v_exp_f32 v98, v98
v_exp_f32 v83, v83
v_exp_f32 v99, v99
v_exp_f32 v84, v84
v_exp_f32 v100, v100
v_exp_f32 v85, v85
v_exp_f32 v101, v101
v_exp_f32 v86, v86
buffer_load_dwordx4 v243, s[28:31], s53 offen offset:3072 lds
v_exp_f32 v102, v102
v_exp_f32 v87, v87
v_exp_f32 v103, v103
v_exp_f32 v88, v88
v_exp_f32 v104, v104
ds_write_b64 v205, v[64:65] offset:2304
v_exp_f32 v89, v89
v_exp_f32 v105, v105
v_exp_f32 v90, v90
v_exp_f32 v106, v106
s_waitcnt vmcnt(14)
s_barrier
s_add_u32 s53, s7, 7
s_and_b32 s53, s53, 7
s_mul_i32 s53, s53, 229376
s_add_u32 m0, s36, 49152
s_add_u32 s53, s53, s34
buffer_load_dwordx4 v240, s[16:19], s53 offen offset:0 lds
v_exp_f32 v91, v91
v_exp_f32 v107, v107
v_exp_f32 v92, v92
v_exp_f32 v108, v108
v_exp_f32 v93, v93
v_exp_f32 v109, v109
v_exp_f32 v94, v94
v_exp_f32 v110, v110
v_exp_f32 v95, v95
v_exp_f32 v111, v111
v_add_f32 v200, v80, v81
v_add_f32 v202, v96, v97
v_add_f32 v201, v88, v89
buffer_load_dwordx4 v241, s[16:19], s53 offen offset:1024 lds
v_add_f32 v203, v104, v105
v_add_f32 v200, v200, v82
ds_write_b64 v205, v[66:67] offset:2320
v_add_f32 v202, v202, v98
v_add_f32 v201, v201, v90
v_add_f32 v203, v203, v106
v_add_f32 v200, v200, v83
v_add_f32 v202, v202, v99
v_add_f32 v201, v201, v91
v_add_f32 v203, v203, v107
v_add_f32 v200, v200, v84
v_add_f32 v202, v202, v100
v_add_f32 v201, v201, v92
buffer_load_dwordx4 v242, s[28:31], s53 offen offset:2048 lds
v_add_f32 v203, v203, v108
v_add_f32 v200, v200, v85
v_add_f32 v202, v202, v101
v_add_f32 v201, v201, v93
v_add_f32 v203, v203, v109
v_add_f32 v200, v200, v86
v_add_f32 v202, v202, v102
v_add_f32 v201, v201, v94
v_add_f32 v203, v203, v110
ds_write_b64 v205, v[68:69] offset:2336
v_add_f32 v200, v200, v87
v_add_f32 v202, v202, v103
v_add_f32 v201, v201, v95
buffer_load_dwordx4 v243, s[28:31], s53 offen offset:3072 lds
v_add_f32 v203, v203, v111
v_permlane32_swap_b32 v200, v201
s_nop 0
v_permlane32_swap_b32 v202, v203
v_add_f32 v200, v200, v201
v_add_f32 v202, v202, v203
v_rcp_f32 v200, v200
v_rcp_f32 v202, v202
v_mul_f32 v200, v200, v15
v_mul_f32 v202, v202, v15
v_mov_b32 v201, v200
v_mov_b32 v203, v202
s_nop 0
v_permlane32_swap_b32 v200, v201
v_permlane32_swap_b32 v202, v203
s_waitcnt vmcnt(12)
s_barrier
s_add_u32 s53, s7, 0
s_and_b32 s53, s53, 7
s_mul_i32 s53, s53, 229376
s_add_u32 m0, s36, 65536
s_add_u32 s53, s53, s35
buffer_load_dwordx4 v248, s[16:19], s53 offen offset:0 lds
v_mul_f32 v80, v80, v200
v_mul_f32 v96, v96, v202
v_mul_f32 v81, v81, v200
ds_write_b64 v205, v[70:71] offset:2352
v_mul_f32 v97, v97, v202
v_mul_f32 v82, v82, v200
v_mul_f32 v98, v98, v202
v_mul_f32 v83, v83, v200
v_mul_f32 v99, v99, v202
v_mul_f32 v84, v84, v200
v_mul_f32 v100, v100, v202
v_mul_f32 v85, v85, v200
v_mul_f32 v101, v101, v202
v_mul_f32 v86, v86, v200
buffer_load_dwordx4 v249, s[28:31], s53 offen offset:1024 lds
v_mul_f32 v102, v102, v202
v_mul_f32 v87, v87, v200
v_mul_f32 v103, v103, v202
v_mul_f32 v88, v88, v201
v_mul_f32 v104, v104, v203
v_mul_f32 v89, v89, v201
v_mul_f32 v105, v105, v203
v_mul_f32 v90, v90, v201
v_mul_f32 v106, v106, v203
v_mul_f32 v91, v91, v201
v_mul_f32 v107, v107, v203
v_mul_f32 v92, v92, v201
v_mul_f32 v108, v108, v203
v_mul_f32 v93, v93, v201
buffer_load_dwordx4 v250, s[16:19], s53 offen offset:2048 lds
v_mul_f32 v109, v109, v203
v_mul_f32 v94, v94, v201
v_mul_f32 v110, v110, v203
v_mul_f32 v95, v95, v201
v_mul_f32 v111, v111, v203
v_cvt_pk_bf16_f32 v80, v80, v81
v_cvt_pk_bf16_f32 v96, v96, v97
v_cvt_pk_bf16_f32 v81, v82, v83
v_cvt_pk_bf16_f32 v97, v98, v99
v_cvt_pk_bf16_f32 v82, v84, v85
v_cvt_pk_bf16_f32 v98, v100, v101
v_cvt_pk_bf16_f32 v83, v86, v87
v_cvt_pk_bf16_f32 v99, v102, v103
v_cvt_pk_bf16_f32 v84, v88, v89
buffer_load_dwordx4 v251, s[28:31], s53 offen offset:3072 lds
v_cvt_pk_bf16_f32 v100, v104, v105
v_cvt_pk_bf16_f32 v85, v90, v91
v_cvt_pk_bf16_f32 v101, v106, v107
v_cvt_pk_bf16_f32 v86, v92, v93
v_cvt_pk_bf16_f32 v102, v108, v109
v_cvt_pk_bf16_f32 v87, v94, v95
v_cvt_pk_bf16_f32 v103, v110, v111
ds_write_b64 v205, v[80:81] offset:4608
ds_write_b64 v205, v[82:83] offset:4624
ds_write_b64 v205, v[84:85] offset:4640
ds_write_b64 v205, v[86:87] offset:4656
s_waitcnt vmcnt(12)
s_barrier
s_add_u32 s53, s7, 2
s_and_b32 s53, s53, 7
s_mul_i32 s53, s53, 229376
s_add_u32 m0, s36, 81920
s_add_u32 s53, s53, s35
buffer_load_dwordx4 v248, s[16:19], s53 offen offset:0 lds
ds_write_b64 v205, v[96:97] offset:6912
ds_write_b64 v205, v[98:99] offset:6928
buffer_load_dwordx4 v249, s[28:31], s53 offen offset:1024 lds
ds_write_b64 v205, v[100:101] offset:6944
ds_write_b64 v205, v[102:103] offset:6960
buffer_load_dwordx4 v250, s[16:19], s53 offen offset:2048 lds
s_waitcnt lgkmcnt(0)
buffer_load_dwordx4 v251, s[28:31], s53 offen offset:3072 lds
s_waitcnt vmcnt(12)
s_barrier
ds_read_b64_tr_b16 v[48:49], v206 offset:0
ds_read_b64_tr_b16 v[50:51], v206 offset:576
ds_read2st64_b32 v[52:53], v207 offset0:0 offset1:1
ds_read2st64_b32 v[54:55], v207 offset0:2 offset1:3
ds_read_b64_tr_b16 v[56:57], v206 offset:1152
ds_read_b64_tr_b16 v[58:59], v206 offset:1728
ds_read2st64_b32 v[60:61], v207 offset0:4 offset1:5
ds_read2st64_b32 v[62:63], v207 offset0:6 offset1:7
ds_read_b64_tr_b16 v[64:65], v206 offset:15360
ds_read_b64_tr_b16 v[66:67], v206 offset:15936
ds_read2st64_b32 v[68:69], v207 offset0:60 offset1:61
ds_read2st64_b32 v[70:71], v207 offset0:62 offset1:63
ds_read_b64_tr_b16 v[72:73], v206 offset:16512
ds_read_b64_tr_b16 v[74:75], v206 offset:17088
ds_read2st64_b32 v[76:77], v207 offset0:64 offset1:65
ds_read2st64_b32 v[78:79], v207 offset0:66 offset1:67
ds_read_b64_tr_b16 v[80:81], v206 offset:30720
ds_read_b64_tr_b16 v[82:83], v206 offset:31296
ds_read2st64_b32 v[84:85], v207 offset0:120 offset1:121
ds_read2st64_b32 v[86:87], v207 offset0:122 offset1:123
ds_read_b64_tr_b16 v[88:89], v206 offset:31872
ds_read_b64_tr_b16 v[90:91], v206 offset:32448
ds_read2st64_b32 v[92:93], v207 offset0:124 offset1:125
ds_read2st64_b32 v[94:95], v207 offset0:126 offset1:127
ds_read_b64_tr_b16 v[96:97], v206 offset:46080
ds_read_b64_tr_b16 v[98:99], v206 offset:46656
ds_read2st64_b32 v[100:101], v207 offset0:180 offset1:181
ds_read2st64_b32 v[102:103], v207 offset0:182 offset1:183
ds_read_b64_tr_b16 v[104:105], v206 offset:47232
ds_read_b64_tr_b16 v[106:107], v206 offset:47808
ds_read2st64_b32 v[108:109], v207 offset0:184 offset1:185
ds_read2st64_b32 v[110:111], v207 offset0:186 offset1:187
s_waitcnt lgkmcnt(0)
s_waitcnt vmcnt(8)
s_barrier
s_add_u32 s53, s7, 4
s_and_b32 s53, s53, 7
s_mul_i32 s53, s53, 229376
s_add_u32 m0, s36, 16384
s_add_u32 s53, s53, s35
buffer_load_dwordx4 v248, s[16:19], s53 offen offset:0 lds
s_setprio 2
v_mfma_f32_32x32x16_bf16 v[32:47], v[48:51], v[52:55], 0
v_mfma_f32_32x32x16_bf16 v[32:47], v[56:59], v[60:63], v[32:47]
v_mfma_f32_32x32x16_bf16 v[32:47], v[64:67], v[68:71], v[32:47]
buffer_load_dwordx4 v249, s[28:31], s53 offen offset:1024 lds
v_mfma_f32_32x32x16_bf16 v[32:47], v[72:75], v[76:79], v[32:47]
v_mfma_f32_32x32x16_bf16 v[32:47], v[80:83], v[84:87], v[32:47]
v_mfma_f32_32x32x16_bf16 v[32:47], v[88:91], v[92:95], v[32:47]
v_mfma_f32_32x32x16_bf16 v[32:47], v[96:99], v[100:103], v[32:47]
buffer_load_dwordx4 v250, s[16:19], s53 offen offset:2048 lds
v_mfma_f32_32x32x16_bf16 v[32:47], v[104:107], v[108:111], v[32:47]
s_setprio 0
s_nop 10
v_cvt_pk_bf16_f32 v48, v32, v33
v_cvt_pk_bf16_f32 v49, v34, v35
buffer_load_dwordx4 v251, s[28:31], s53 offen offset:3072 lds
v_cvt_pk_bf16_f32 v50, v36, v37
v_cvt_pk_bf16_f32 v51, v38, v39
v_cvt_pk_bf16_f32 v52, v40, v41
s_waitcnt vmcnt(8)
s_barrier
v_cvt_pk_bf16_f32 v53, v42, v43
v_cvt_pk_bf16_f32 v54, v44, v45
v_cvt_pk_bf16_f32 v55, v46, v47
buffer_store_dwordx4 v[48:51], v208, s[20:23], 0 offen sc1
buffer_store_dwordx4 v[52:55], v209, s[20:23], 0 offen sc1
s_waitcnt vmcnt(6)
s_barrier
s_add_u32 s53, s7, 6
s_and_b32 s53, s53, 7
s_mul_i32 s53, s53, 229376
s_add_u32 m0, s36, 32768
s_add_u32 s53, s53, s35
buffer_load_dwordx4 v248, s[16:19], s53 offen offset:0 lds
s_lshl_b32 s44, s4, 12
s_add_u32 s44, s44, 65536
v_lshl_add_u32 v6, v1, 2, s44
s_lshl_b32 s57, s6, 12
s_add_u32 s57, s57, s55
ds_read2st64_b32 v[16:17], v6 offset0:0 offset1:1
ds_read2st64_b32 v[18:19], v6 offset0:2 offset1:3
ds_read2st64_b32 v[20:21], v6 offset0:4 offset1:5
ds_read2st64_b32 v[22:23], v6 offset0:6 offset1:7
buffer_load_dwordx4 v249, s[28:31], s53 offen offset:1024 lds
ds_read2st64_b32 v[24:25], v6 offset0:8 offset1:9
ds_read2st64_b32 v[26:27], v6 offset0:10 offset1:11
ds_read2st64_b32 v[28:29], v6 offset0:12 offset1:13
ds_read2st64_b32 v[30:31], v6 offset0:14 offset1:15
s_waitcnt lgkmcnt(4)
v_lshlrev_b32 v32, 16, v16
v_and_b32 v33, v9, v16
v_lshlrev_b32 v34, 16, v17
v_and_b32 v35, v9, v17
buffer_load_dwordx4 v250, s[16:19], s53 offen offset:2048 lds
v_lshlrev_b32 v36, 16, v18
v_and_b32 v37, v9, v18
v_lshlrev_b32 v38, 16, v19
v_and_b32 v39, v9, v19
v_lshlrev_b32 v40, 16, v20
v_and_b32 v41, v9, v20
v_lshlrev_b32 v42, 16, v21
v_and_b32 v43, v9, v21
v_lshlrev_b32 v44, 16, v22
buffer_load_dwordx4 v251, s[28:31], s53 offen offset:3072 lds
v_and_b32 v45, v9, v22
v_lshlrev_b32 v46, 16, v23
v_and_b32 v47, v9, v23
v_mul_f32 v48, v7, v32
v_mul_f32 v49, v7, v33
v_mul_f32 v50, v7, v34
v_mul_f32 v51, v7, v35
s_waitcnt vmcnt(4)
s_barrier
v_lshrrev_b32 v10, 4, v1
v_lshlrev_b32 v10, 19, v10
v_add_u32 v10, v10, v1
v_lshlrev_b32 v10, 7, v10
v_mov_b32 v11, 1
buffer_store_dword v11, v10, s[20:23], s56 offen sc1
v_mul_f32 v52, v7, v36
v_mul_f32 v53, v7, v37
v_mul_f32 v54, v7, v38
v_mul_f32 v55, v7, v39
v_exp_f32 v48, v48
v_exp_f32 v49, v49
v_exp_f32 v50, v50
v_exp_f32 v51, v51
v_exp_f32 v52, v52
v_exp_f32 v53, v53
v_exp_f32 v54, v54
v_exp_f32 v55, v55
v_mul_f32 v32, v32, v40
v_mul_f32 v33, v33, v41
v_mul_f32 v34, v34, v42
v_mul_f32 v35, v35, v43
v_mul_f32 v36, v36, v44
v_mul_f32 v37, v37, v45
v_mul_f32 v38, v38, v46
v_mul_f32 v39, v39, v47
v_fma_f32 v48, v48, v8, v8
v_fma_f32 v49, v49, v8, v8
v_fma_f32 v50, v50, v8, v8
v_fma_f32 v51, v51, v8, v8
v_fma_f32 v52, v52, v8, v8
v_fma_f32 v53, v53, v8, v8
v_fma_f32 v54, v54, v8, v8
v_fma_f32 v55, v55, v8, v8
v_rcp_f32 v48, v48
v_rcp_f32 v49, v49
v_rcp_f32 v50, v50
v_rcp_f32 v51, v51
v_rcp_f32 v52, v52
v_rcp_f32 v53, v53
v_rcp_f32 v54, v54
v_rcp_f32 v55, v55
v_mul_f32 v32, v32, v48
v_mul_f32 v33, v33, v49
v_mul_f32 v34, v34, v50
v_mul_f32 v35, v35, v51
v_mul_f32 v36, v36, v52
v_mul_f32 v37, v37, v53
v_mul_f32 v38, v38, v54
v_mul_f32 v39, v39, v55
v_cvt_pk_bf16_f32 v192, v32, v33
v_cvt_pk_bf16_f32 v193, v34, v35
v_cvt_pk_bf16_f32 v194, v36, v37
v_cvt_pk_bf16_f32 v195, v38, v39
s_add_u32 s44, s57, 65536
buffer_store_dwordx4 v[192:195], v3, s[20:23], s44 offen sc1
s_waitcnt lgkmcnt(0)
v_lshlrev_b32 v32, 16, v24
v_and_b32 v33, v9, v24
v_lshlrev_b32 v34, 16, v25
v_and_b32 v35, v9, v25
s_waitcnt vmcnt(2)
s_barrier
v_lshlrev_b32 v36, 16, v26
v_and_b32 v37, v9, v26
v_lshlrev_b32 v38, 16, v27
v_and_b32 v39, v9, v27
v_lshlrev_b32 v40, 16, v28
v_and_b32 v41, v9, v28
v_lshlrev_b32 v42, 16, v29
v_and_b32 v43, v9, v29
v_lshlrev_b32 v44, 16, v30
v_and_b32 v45, v9, v30
v_lshlrev_b32 v46, 16, v31
v_and_b32 v47, v9, v31
v_mul_f32 v48, v7, v32
v_mul_f32 v49, v7, v33
v_mul_f32 v50, v7, v34
v_mul_f32 v51, v7, v35
v_mul_f32 v52, v7, v36
v_mul_f32 v53, v7, v37
v_mul_f32 v54, v7, v38
v_mul_f32 v55, v7, v39
v_exp_f32 v48, v48
v_exp_f32 v49, v49
v_exp_f32 v50, v50
v_exp_f32 v51, v51
v_exp_f32 v52, v52
v_exp_f32 v53, v53
v_exp_f32 v54, v54
v_exp_f32 v55, v55
v_mul_f32 v32, v32, v40
v_mul_f32 v33, v33, v41
v_mul_f32 v34, v34, v42
v_mul_f32 v35, v35, v43
v_mul_f32 v36, v36, v44
v_mul_f32 v37, v37, v45
v_mul_f32 v38, v38, v46
v_mul_f32 v39, v39, v47
v_fma_f32 v48, v48, v8, v8
v_fma_f32 v49, v49, v8, v8
v_fma_f32 v50, v50, v8, v8
v_fma_f32 v51, v51, v8, v8
v_fma_f32 v52, v52, v8, v8
v_fma_f32 v53, v53, v8, v8
v_fma_f32 v54, v54, v8, v8
v_fma_f32 v55, v55, v8, v8
v_rcp_f32 v48, v48
v_rcp_f32 v49, v49
v_rcp_f32 v50, v50
v_rcp_f32 v51, v51
v_rcp_f32 v52, v52
v_rcp_f32 v53, v53
v_rcp_f32 v54, v54
v_rcp_f32 v55, v55
v_mul_f32 v32, v32, v48
v_mul_f32 v33, v33, v49
v_mul_f32 v34, v34, v50
v_mul_f32 v35, v35, v51
v_mul_f32 v36, v36, v52
v_mul_f32 v37, v37, v53
v_mul_f32 v38, v38, v54
v_mul_f32 v39, v39, v55
v_cvt_pk_bf16_f32 v196, v32, v33
v_cvt_pk_bf16_f32 v197, v34, v35
v_cvt_pk_bf16_f32 v198, v36, v37
v_cvt_pk_bf16_f32 v199, v38, v39
s_add_u32 s44, s57, 66560
buffer_store_dwordx4 v[196:199], v3, s[20:23], s44 offen sc1
s_waitcnt lgkmcnt(0)
s_barrier
s_load_dwordx16 s[28:43], s[50:51], 0 glc
s_waitcnt lgkmcnt(0)
s_min_u32 s12, s32, s33
s_min_u32 s12, s12, s40
s_min_u32 s12, s12, s41
s_sub_u32 s13, s12, 1
s_cmp_ge_i32 s13, 0
s_cbranch_scc1 L_pf_hD_0_ok
s_mov_b32 s58, 0
L_pf_hD_0:
s_load_dwordx16 s[28:43], s[50:51], 0 glc
s_waitcnt lgkmcnt(0)
s_min_u32 s12, s32, s33
s_min_u32 s12, s12, s40
s_min_u32 s12, s12, s41
s_sub_u32 s13, s12, 1
s_cmp_ge_i32 s13, 0
s_cbranch_scc1 L_pf_hD_0_ok
s_sleep 1
s_add_u32 s58, s58, 1
s_cmp_lt_u32 s58, 0x20000
s_cbranch_scc1 L_pf_hD_0
L_pf_hD_0_ok:
s_add_u32 s62, s0, 0
s_add_u32 s63, s0, 147456
buffer_load_dwordx4 v[64:67], v3, s[20:23], s62 offen sc1
buffer_load_dwordx4 v[68:71], v3, s[20:23], s63 offen sc1
s_add_u32 s62, s0, 1024
s_add_u32 s63, s0, 148480
buffer_load_dwordx4 v[72:75], v3, s[20:23], s62 offen sc1
buffer_load_dwordx4 v[76:79], v3, s[20:23], s63 offen sc1
s_add_u32 s62, s0, 2048
s_add_u32 s63, s0, 149504
buffer_load_dwordx4 v[80:83], v3, s[20:23], s62 offen sc1
buffer_load_dwordx4 v[84:87], v3, s[20:23], s63 offen sc1
s_add_u32 s62, s0, 3072
s_add_u32 s63, s0, 150528
buffer_load_dwordx4 v[88:91], v3, s[20:23], s62 offen sc1
buffer_load_dwordx4 v[92:95], v3, s[20:23], s63 offen sc1
ds_read_b64_tr_b16 v[16:17], v4 offset:0
ds_read_b64_tr_b16 v[18:19], v4 offset:1024
ds_read_b64_tr_b16 v[20:21], v5 offset:0
ds_read_b64_tr_b16 v[22:23], v5 offset:1024
s_waitcnt vmcnt(8)
v_mov_b32 v11, 1
buffer_store_dword v11, v12, s[20:23], s47 offen sc1
s_add_u32 s62, s0, 8192
s_add_u32 s63, s0, 155648
buffer_load_dwordx4 v[96:99], v3, s[20:23], s62 offen sc1
buffer_load_dwordx4 v[100:103], v3, s[20:23], s63 offen sc1
ds_read_b64_tr_b16 v[24:25], v4 offset:2048
ds_read_b64_tr_b16 v[26:27], v4 offset:3072
ds_read_b64_tr_b16 v[28:29], v5 offset:2048
ds_read_b64_tr_b16 v[30:31], v5 offset:3072
s_waitcnt lgkmcnt(4)
s_waitcnt vmcnt(9)
v_mfma_f32_32x32x16_bf16 v[192:207], v[16:19], v[64:67], 0
v_mfma_f32_32x32x16_bf16 v[224:239], v[16:19], v[68:71], 0
v_mfma_f32_32x32x16_bf16 v[208:223], v[20:23], v[64:67], 0
v_mfma_f32_32x32x16_bf16 v[240:255], v[20:23], v[68:71], 0
s_add_u32 s62, s0, 9216
s_add_u32 s63, s0, 156672
buffer_load_dwordx4 v[104:107], v3, s[20:23], s62 offen sc1
buffer_load_dwordx4 v[108:111], v3, s[20:23], s63 offen sc1
ds_read_b64_tr_b16 v[16:17], v4 offset:4096
ds_read_b64_tr_b16 v[18:19], v4 offset:5120
ds_read_b64_tr_b16 v[20:21], v5 offset:4096
ds_read_b64_tr_b16 v[22:23], v5 offset:5120
s_waitcnt lgkmcnt(4)
s_waitcnt vmcnt(9)
v_mfma_f32_32x32x16_bf16 v[192:207], v[24:27], v[72:75], v[192:207]
v_mfma_f32_32x32x16_bf16 v[224:239], v[24:27], v[76:79], v[224:239]
v_mfma_f32_32x32x16_bf16 v[208:223], v[28:31], v[72:75], v[208:223]
v_mfma_f32_32x32x16_bf16 v[240:255], v[28:31], v[76:79], v[240:255]
s_add_u32 s62, s0, 10240
s_add_u32 s63, s0, 157696
buffer_load_dwordx4 v[112:115], v3, s[20:23], s62 offen sc1
buffer_load_dwordx4 v[116:119], v3, s[20:23], s63 offen sc1
ds_read_b64_tr_b16 v[24:25], v4 offset:6144
ds_read_b64_tr_b16 v[26:27], v4 offset:7168
ds_read_b64_tr_b16 v[28:29], v5 offset:6144
ds_read_b64_tr_b16 v[30:31], v5 offset:7168
s_waitcnt lgkmcnt(4)
s_add_u32 s62, s54, 65536
s_add_u32 m0, s52, 0
s_add_u32 s63, s62, 7168
buffer_load_dwordx4 v2, s[64:67], s62 offen lds
buffer_load_dwordx4 v2, s[64:67], s63 offen offset:1024 lds
s_waitcnt vmcnt(11)
v_mfma_f32_32x32x16_bf16 v[192:207], v[16:19], v[80:83], v[192:207]
v_mfma_f32_32x32x16_bf16 v[224:239], v[16:19], v[84:87], v[224:239]
v_mfma_f32_32x32x16_bf16 v[208:223], v[20:23], v[80:83], v[208:223]
v_mfma_f32_32x32x16_bf16 v[240:255], v[20:23], v[84:87], v[240:255]
s_add_u32 s62, s0, 11264
s_add_u32 s63, s0, 158720
buffer_load_dwordx4 v[120:123], v3, s[20:23], s62 offen sc1
buffer_load_dwordx4 v[124:127], v3, s[20:23], s63 offen sc1
ds_read_b64_tr_b16 v[16:17], v4 offset:8192
ds_read_b64_tr_b16 v[18:19], v4 offset:9216
ds_read_b64_tr_b16 v[20:21], v5 offset:8192
ds_read_b64_tr_b16 v[22:23], v5 offset:9216
s_waitcnt lgkmcnt(4)
s_load_dwordx16 s[28:43], s[50:51], 0 glc
s_add_u32 s62, s54, 81920
s_add_u32 m0, s52, 2048
s_add_u32 s63, s62, 7168
buffer_load_dwordx4 v2, s[64:67], s62 offen lds
buffer_load_dwordx4 v2, s[64:67], s63 offen offset:1024 lds
s_waitcnt vmcnt(13)
v_mfma_f32_32x32x16_bf16 v[192:207], v[24:27], v[88:91], v[192:207]
v_mfma_f32_32x32x16_bf16 v[224:239], v[24:27], v[92:95], v[224:239]
v_mfma_f32_32x32x16_bf16 v[208:223], v[28:31], v[88:91], v[208:223]
v_mfma_f32_32x32x16_bf16 v[240:255], v[28:31], v[92:95], v[240:255]
s_waitcnt lgkmcnt(0)
s_min_u32 s12, s32, s33
s_min_u32 s12, s12, s40
s_min_u32 s12, s12, s41
s_sub_u32 s13, s12, 2
s_min_u32 s12, s34, s35
s_min_u32 s12, s12, s42
s_min_u32 s12, s12, s43
s_sub_u32 s12, s12, 1
s_or_b32 s13, s13, s12
s_cmp_ge_i32 s13, 0
s_cbranch_scc1 L_pf_hD_1_ok
s_mov_b32 s58, 0
L_pf_hD_1:
s_load_dwordx16 s[28:43], s[50:51], 0 glc
s_waitcnt lgkmcnt(0)
s_min_u32 s12, s32, s33
s_min_u32 s12, s12, s40
s_min_u32 s12, s12, s41
s_sub_u32 s13, s12, 2
s_min_u32 s12, s34, s35
s_min_u32 s12, s12, s42
s_min_u32 s12, s12, s43
s_sub_u32 s12, s12, 1
s_or_b32 s13, s13, s12
s_cmp_ge_i32 s13, 0
s_cbranch_scc1 L_pf_hD_1_ok
s_sleep 1
s_add_u32 s58, s58, 1
s_cmp_lt_u32 s58, 0x20000
s_cbranch_scc1 L_pf_hD_1
L_pf_hD_1_ok:
s_add_u32 s62, s0, 4096
s_add_u32 s63, s0, 151552
buffer_load_dwordx4 v[128:131], v3, s[20:23], s62 offen sc1
buffer_load_dwordx4 v[132:135], v3, s[20:23], s63 offen sc1
ds_read_b64_tr_b16 v[24:25], v4 offset:10240
ds_read_b64_tr_b16 v[26:27], v4 offset:11264
ds_read_b64_tr_b16 v[28:29], v5 offset:10240
ds_read_b64_tr_b16 v[30:31], v5 offset:11264
s_add_u32 s62, s54, 98304
s_add_u32 m0, s52, 4096
s_add_u32 s63, s62, 7168
buffer_load_dwordx4 v2, s[64:67], s62 offen lds
buffer_load_dwordx4 v2, s[64:67], s63 offen offset:1024 lds
s_waitcnt vmcnt(14)
v_mfma_f32_32x32x16_bf16 v[192:207], v[16:19], v[96:99], v[192:207]
v_mfma_f32_32x32x16_bf16 v[224:239], v[16:19], v[100:103], v[224:239]
v_mfma_f32_32x32x16_bf16 v[208:223], v[20:23], v[96:99], v[208:223]
v_mfma_f32_32x32x16_bf16 v[240:255], v[20:23], v[100:103], v[240:255]
s_add_u32 s62, s0, 5120
s_add_u32 s63, s0, 152576
buffer_load_dwordx4 v[136:139], v3, s[20:23], s62 offen sc1
buffer_load_dwordx4 v[140:143], v3, s[20:23], s63 offen sc1
ds_read_b64_tr_b16 v[16:17], v4 offset:12288
ds_read_b64_tr_b16 v[18:19], v4 offset:13312
ds_read_b64_tr_b16 v[20:21], v5 offset:12288
ds_read_b64_tr_b16 v[22:23], v5 offset:13312
s_waitcnt lgkmcnt(4)
s_add_u32 s62, s54, 114688
s_add_u32 m0, s52, 6144
s_add_u32 s63, s62, 7168
buffer_load_dwordx4 v2, s[64:67], s62 offen lds
buffer_load_dwordx4 v2, s[64:67], s63 offen offset:1024 lds
s_waitcnt vmcnt(16)
v_mfma_f32_32x32x16_bf16 v[192:207], v[24:27], v[104:107], v[192:207]
v_mfma_f32_32x32x16_bf16 v[224:239], v[24:27], v[108:111], v[224:239]
v_mfma_f32_32x32x16_bf16 v[208:223], v[28:31], v[104:107], v[208:223]
v_mfma_f32_32x32x16_bf16 v[240:255], v[28:31], v[108:111], v[240:255]
s_add_u32 s62, s0, 6144
s_add_u32 s63, s0, 153600
buffer_load_dwordx4 v[144:147], v3, s[20:23], s62 offen sc1
buffer_load_dwordx4 v[148:151], v3, s[20:23], s63 offen sc1
ds_read_b64_tr_b16 v[24:25], v4 offset:14336
ds_read_b64_tr_b16 v[26:27], v4 offset:15360
ds_read_b64_tr_b16 v[28:29], v5 offset:14336
ds_read_b64_tr_b16 v[30:31], v5 offset:15360
s_waitcnt lgkmcnt(4)
s_add_u32 s62, s54, 196608
s_add_u32 m0, s52, 8192
s_add_u32 s63, s62, 7168
buffer_load_dwordx4 v2, s[64:67], s62 offen lds
buffer_load_dwordx4 v2, s[64:67], s63 offen offset:1024 lds
s_waitcnt vmcnt(18)
v_mfma_f32_32x32x16_bf16 v[192:207], v[16:19], v[112:115], v[192:207]
v_mfma_f32_32x32x16_bf16 v[224:239], v[16:19], v[116:119], v[224:239]
v_mfma_f32_32x32x16_bf16 v[208:223], v[20:23], v[112:115], v[208:223]
v_mfma_f32_32x32x16_bf16 v[240:255], v[20:23], v[116:119], v[240:255]
s_add_u32 s62, s0, 7168
s_add_u32 s63, s0, 154624
buffer_load_dwordx4 v[152:155], v3, s[20:23], s62 offen sc1
buffer_load_dwordx4 v[156:159], v3, s[20:23], s63 offen sc1
s_waitcnt vmcnt(18)
ds_read_b64_tr_b16 v[16:17], v4 offset:0
ds_read_b64_tr_b16 v[18:19], v4 offset:1024
ds_read_b64_tr_b16 v[20:21], v5 offset:0
ds_read_b64_tr_b16 v[22:23], v5 offset:1024
s_waitcnt lgkmcnt(4)
s_add_u32 s62, s54, 212992
s_add_u32 m0, s52, 10240
s_add_u32 s63, s62, 7168
buffer_load_dwordx4 v2, s[64:67], s62 offen lds
buffer_load_dwordx4 v2, s[64:67], s63 offen offset:1024 lds
s_waitcnt vmcnt(18)
v_mfma_f32_32x32x16_bf16 v[192:207], v[24:27], v[120:123], v[192:207]
v_mfma_f32_32x32x16_bf16 v[224:239], v[24:27], v[124:127], v[224:239]
v_mfma_f32_32x32x16_bf16 v[208:223], v[28:31], v[120:123], v[208:223]
v_mfma_f32_32x32x16_bf16 v[240:255], v[28:31], v[124:127], v[240:255]
s_add_u32 s62, s0, 12288
s_add_u32 s63, s0, 159744
buffer_load_dwordx4 v[160:163], v3, s[20:23], s62 offen sc1
buffer_load_dwordx4 v[164:167], v3, s[20:23], s63 offen sc1
s_waitcnt vmcnt(18)
ds_read_b64_tr_b16 v[24:25], v4 offset:2048
ds_read_b64_tr_b16 v[26:27], v4 offset:3072
ds_read_b64_tr_b16 v[28:29], v5 offset:2048
ds_read_b64_tr_b16 v[30:31], v5 offset:3072
s_waitcnt lgkmcnt(4)
s_add_u32 s62, s54, 229376
s_add_u32 m0, s52, 12288
s_add_u32 s63, s62, 7168
buffer_load_dwordx4 v2, s[64:67], s62 offen lds
buffer_load_dwordx4 v2, s[64:67], s63 offen offset:1024 lds
s_waitcnt vmcnt(18)
v_mfma_f32_32x32x16_bf16 v[192:207], v[16:19], v[128:131], v[192:207]
v_mfma_f32_32x32x16_bf16 v[224:239], v[16:19], v[132:135], v[224:239]
v_mfma_f32_32x32x16_bf16 v[208:223], v[20:23], v[128:131], v[208:223]
v_mfma_f32_32x32x16_bf16 v[240:255], v[20:23], v[132:135], v[240:255]
s_add_u32 s62, s0, 13312
s_add_u32 s63, s0, 160768
buffer_load_dwordx4 v[168:171], v3, s[20:23], s62 offen sc1
buffer_load_dwordx4 v[172:175], v3, s[20:23], s63 offen sc1
s_waitcnt vmcnt(18)
ds_read_b64_tr_b16 v[16:17], v4 offset:4096
ds_read_b64_tr_b16 v[18:19], v4 offset:5120
ds_read_b64_tr_b16 v[20:21], v5 offset:4096
ds_read_b64_tr_b16 v[22:23], v5 offset:5120
s_waitcnt lgkmcnt(4)
s_add_u32 s62, s54, 245760
s_add_u32 m0, s52, 14336
s_add_u32 s63, s62, 7168
buffer_load_dwordx4 v2, s[64:67], s62 offen lds
buffer_load_dwordx4 v2, s[64:67], s63 offen offset:1024 lds
s_waitcnt vmcnt(18)
v_mfma_f32_32x32x16_bf16 v[192:207], v[24:27], v[136:139], v[192:207]
v_mfma_f32_32x32x16_bf16 v[224:239], v[24:27], v[140:143], v[224:239]
v_mfma_f32_32x32x16_bf16 v[208:223], v[28:31], v[136:139], v[208:223]
v_mfma_f32_32x32x16_bf16 v[240:255], v[28:31], v[140:143], v[240:255]
s_add_u32 s62, s0, 14336
s_add_u32 s63, s0, 161792
buffer_load_dwordx4 v[176:179], v3, s[20:23], s62 offen sc1
buffer_load_dwordx4 v[180:183], v3, s[20:23], s63 offen sc1
s_waitcnt vmcnt(18)
ds_read_b64_tr_b16 v[24:25], v4 offset:6144
ds_read_b64_tr_b16 v[26:27], v4 offset:7168
ds_read_b64_tr_b16 v[28:29], v5 offset:6144
ds_read_b64_tr_b16 v[30:31], v5 offset:7168
s_waitcnt lgkmcnt(4)
s_add_u32 s62, s60, 1048576
s_add_u32 m0, s52, 0
s_add_u32 s63, s62, 7168
buffer_load_dwordx4 v2, s[64:67], s62 offen lds
buffer_load_dwordx4 v2, s[64:67], s63 offen offset:1024 lds
s_waitcnt vmcnt(18)
v_mfma_f32_32x32x16_bf16 v[192:207], v[16:19], v[144:147], v[192:207]
v_mfma_f32_32x32x16_bf16 v[224:239], v[16:19], v[148:151], v[224:239]
v_mfma_f32_32x32x16_bf16 v[208:223], v[20:23], v[144:147], v[208:223]
v_mfma_f32_32x32x16_bf16 v[240:255], v[20:23], v[148:151], v[240:255]
s_add_u32 s62, s0, 15360
s_add_u32 s63, s0, 162816
buffer_load_dwordx4 v[184:187], v3, s[20:23], s62 offen sc1
buffer_load_dwordx4 v[188:191], v3, s[20:23], s63 offen sc1
s_waitcnt vmcnt(18)
ds_read_b64_tr_b16 v[16:17], v4 offset:8192
ds_read_b64_tr_b16 v[18:19], v4 offset:9216
ds_read_b64_tr_b16 v[20:21], v5 offset:8192
ds_read_b64_tr_b16 v[22:23], v5 offset:9216
s_waitcnt lgkmcnt(4)
s_load_dwordx16 s[28:43], s[50:51], 0 glc
s_add_u32 s62, s60, 1064960
s_add_u32 m0, s52, 2048
s_add_u32 s63, s62, 7168
buffer_load_dwordx4 v2, s[64:67], s62 offen lds
buffer_load_dwordx4 v2, s[64:67], s63 offen offset:1024 lds
s_waitcnt vmcnt(18)
v_mfma_f32_32x32x16_bf16 v[192:207], v[24:27], v[152:155], v[192:207]
v_mfma_f32_32x32x16_bf16 v[224:239], v[24:27], v[156:159], v[224:239]
v_mfma_f32_32x32x16_bf16 v[208:223], v[28:31], v[152:155], v[208:223]
v_mfma_f32_32x32x16_bf16 v[240:255], v[28:31], v[156:159], v[240:255]
s_waitcnt lgkmcnt(0)
s_min_u32 s12, s28, s29
s_min_u32 s12, s12, s36
s_min_u32 s12, s12, s37
s_sub_u32 s13, s12, 1
s_min_u32 s12, s30, s31
s_min_u32 s12, s12, s38
s_min_u32 s12, s12, s39
s_sub_u32 s12, s12, 1
s_or_b32 s13, s13, s12
s_cmp_ge_i32 s13, 0
s_cbranch_scc1 L_pf_hD_2_ok
s_mov_b32 s58, 0
L_pf_hD_2:
s_load_dwordx16 s[28:43], s[50:51], 0 glc
s_waitcnt lgkmcnt(0)
s_min_u32 s12, s28, s29
s_min_u32 s12, s12, s36
s_min_u32 s12, s12, s37
s_sub_u32 s13, s12, 1
s_min_u32 s12, s30, s31
s_min_u32 s12, s12, s38
s_min_u32 s12, s12, s39
s_sub_u32 s12, s12, 1
s_or_b32 s13, s13, s12
s_cmp_ge_i32 s13, 0
s_cbranch_scc1 L_pf_hD_2_ok
s_sleep 1
s_add_u32 s58, s58, 1
s_cmp_lt_u32 s58, 0x20000
s_cbranch_scc1 L_pf_hD_2
L_pf_hD_2_ok:
s_add_u32 s62, s1, 65536
s_add_u32 s63, s1, 212992
buffer_load_dwordx4 v[64:67], v3, s[20:23], s62 offen sc1
buffer_load_dwordx4 v[68:71], v3, s[20:23], s63 offen sc1
s_waitcnt vmcnt(18)
ds_read_b64_tr_b16 v[24:25], v4 offset:10240
ds_read_b64_tr_b16 v[26:27], v4 offset:11264
ds_read_b64_tr_b16 v[28:29], v5 offset:10240
ds_read_b64_tr_b16 v[30:31], v5 offset:11264
s_waitcnt vmcnt(16)
v_mfma_f32_32x32x16_bf16 v[192:207], v[16:19], v[160:163], v[192:207]
v_mfma_f32_32x32x16_bf16 v[224:239], v[16:19], v[164:167], v[224:239]
v_mfma_f32_32x32x16_bf16 v[208:223], v[20:23], v[160:163], v[208:223]
v_mfma_f32_32x32x16_bf16 v[240:255], v[20:23], v[164:167], v[240:255]
s_mov_b32 s24, s100
s_mov_b32 s25, s101
s_mov_b32 s26, 0x200000
s_mov_b32 s27, 0x20000
s_lshl_b32 s44, s48, 1
s_lshr_b32 s45, s3, 2
s_add_u32 s44, s44, s45
s_lshl_b32 s44, s44, 15
s_lshl_b32 s45, s49, 7
s_add_u32 s44, s44, s45
s_lshl_b32 s45, s4, 5
s_add_u32 s44, s44, s45
v_and_b32 v6, 31, v1
v_lshlrev_b32 v6, 10, v6
v_lshrrev_b32 v7, 5, v1
v_lshl_add_u32 v6, v7, 4, v6
v_add_u32 v6, s44, v6
buffer_load_dwordx4 v[32:35], v6, s[8:11], 0 offen
s_add_u32 s62, s1, 66560
s_add_u32 s63, s1, 214016
buffer_load_dwordx4 v[72:75], v3, s[20:23], s62 offen sc1
buffer_load_dwordx4 v[76:79], v3, s[20:23], s63 offen sc1
s_waitcnt vmcnt(17)
ds_read_b64_tr_b16 v[16:17], v4 offset:12288
ds_read_b64_tr_b16 v[18:19], v4 offset:13312
ds_read_b64_tr_b16 v[20:21], v5 offset:12288
ds_read_b64_tr_b16 v[22:23], v5 offset:13312
s_waitcnt lgkmcnt(4)
s_waitcnt vmcnt(15)
v_mfma_f32_32x32x16_bf16 v[192:207], v[24:27], v[168:171], v[192:207]
v_mfma_f32_32x32x16_bf16 v[224:239], v[24:27], v[172:175], v[224:239]
v_mfma_f32_32x32x16_bf16 v[208:223], v[28:31], v[168:171], v[208:223]
v_mfma_f32_32x32x16_bf16 v[240:255], v[28:31], v[172:175], v[240:255]
s_waitcnt vmcnt(13)
ds_read_b64_tr_b16 v[24:25], v4 offset:14336
ds_read_b64_tr_b16 v[26:27], v4 offset:15360
ds_read_b64_tr_b16 v[28:29], v5 offset:14336
ds_read_b64_tr_b16 v[30:31], v5 offset:15360
s_waitcnt lgkmcnt(4)
s_waitcnt vmcnt(11)
v_mfma_f32_32x32x16_bf16 v[192:207], v[16:19], v[176:179], v[192:207]
v_mfma_f32_32x32x16_bf16 v[224:239], v[16:19], v[180:183], v[224:239]
v_mfma_f32_32x32x16_bf16 v[208:223], v[20:23], v[176:179], v[208:223]
v_mfma_f32_32x32x16_bf16 v[240:255], v[20:23], v[180:183], v[240:255]
s_waitcnt vmcnt(9)
ds_read_b64_tr_b16 v[16:17], v4 offset:0
ds_read_b64_tr_b16 v[18:19], v4 offset:1024
ds_read_b64_tr_b16 v[20:21], v5 offset:0
ds_read_b64_tr_b16 v[22:23], v5 offset:1024
s_waitcnt lgkmcnt(4)
s_waitcnt vmcnt(7)
v_mfma_f32_32x32x16_bf16 v[192:207], v[24:27], v[184:187], v[192:207]
v_mfma_f32_32x32x16_bf16 v[224:239], v[24:27], v[188:191], v[224:239]
v_mfma_f32_32x32x16_bf16 v[208:223], v[28:31], v[184:187], v[208:223]
v_mfma_f32_32x32x16_bf16 v[240:255], v[28:31], v[188:191], v[240:255]
s_waitcnt vmcnt(5)
ds_read_b64_tr_b16 v[24:25], v4 offset:2048
ds_read_b64_tr_b16 v[26:27], v4 offset:3072
ds_read_b64_tr_b16 v[28:29], v5 offset:2048
ds_read_b64_tr_b16 v[30:31], v5 offset:3072
s_waitcnt lgkmcnt(4)
s_waitcnt vmcnt(3)
v_mfma_f32_32x32x16_bf16 v[192:207], v[16:19], v[64:67], v[192:207]
v_mfma_f32_32x32x16_bf16 v[224:239], v[16:19], v[68:71], v[224:239]
v_mfma_f32_32x32x16_bf16 v[208:223], v[20:23], v[64:67], v[208:223]
v_mfma_f32_32x32x16_bf16 v[240:255], v[20:23], v[68:71], v[240:255]
s_waitcnt lgkmcnt(0)
s_waitcnt vmcnt(0)
v_mfma_f32_32x32x16_bf16 v[192:207], v[24:27], v[72:75], v[192:207]
v_mfma_f32_32x32x16_bf16 v[224:239], v[24:27], v[76:79], v[224:239]
v_mfma_f32_32x32x16_bf16 v[208:223], v[28:31], v[72:75], v[208:223]
v_mfma_f32_32x32x16_bf16 v[240:255], v[28:31], v[76:79], v[240:255]
s_lshl_b32 s40, s3, 11
v_lshl_add_u32 v12, v1, 2, s40
v_add_u32 v13, 0x10000, v12
v_lshl_add_u32 v7, v1, 2, s52
s_nop 4
ds_write2st64_b32 v7, v192, v193 offset0:0 offset1:1
ds_write2st64_b32 v7, v194, v195 offset0:2 offset1:3
ds_write2st64_b32 v7, v196, v197 offset0:4 offset1:5
ds_write2st64_b32 v7, v198, v199 offset0:6 offset1:7
ds_write2st64_b32 v7, v200, v201 offset0:8 offset1:9
ds_write2st64_b32 v7, v202, v203 offset0:10 offset1:11
ds_write2st64_b32 v7, v204, v205 offset0:12 offset1:13
ds_write2st64_b32 v7, v206, v207 offset0:14 offset1:15
ds_write2st64_b32 v7, v208, v209 offset0:16 offset1:17
ds_write2st64_b32 v7, v210, v211 offset0:18 offset1:19
ds_write2st64_b32 v7, v212, v213 offset0:20 offset1:21
ds_write2st64_b32 v7, v214, v215 offset0:22 offset1:23
ds_write2st64_b32 v7, v216, v217 offset0:24 offset1:25
ds_write2st64_b32 v7, v218, v219 offset0:26 offset1:27
ds_write2st64_b32 v7, v220, v221 offset0:28 offset1:29
ds_write2st64_b32 v7, v222, v223 offset0:30 offset1:31
ds_write2st64_b32 v7, v224, v225 offset0:32 offset1:33
ds_write2st64_b32 v7, v226, v227 offset0:34 offset1:35
ds_write2st64_b32 v7, v228, v229 offset0:36 offset1:37
ds_write2st64_b32 v7, v230, v231 offset0:38 offset1:39
ds_write2st64_b32 v7, v232, v233 offset0:40 offset1:41
ds_write2st64_b32 v7, v234, v235 offset0:42 offset1:43
ds_write2st64_b32 v7, v236, v237 offset0:44 offset1:45
ds_write2st64_b32 v7, v238, v239 offset0:46 offset1:47
ds_write2st64_b32 v7, v240, v241 offset0:48 offset1:49
ds_write2st64_b32 v7, v242, v243 offset0:50 offset1:51
ds_write2st64_b32 v7, v244, v245 offset0:52 offset1:53
ds_write2st64_b32 v7, v246, v247 offset0:54 offset1:55
ds_write2st64_b32 v7, v248, v249 offset0:56 offset1:57
ds_write2st64_b32 v7, v250, v251 offset0:58 offset1:59
ds_write2st64_b32 v7, v252, v253 offset0:60 offset1:61
ds_write2st64_b32 v7, v254, v255 offset0:62 offset1:63
v_mov_b32 v9, 0xffff0000
v_permlane32_swap_b32 v32, v34
v_permlane32_swap_b32 v33, v35
v_lshlrev_b32 v36, 16, v32
v_and_b32 v37, v9, v32
v_lshlrev_b32 v38, 16, v33
v_and_b32 v39, v9, v33
v_lshlrev_b32 v40, 16, v34
v_and_b32 v41, v9, v34
v_lshlrev_b32 v42, 16, v35
v_and_b32 v43, v9, v35
s_waitcnt lgkmcnt(0)
s_barrier
ds_read2st64_b32 v[64:65], v12 offset0:0 offset1:1
ds_read2st64_b32 v[66:67], v12 offset0:2 offset1:3
ds_read2st64_b32 v[68:69], v12 offset0:4 offset1:5
ds_read2st64_b32 v[70:71], v12 offset0:6 offset1:7
ds_read2st64_b32 v[72:73], v12 offset0:64 offset1:65
ds_read2st64_b32 v[74:75], v12 offset0:66 offset1:67
ds_read2st64_b32 v[76:77], v12 offset0:68 offset1:69
ds_read2st64_b32 v[78:79], v12 offset0:70 offset1:71
ds_read2st64_b32 v[80:81], v12 offset0:128 offset1:129
ds_read2st64_b32 v[82:83], v12 offset0:130 offset1:131
ds_read2st64_b32 v[84:85], v12 offset0:132 offset1:133
ds_read2st64_b32 v[86:87], v12 offset0:134 offset1:135
ds_read2st64_b32 v[88:89], v12 offset0:192 offset1:193
ds_read2st64_b32 v[90:91], v12 offset0:194 offset1:195
ds_read2st64_b32 v[92:93], v12 offset0:196 offset1:197
ds_read2st64_b32 v[94:95], v12 offset0:198 offset1:199
ds_read2st64_b32 v[96:97], v13 offset0:0 offset1:1
ds_read2st64_b32 v[98:99], v13 offset0:2 offset1:3
ds_read2st64_b32 v[100:101], v13 offset0:4 offset1:5
ds_read2st64_b32 v[102:103], v13 offset0:6 offset1:7
ds_read2st64_b32 v[104:105], v13 offset0:64 offset1:65
ds_read2st64_b32 v[106:107], v13 offset0:66 offset1:67
ds_read2st64_b32 v[108:109], v13 offset0:68 offset1:69
ds_read2st64_b32 v[110:111], v13 offset0:70 offset1:71
ds_read2st64_b32 v[112:113], v13 offset0:128 offset1:129
ds_read2st64_b32 v[114:115], v13 offset0:130 offset1:131
ds_read2st64_b32 v[116:117], v13 offset0:132 offset1:133
ds_read2st64_b32 v[118:119], v13 offset0:134 offset1:135
ds_read2st64_b32 v[120:121], v13 offset0:192 offset1:193
ds_read2st64_b32 v[122:123], v13 offset0:194 offset1:195
ds_read2st64_b32 v[124:125], v13 offset0:196 offset1:197
ds_read2st64_b32 v[126:127], v13 offset0:198 offset1:199
s_waitcnt lgkmcnt(15)
v_add_f32 v36, v36, v64
v_add_f32 v37, v37, v65
v_add_f32 v38, v38, v66
v_add_f32 v39, v39, v67
v_add_f32 v40, v40, v68
v_add_f32 v41, v41, v69
v_add_f32 v42, v42, v70
v_add_f32 v43, v43, v71
v_add_f32 v36, v36, v72
v_add_f32 v37, v37, v73
v_add_f32 v38, v38, v74
v_add_f32 v39, v39, v75
v_add_f32 v40, v40, v76
v_add_f32 v41, v41, v77
v_add_f32 v42, v42, v78
v_add_f32 v43, v43, v79
v_add_f32 v36, v36, v80
v_add_f32 v37, v37, v81
v_add_f32 v38, v38, v82
v_add_f32 v39, v39, v83
v_add_f32 v40, v40, v84
v_add_f32 v41, v41, v85
v_add_f32 v42, v42, v86
v_add_f32 v43, v43, v87
v_add_f32 v36, v36, v88
v_add_f32 v37, v37, v89
v_add_f32 v38, v38, v90
v_add_f32 v39, v39, v91
v_add_f32 v40, v40, v92
v_add_f32 v41, v41, v93
v_add_f32 v42, v42, v94
v_add_f32 v43, v43, v95
s_waitcnt lgkmcnt(12)
v_add_f32 v36, v36, v96
v_add_f32 v37, v37, v97
v_add_f32 v38, v38, v98
v_add_f32 v39, v39, v99
v_add_f32 v40, v40, v100
v_add_f32 v41, v41, v101
v_add_f32 v42, v42, v102
v_add_f32 v43, v43, v103
s_waitcnt lgkmcnt(8)
v_add_f32 v36, v36, v104
v_add_f32 v37, v37, v105
v_add_f32 v38, v38, v106
v_add_f32 v39, v39, v107
v_add_f32 v40, v40, v108
v_add_f32 v41, v41, v109
v_add_f32 v42, v42, v110
v_add_f32 v43, v43, v111
s_waitcnt lgkmcnt(4)
v_add_f32 v36, v36, v112
v_add_f32 v37, v37, v113
v_add_f32 v38, v38, v114
v_add_f32 v39, v39, v115
v_add_f32 v40, v40, v116
v_add_f32 v41, v41, v117
v_add_f32 v42, v42, v118
v_add_f32 v43, v43, v119
s_waitcnt lgkmcnt(0)
v_add_f32 v36, v36, v120
v_add_f32 v37, v37, v121
v_add_f32 v38, v38, v122
v_add_f32 v39, v39, v123
v_add_f32 v40, v40, v124
v_add_f32 v41, v41, v125
v_add_f32 v42, v42, v126
v_add_f32 v43, v43, v127
v_cvt_pk_bf16_f32 v32, v36, v37
v_cvt_pk_bf16_f32 v33, v38, v39
v_cvt_pk_bf16_f32 v34, v40, v41
v_cvt_pk_bf16_f32 v35, v42, v43
s_nop 0
v_permlane32_swap_b32 v32, v34
v_permlane32_swap_b32 v33, v35
buffer_store_dwordx4 v[32:35], v6, s[24:27], 0 offen
s_endpgm
.p2align 6
L_hQ:
s_mov_b32 s12, s42
s_mov_b32 s13, s43
s_mov_b32 s14, 0x180000
s_mov_b32 s15, 0x20000
s_mov_b32 s16, s50
s_mov_b32 s17, s51
s_mov_b32 s18, 0x1c0000
s_mov_b32 s19, 0x20000
s_sub_u32 s28, s52, 2048
s_subb_u32 s29, s53, 0
s_mov_b32 s30, 0x1c0800
s_mov_b32 s31, 0x20000
v_lshrrev_b32 v10, 3, v1
v_and_b32 v11, 7, v1
v_bfe_u32 v12, v1, 4, 1
s_lshl_b32 s40, s6, 8
s_add_u32 s41, s40, 128
s_lshl_b32 s42, s6, 7
s_mul_i32 s32, s4, 57344
s_add_u32 s32, s32, s40
s_mul_i32 s33, s4, 57344
s_add_u32 s33, s33, s41
s_mul_i32 s34, s4, 98304
s_add_u32 s34, s34, s42
s_lshl_b32 s36, s4, 12
s_add_u32 s36, s36, 65536
v_lshlrev_b32 v13, 1, v12
v_xor_b32 v13, v13, v11
v_mul_u32_u24 v14, 3584, v10
v_lshl_add_u32 v240, v13, 4, v14
v_add_u32 v241, 27648, v240
v_xor_b32 v242, 64, v240
v_add_u32 v243, 27648, v242
s_add_u32 s53, s7, 0
s_and_b32 s53, s53, 7
s_mul_i32 s53, s53, 229376
s_add_u32 m0, s36, 0
s_add_u32 s53, s53, s32
buffer_load_dwordx4 v240, s[16:19], s53 offen offset:0 lds
buffer_load_dwordx4 v241, s[16:19], s53 offen offset:1024 lds
buffer_load_dwordx4 v242, s[28:31], s53 offen offset:2048 lds
buffer_load_dwordx4 v243, s[28:31], s53 offen offset:3072 lds
s_getpc_b64 s[62:63]
L_pc_Q:
s_sub_u32 s62, s62, L_pc_Q-L_code
s_subb_u32 s63, s63, 0
s_lshr_b32 s37, s2, 3
s_lshl_b32 s37, s37, 2
s_add_u32 s37, s37, s4
s_mul_i32 s37, s37, 5
v_min_u32 v14, 4, v1
v_add_u32 v14, s37, v14
v_lshlrev_b32 v14, 7, v14
v_min_u32 v14, L_code_end-L_code-4, v14
global_load_dword v255, v14, s[62:63]
v_lshlrev_b32 v13, 2, v12
v_xor_b32 v13, v13, v11
v_mul_u32_u24 v14, 3072, v10
v_lshl_add_u32 v244, v13, 4, v14
v_add_u32 v245, 23552, v244
v_add_u32 v246, 47104, v244
v_add_u32 v247, 70656, v244
s_mov_b32 s24, s58
s_mov_b32 s25, s59
s_mov_b32 s26, 0x100
s_mov_b32 s27, 0x20000
s_mov_b64 s[60:61], s[44:45]
s_mul_i32 s44, s4, 15360
v_lshl_add_u32 v6, v1, 2, s44
v_lshlrev_b32 v3, 4, v1
v_mov_b32 v9, 0xffff0000
s_lshl_b32 s55, s5, 2
s_add_u32 s55, s55, s4
s_mul_i32 s55, s55, 147456
v_lshrrev_b32 v12, 3, v1
v_lshlrev_b32 v12, 18, v12
v_add_u32 v12, v12, v1
v_lshlrev_b32 v12, 8, v12
s_lshl_b32 s47, s5, 1
s_lshr_b32 s44, s4, 1
s_add_u32 s47, s47, s44
s_lshl_b32 s47, s47, 6
s_add_u32 s47, s47, s6
s_lshl_b32 s47, s47, 3
s_and_b32 s44, s4, 1
s_add_u32 s47, s47, s44
s_lshl_b32 s47, s47, 2
s_add_u32 s47, s47, 10092560
s_lshl_b32 s37, s4, 8
s_add_u32 s37, s37, s2
s_lshl_b32 s44, s2, 11
s_add_u32 s44, s44, 10092544
s_lshl_b32 s45, s2, 9
s_add_u32 s45, s45, 10027008
s_cmp_lt_u32 s37, 32
s_cselect_b32 s44, s44, 0x7fff0000
s_cselect_b32 s45, s45, 0x7fff0000
v_and_b32 v11, 31, v1
v_lshlrev_b32 v11, 4, v11
v_mov_b32 v20, 0
v_mov_b32 v21, 0
v_mov_b32 v22, 0
v_mov_b32 v23, 0
buffer_store_dwordx4 v[20:23], v3, s[20:23], s44 offen sc1
buffer_store_dwordx4 v[20:23], v3, s[20:23], s44 offen offset:1024 sc1
buffer_store_dwordx4 v[20:23], v11, s[20:23], s45 offen sc1
s_and_b32 s37, s4, 1
s_lshl_b32 s37, s37, 10
s_lshl_b32 s44, s6, 11
s_add_u32 s44, s44, s37
v_add_u32 v10, s44, v3
global_load_dwordx4 v[216:219], v10, s[60:61]
s_add_u32 s37, s37, 139264
v_add_u32 v220, s37, v3
s_and_b32 s37, s2, 7
s_lshr_b32 s38, s2, 3
s_lshl_b32 s48, s5, 1
s_bfe_u32 s39, s37, 0x10001
s_add_u32 s48, s48, s39
s_lshr_b32 s39, s38, 2
s_and_b32 s49, s37, 1
s_lshl_b32 s49, s49, 2
s_and_b32 s38, s38, 3
s_add_u32 s49, s49, s38
s_add_u32 s39, s4, s39
s_and_b32 s39, s39, 3
v_and_b32 v10, 7, v1
v_bfe_u32 v11, v1, 4, 1
v_lshlrev_b32 v11, 2, v11
v_xor_b32 v10, v10, v11
v_lshrrev_b32 v11, 3, v1
v_lshlrev_b32 v11, 10, v11
v_lshl_add_u32 v10, v10, 4, v11
s_lshl_b32 s37, s49, 7
v_add_u32 v2, s37, v10
v_lshlrev_b32 v3, 4, v1
s_lshl_b32 s52, s4, 14
v_bfe_u32 v10, v1, 4, 1
v_bfe_u32 v11, v1, 3, 1
v_lshl_add_u32 v10, v11, 1, v10
v_lshlrev_b32 v10, 5, v10
v_and_b32 v11, 3, v1
v_lshl_add_u32 v10, v11, 3, v10
v_bfe_u32 v11, v1, 2, 2
v_lshl_add_u32 v10, v11, 7, v10
v_lshrrev_b32 v11, 5, v1
v_lshl_add_u32 v10, v11, 9, v10
v_add_u32 v4, s52, v10
s_mul_i32 s37, s48, 294912
s_lshl_b32 s0, s39, 14
s_lshl_b32 s54, s0, 4
s_add_u32 s0, s0, s37
s_lshl_b32 s1, s39, 13
s_lshl_b32 s60, s1, 4
s_add_u32 s1, s1, s37
s_lshl_b32 s46, s39, 12
s_lshl_b32 s61, s46, 4
s_add_u32 s46, s46, s37
s_lshl_b32 s50, s48, 3
s_add_u32 s50, s50, s49
s_lshl_b32 s50, s50, 2
s_add_u32 s50, s50, s39
s_lshl_b32 s50, s50, 6
s_add_u32 s50, s50, 10092544
s_add_u32 s50, s20, s50
s_addc_u32 s51, s21, 0
v_xor_b32 v5, 64, v4
s_mul_i32 s59, s4, 15360
s_sub_u32 s37, s59, s52
v_add_u32 v214, s37, v4
v_xor_b32 v215, 64, v214
s_barrier
s_add_u32 s53, s7, 1
s_and_b32 s53, s53, 7
s_mul_i32 s53, s53, 229376
s_add_u32 m0, s36, 16384
s_add_u32 s53, s53, s32
buffer_load_dwordx4 v240, s[16:19], s53 offen offset:0 lds
buffer_load_dwordx4 v241, s[16:19], s53 offen offset:1024 lds
buffer_load_dwordx4 v242, s[28:31], s53 offen offset:2048 lds
buffer_load_dwordx4 v243, s[28:31], s53 offen offset:3072 lds
s_and_b32 s45, s5, 7
s_lshl_b32 s45, s45, 2
s_add_u32 s45, s45, s4
s_mul_i32 s45, s45, 57344
s_add_u32 s45, s45, s40
v_and_b32 v10, 15, v1
v_mul_u32_u24 v10, 3584, v10
buffer_load_dword v254, v10, s[16:19], s45 offen
buffer_load_dword v254, v10, s[28:31], s45 offen offset:2048
s_waitcnt vmcnt(11)
s_barrier
s_add_u32 s53, s7, 2
s_and_b32 s53, s53, 7
s_mul_i32 s53, s53, 229376
s_add_u32 m0, s36, 32768
s_add_u32 s53, s53, s32
buffer_load_dwordx4 v240, s[16:19], s53 offen offset:0 lds
buffer_load_dwordx4 v241, s[16:19], s53 offen offset:1024 lds
buffer_load_dwordx4 v242, s[28:31], s53 offen offset:2048 lds
buffer_load_dwordx4 v243, s[28:31], s53 offen offset:3072 lds
s_add_u32 s53, s7, 3
s_and_b32 s53, s53, 7
s_mul_i32 s53, s53, 229376
s_add_u32 m0, s36, 49152
s_add_u32 s53, s53, s32
buffer_load_dwordx4 v240, s[16:19], s53 offen offset:0 lds
buffer_load_dwordx4 v241, s[16:19], s53 offen offset:1024 lds
buffer_load_dwordx4 v242, s[28:31], s53 offen offset:2048 lds
buffer_load_dwordx4 v243, s[28:31], s53 offen offset:3072 lds
s_add_u32 s53, s7, 4
s_and_b32 s53, s53, 7
s_mul_i32 s53, s53, 229376
s_add_u32 m0, s36, 65536
s_add_u32 s53, s53, s32
buffer_load_dwordx4 v240, s[16:19], s53 offen offset:0 lds
buffer_load_dwordx4 v241, s[16:19], s53 offen offset:1024 lds
buffer_load_dwordx4 v242, s[28:31], s53 offen offset:2048 lds
buffer_load_dwordx4 v243, s[28:31], s53 offen offset:3072 lds
s_waitcnt vmcnt(19)
s_lshl_b32 s37, s4, 8
s_add_u32 s37, s37, s2
s_lshl_b32 s45, s2, 2
s_cmp_lt_u32 s37, 32
s_cselect_b32 s45, s45, 0x1000
v_mov_b32 v10, 0
v_mov_b32 v11, 1
buffer_store_dword v11, v10, s[24:27], s45 offen sc1
s_and_b32 s45, s5, 7
s_lshl_b32 s45, s45, 2
s_add_u32 s45, s45, s4
s_mul_i32 s45, s45, 57344
s_add_u32 s45, s45, s41
v_and_b32 v10, 15, v1
v_mul_u32_u24 v10, 3584, v10
buffer_load_dword v254, v10, s[16:19], s45 offen
buffer_load_dword v254, v10, s[28:31], s45 offen offset:2048
s_waitcnt vmcnt(17)
s_barrier
s_add_u32 s53, s7, 5
s_and_b32 s53, s53, 7
s_mul_i32 s53, s53, 229376
s_add_u32 m0, s36, 81920
s_add_u32 s53, s53, s32
buffer_load_dwordx4 v240, s[16:19], s53 offen offset:0 lds
v_and_b32 v10, 31, v1
s_lshl_b32 s44, s4, 8
s_add_u32 s44, s44, 61440
v_lshl_add_u32 v15, v10, 3, s44
ds_read_b64 v[10:11], v15
buffer_load_dwordx4 v241, s[16:19], s53 offen offset:1024 lds
s_waitcnt lgkmcnt(0)
v_fma_f32 v14, -v10, v10, v11
v_max_f32 v14, 0, v14
v_cvt_pk_bf16_f32 v14, v14, v14
v_lshlrev_b32 v14, 16, v14
buffer_load_dwordx4 v242, s[28:31], s53 offen offset:2048 lds
v_add_f32 v14, 0x3727c5ac, v14
v_cvt_pk_bf16_f32 v14, v14, v14
v_lshlrev_b32 v14, 16, v14
v_sqrt_f32 v14, v14
s_nop 0
v_cvt_pk_bf16_f32 v14, v14, v14
buffer_load_dwordx4 v243, s[28:31], s53 offen offset:3072 lds
v_lshlrev_b32 v14, 16, v14
v_rcp_f32 v15, v14
s_nop 0
v_mul_f32 v7, 0xbfb8aa3b, v15
v_mul_f32 v8, v14, v14
s_waitcnt vmcnt(15)
s_barrier
s_add_u32 s53, s7, 6
s_and_b32 s53, s53, 7
s_mul_i32 s53, s53, 229376
s_add_u32 m0, s36, 0
s_add_u32 s53, s53, s32
buffer_load_dwordx4 v240, s[16:19], s53 offen offset:0 lds
buffer_load_dwordx4 v241, s[16:19], s53 offen offset:1024 lds
buffer_load_dwordx4 v242, s[28:31], s53 offen offset:2048 lds
buffer_load_dwordx4 v243, s[28:31], s53 offen offset:3072 lds
s_waitcnt vmcnt(15)
s_barrier
s_add_u32 s53, s7, 7
s_and_b32 s53, s53, 7
s_mul_i32 s53, s53, 229376
s_add_u32 m0, s36, 16384
s_add_u32 s53, s53, s32
buffer_load_dwordx4 v240, s[16:19], s53 offen offset:0 lds
buffer_load_dwordx4 v241, s[16:19], s53 offen offset:1024 lds
buffer_load_dwordx4 v242, s[28:31], s53 offen offset:2048 lds
buffer_load_dwordx4 v243, s[28:31], s53 offen offset:3072 lds
s_waitcnt vmcnt(15)
s_barrier
s_lshr_b32 s37, s2, 3
s_and_b32 s38, s37, 3
s_and_b32 s45, s2, 1
s_lshl_b32 s45, s45, 2
s_add_u32 s38, s38, s45
s_lshl_b32 s38, s38, 7
s_lshr_b32 s37, s37, 2
s_lshl_b32 s45, s37, 2
s_add_u32 s45, s45, s4
s_mul_i32 s45, s45, 56
s_add_u32 s45, s45, 0
s_lshl_b32 s45, s45, 10
s_add_u32 s45, s45, s38
v_min_u32 v10, 55, v1
v_lshlrev_b32 v10, 10, v10
buffer_load_dword v254, v10, s[64:67], s45 offen
s_lshl_b32 s45, s37, 2
s_add_u32 s45, s45, s4
s_lshl_b32 s45, s45, 14
s_add_u32 s45, s45, s38
v_and_b32 v10, 15, v1
v_lshlrev_b32 v10, 10, v10
buffer_load_dword v254, v10, s[68:71], s45 offen
s_add_u32 s53, s7, 0
s_and_b32 s53, s53, 7
s_mul_i32 s53, s53, 229376
s_add_u32 m0, s36, 32768
s_add_u32 s53, s53, s33
buffer_load_dwordx4 v240, s[16:19], s53 offen offset:0 lds
buffer_load_dwordx4 v241, s[16:19], s53 offen offset:1024 lds
buffer_load_dwordx4 v242, s[28:31], s53 offen offset:2048 lds
buffer_load_dwordx4 v243, s[28:31], s53 offen offset:3072 lds
s_waitcnt vmcnt(14)
s_barrier
s_add_u32 s53, s7, 1
s_and_b32 s53, s53, 7
s_mul_i32 s53, s53, 229376
s_add_u32 m0, s36, 49152
s_add_u32 s53, s53, s33
buffer_load_dwordx4 v240, s[16:19], s53 offen offset:0 lds
buffer_load_dwordx4 v241, s[16:19], s53 offen offset:1024 lds
buffer_load_dwordx4 v242, s[28:31], s53 offen offset:2048 lds
buffer_load_dwordx4 v243, s[28:31], s53 offen offset:3072 lds
s_waitcnt vmcnt(14)
s_barrier
v_and_b32 v212, 31, v1
v_lshlrev_b32 v212, 2, v212
buffer_load_dword v213, v212, s[24:27], 0 offen sc1
s_add_u32 s53, s7, 2
s_and_b32 s53, s53, 7
s_mul_i32 s53, s53, 229376
s_add_u32 m0, s36, 65536
s_add_u32 s53, s53, s33
buffer_load_dwordx4 v240, s[16:19], s53 offen offset:0 lds
buffer_load_dwordx4 v241, s[16:19], s53 offen offset:1024 lds
buffer_load_dwordx4 v242, s[28:31], s53 offen offset:2048 lds
buffer_load_dwordx4 v243, s[28:31], s53 offen offset:3072 lds
s_waitcnt vmcnt(15)
s_barrier
s_add_u32 s53, s7, 3
s_and_b32 s53, s53, 7
s_mul_i32 s53, s53, 229376
s_add_u32 m0, s36, 81920
s_add_u32 s53, s53, s33
buffer_load_dwordx4 v240, s[16:19], s53 offen offset:0 lds
buffer_load_dwordx4 v241, s[16:19], s53 offen offset:1024 lds
buffer_load_dwordx4 v242, s[28:31], s53 offen offset:2048 lds
buffer_load_dwordx4 v243, s[28:31], s53 offen offset:3072 lds
s_waitcnt vmcnt(8)
v_cmp_ne_u32 vcc, 1, v213
s_nop 0
s_cmp_eq_u64 vcc, 0
s_cbranch_scc1 L_mk_Q_ok
s_mov_b32 s58, 0
L_mk_Q:
s_sleep 4
buffer_load_dword v213, v212, s[24:27], 0 offen sc1
s_waitcnt vmcnt(0)
v_cmp_ne_u32 vcc, 1, v213
s_nop 0
s_cmp_eq_u64 vcc, 0
s_cbranch_scc1 L_mk_Q_ok
s_add_u32 s58, s58, 1
s_cmp_lt_u32 s58, 0x20000
s_cbranch_scc1 L_mk_Q
L_mk_Q_ok:
s_barrier
s_and_b32 s45, s5, 7
s_lshl_b32 s45, s45, 2
s_add_u32 s45, s45, s4
s_mul_i32 s45, s45, 49152
s_add_u32 s45, s45, s42
v_and_b32 v10, 15, v1
v_mul_u32_u24 v10, 3072, v10
buffer_load_dword v254, v10, s[12:15], s45 offen
s_barrier
s_add_u32 s53, s7, 4
s_and_b32 s53, s53, 7
s_mul_i32 s53, s53, 229376
s_add_u32 m0, s36, 0
s_add_u32 s53, s53, s33
buffer_load_dwordx4 v240, s[16:19], s53 offen offset:0 lds
s_lshl_b32 s57, s6, 13
s_add_u32 s57, s57, s55
buffer_load_dwordx4 v241, s[16:19], s53 offen offset:1024 lds
ds_read2st64_b32 v[16:17], v6 offset0:0 offset1:1
ds_read2st64_b32 v[18:19], v6 offset0:2 offset1:3
buffer_load_dwordx4 v242, s[28:31], s53 offen offset:2048 lds
ds_read2st64_b32 v[20:21], v6 offset0:4 offset1:5
ds_read2st64_b32 v[22:23], v6 offset0:6 offset1:7
buffer_load_dwordx4 v243, s[28:31], s53 offen offset:3072 lds
ds_read2st64_b32 v[24:25], v6 offset0:8 offset1:9
ds_read2st64_b32 v[26:27], v6 offset0:10 offset1:11
s_add_u32 s53, s7, 5
s_and_b32 s53, s53, 7
s_mul_i32 s53, s53, 229376
s_add_u32 m0, s36, 16384
s_add_u32 s53, s53, s33
buffer_load_dwordx4 v240, s[16:19], s53 offen offset:0 lds
ds_read2st64_b32 v[28:29], v6 offset0:12 offset1:13
ds_read2st64_b32 v[30:31], v6 offset0:14 offset1:15
buffer_load_dwordx4 v241, s[16:19], s53 offen offset:1024 lds
s_waitcnt lgkmcnt(4)
v_lshlrev_b32 v32, 16, v16
buffer_load_dwordx4 v242, s[28:31], s53 offen offset:2048 lds
v_and_b32 v33, v9, v16
v_lshlrev_b32 v34, 16, v17
buffer_load_dwordx4 v243, s[28:31], s53 offen offset:3072 lds
v_and_b32 v35, v9, v17
s_waitcnt vmcnt(13)
s_barrier
s_add_u32 s53, s7, 6
s_and_b32 s53, s53, 7
s_mul_i32 s53, s53, 229376
s_add_u32 m0, s36, 32768
s_add_u32 s53, s53, s33
buffer_load_dwordx4 v240, s[16:19], s53 offen offset:0 lds
v_lshlrev_b32 v36, 16, v18
v_and_b32 v37, v9, v18
v_lshlrev_b32 v38, 16, v19
v_and_b32 v39, v9, v19
v_lshlrev_b32 v40, 16, v20
v_and_b32 v41, v9, v20
v_lshlrev_b32 v42, 16, v21
v_and_b32 v43, v9, v21
v_lshlrev_b32 v44, 16, v22
v_and_b32 v45, v9, v22
v_lshlrev_b32 v46, 16, v23
v_and_b32 v47, v9, v23
ds_read2st64_b32 v[16:17], v6 offset0:16 offset1:17
buffer_load_dwordx4 v241, s[16:19], s53 offen offset:1024 lds
ds_read2st64_b32 v[18:19], v6 offset0:18 offset1:19
ds_read2st64_b32 v[20:21], v6 offset0:20 offset1:21
ds_read2st64_b32 v[22:23], v6 offset0:22 offset1:23
v_mul_f32 v48, v7, v32
v_mul_f32 v49, v7, v33
v_mul_f32 v50, v7, v34
v_mul_f32 v51, v7, v35
v_mul_f32 v52, v7, v36
v_mul_f32 v53, v7, v37
v_mul_f32 v54, v7, v38
v_mul_f32 v55, v7, v39
v_exp_f32 v48, v48
v_exp_f32 v49, v49
buffer_load_dwordx4 v242, s[28:31], s53 offen offset:2048 lds
v_exp_f32 v50, v50
v_exp_f32 v51, v51
v_exp_f32 v52, v52
v_exp_f32 v53, v53
v_exp_f32 v54, v54
v_exp_f32 v55, v55
v_mul_f32 v32, v32, v40
v_mul_f32 v33, v33, v41
v_mul_f32 v34, v34, v42
v_mul_f32 v35, v35, v43
v_mul_f32 v36, v36, v44
v_mul_f32 v37, v37, v45
v_mul_f32 v38, v38, v46
buffer_load_dwordx4 v243, s[28:31], s53 offen offset:3072 lds
v_mul_f32 v39, v39, v47
v_fma_f32 v48, v48, v8, v8
v_fma_f32 v49, v49, v8, v8
v_fma_f32 v50, v50, v8, v8
v_fma_f32 v51, v51, v8, v8
v_fma_f32 v52, v52, v8, v8
v_fma_f32 v53, v53, v8, v8
v_fma_f32 v54, v54, v8, v8
v_fma_f32 v55, v55, v8, v8
v_rcp_f32 v48, v48
s_waitcnt vmcnt(13)
s_barrier
s_add_u32 s53, s7, 7
s_and_b32 s53, s53, 7
s_mul_i32 s53, s53, 229376
s_add_u32 m0, s36, 49152
s_add_u32 s53, s53, s33
buffer_load_dwordx4 v240, s[16:19], s53 offen offset:0 lds
v_rcp_f32 v49, v49
v_rcp_f32 v50, v50
v_rcp_f32 v51, v51
v_rcp_f32 v52, v52
v_rcp_f32 v53, v53
v_rcp_f32 v54, v54
v_rcp_f32 v55, v55
v_mul_f32 v32, v32, v48
v_mul_f32 v33, v33, v49
v_mul_f32 v34, v34, v50
v_mul_f32 v35, v35, v51
v_mul_f32 v36, v36, v52
v_mul_f32 v37, v37, v53
buffer_load_dwordx4 v241, s[16:19], s53 offen offset:1024 lds
v_mul_f32 v38, v38, v54
v_mul_f32 v39, v39, v55
v_cvt_pk_bf16_f32 v192, v32, v33
v_cvt_pk_bf16_f32 v193, v34, v35
v_cvt_pk_bf16_f32 v194, v36, v37
v_cvt_pk_bf16_f32 v195, v38, v39
s_add_u32 s44, s57, 0
buffer_store_dwordx4 v[192:195], v3, s[20:23], s44 offen sc1
s_waitcnt lgkmcnt(4)
v_lshlrev_b32 v32, 16, v24
v_and_b32 v33, v9, v24
v_lshlrev_b32 v34, 16, v25
v_and_b32 v35, v9, v25
buffer_load_dwordx4 v242, s[28:31], s53 offen offset:2048 lds
v_lshlrev_b32 v36, 16, v26
v_and_b32 v37, v9, v26
v_lshlrev_b32 v38, 16, v27
v_and_b32 v39, v9, v27
v_lshlrev_b32 v40, 16, v28
v_and_b32 v41, v9, v28
v_lshlrev_b32 v42, 16, v29
v_and_b32 v43, v9, v29
v_lshlrev_b32 v44, 16, v30
v_and_b32 v45, v9, v30
v_lshlrev_b32 v46, 16, v31
v_and_b32 v47, v9, v31
ds_read2st64_b32 v[24:25], v6 offset0:24 offset1:25
buffer_load_dwordx4 v243, s[28:31], s53 offen offset:3072 lds
ds_read2st64_b32 v[26:27], v6 offset0:26 offset1:27
ds_read2st64_b32 v[28:29], v6 offset0:28 offset1:29
ds_read2st64_b32 v[30:31], v6 offset0:30 offset1:31
v_mul_f32 v48, v7, v32
v_mul_f32 v49, v7, v33
v_mul_f32 v50, v7, v34
v_mul_f32 v51, v7, v35
v_mul_f32 v52, v7, v36
v_mul_f32 v53, v7, v37
v_mul_f32 v54, v7, v38
s_waitcnt vmcnt(13)
s_barrier
s_add_u32 s53, s7, 0
s_and_b32 s53, s53, 7
s_mul_i32 s53, s53, 196608
s_add_u32 m0, s36, 65536
s_add_u32 s53, s53, s34
buffer_load_dwordx4 v244, s[12:15], s53 offen offset:0 lds
v_mul_f32 v55, v7, v39
v_exp_f32 v48, v48
v_exp_f32 v49, v49
v_exp_f32 v50, v50
v_exp_f32 v51, v51
v_exp_f32 v52, v52
v_exp_f32 v53, v53
v_exp_f32 v54, v54
v_exp_f32 v55, v55
v_mul_f32 v32, v32, v40
v_mul_f32 v33, v33, v41
v_mul_f32 v34, v34, v42
buffer_load_dwordx4 v245, s[12:15], s53 offen offset:1024 lds
v_mul_f32 v35, v35, v43
v_mul_f32 v36, v36, v44
v_mul_f32 v37, v37, v45
v_mul_f32 v38, v38, v46
v_mul_f32 v39, v39, v47
v_fma_f32 v48, v48, v8, v8
v_fma_f32 v49, v49, v8, v8
v_fma_f32 v50, v50, v8, v8
v_fma_f32 v51, v51, v8, v8
v_fma_f32 v52, v52, v8, v8
v_fma_f32 v53, v53, v8, v8
v_fma_f32 v54, v54, v8, v8
buffer_load_dwordx4 v246, s[12:15], s53 offen offset:2048 lds
v_fma_f32 v55, v55, v8, v8
v_rcp_f32 v48, v48
v_rcp_f32 v49, v49
v_rcp_f32 v50, v50
v_rcp_f32 v51, v51
v_rcp_f32 v52, v52
v_rcp_f32 v53, v53
v_rcp_f32 v54, v54
v_rcp_f32 v55, v55
v_mul_f32 v32, v32, v48
v_mul_f32 v33, v33, v49
v_mul_f32 v34, v34, v50
buffer_load_dwordx4 v247, s[12:15], s53 offen offset:3072 lds
v_mul_f32 v35, v35, v51
v_mul_f32 v36, v36, v52
v_mul_f32 v37, v37, v53
v_mul_f32 v38, v38, v54
v_mul_f32 v39, v39, v55
v_cvt_pk_bf16_f32 v196, v32, v33
v_cvt_pk_bf16_f32 v197, v34, v35
v_cvt_pk_bf16_f32 v198, v36, v37
v_cvt_pk_bf16_f32 v199, v38, v39
s_add_u32 s44, s57, 1024
buffer_store_dwordx4 v[196:199], v3, s[20:23], s44 offen sc1
s_waitcnt vmcnt(14)
s_barrier
s_add_u32 s53, s7, 2
s_and_b32 s53, s53, 7
s_mul_i32 s53, s53, 196608
s_add_u32 m0, s36, 81920
s_add_u32 s53, s53, s34
buffer_load_dwordx4 v244, s[12:15], s53 offen offset:0 lds
s_waitcnt lgkmcnt(4)
v_lshlrev_b32 v32, 16, v16
v_and_b32 v33, v9, v16
v_lshlrev_b32 v34, 16, v17
v_and_b32 v35, v9, v17
v_lshlrev_b32 v36, 16, v18
v_and_b32 v37, v9, v18
v_lshlrev_b32 v38, 16, v19
v_and_b32 v39, v9, v19
v_lshlrev_b32 v40, 16, v20
v_and_b32 v41, v9, v20
v_lshlrev_b32 v42, 16, v21
v_and_b32 v43, v9, v21
v_lshlrev_b32 v44, 16, v22
buffer_load_dwordx4 v245, s[12:15], s53 offen offset:1024 lds
v_and_b32 v45, v9, v22
v_lshlrev_b32 v46, 16, v23
v_and_b32 v47, v9, v23
v_mul_f32 v48, v7, v32
v_mul_f32 v49, v7, v33
v_mul_f32 v50, v7, v34
v_mul_f32 v51, v7, v35
v_mul_f32 v52, v7, v36
v_mul_f32 v53, v7, v37
v_mul_f32 v54, v7, v38
v_mul_f32 v55, v7, v39
v_exp_f32 v48, v48
v_exp_f32 v49, v49
v_exp_f32 v50, v50
buffer_load_dwordx4 v246, s[12:15], s53 offen offset:2048 lds
v_exp_f32 v51, v51
v_exp_f32 v52, v52
v_exp_f32 v53, v53
v_exp_f32 v54, v54
v_exp_f32 v55, v55
v_mul_f32 v32, v32, v40
v_mul_f32 v33, v33, v41
v_mul_f32 v34, v34, v42
v_mul_f32 v35, v35, v43
v_mul_f32 v36, v36, v44
v_mul_f32 v37, v37, v45
v_mul_f32 v38, v38, v46
v_mul_f32 v39, v39, v47
v_fma_f32 v48, v48, v8, v8
buffer_load_dwordx4 v247, s[12:15], s53 offen offset:3072 lds
v_fma_f32 v49, v49, v8, v8
v_fma_f32 v50, v50, v8, v8
v_fma_f32 v51, v51, v8, v8
v_fma_f32 v52, v52, v8, v8
v_fma_f32 v53, v53, v8, v8
v_fma_f32 v54, v54, v8, v8
v_fma_f32 v55, v55, v8, v8
v_rcp_f32 v48, v48
v_rcp_f32 v49, v49
v_rcp_f32 v50, v50
v_rcp_f32 v51, v51
s_waitcnt vmcnt(14)
s_barrier
v_rcp_f32 v52, v52
v_rcp_f32 v53, v53
v_rcp_f32 v54, v54
v_rcp_f32 v55, v55
v_mul_f32 v32, v32, v48
v_mul_f32 v33, v33, v49
v_mul_f32 v34, v34, v50
v_mul_f32 v35, v35, v51
v_mul_f32 v36, v36, v52
v_mul_f32 v37, v37, v53
v_mul_f32 v38, v38, v54
v_mul_f32 v39, v39, v55
v_cvt_pk_bf16_f32 v192, v32, v33
v_cvt_pk_bf16_f32 v193, v34, v35
v_cvt_pk_bf16_f32 v194, v36, v37
v_cvt_pk_bf16_f32 v195, v38, v39
s_add_u32 s44, s57, 2048
buffer_store_dwordx4 v[192:195], v3, s[20:23], s44 offen sc1
s_waitcnt lgkmcnt(0)
v_lshlrev_b32 v32, 16, v24
v_and_b32 v33, v9, v24
v_lshlrev_b32 v34, 16, v25
v_and_b32 v35, v9, v25
v_lshlrev_b32 v36, 16, v26
v_and_b32 v37, v9, v26
v_lshlrev_b32 v38, 16, v27
v_and_b32 v39, v9, v27
v_lshlrev_b32 v40, 16, v28
v_and_b32 v41, v9, v28
v_lshlrev_b32 v42, 16, v29
v_and_b32 v43, v9, v29
v_lshlrev_b32 v44, 16, v30
v_and_b32 v45, v9, v30
v_lshlrev_b32 v46, 16, v31
v_and_b32 v47, v9, v31
v_mul_f32 v48, v7, v32
v_mul_f32 v49, v7, v33
v_mul_f32 v50, v7, v34
v_mul_f32 v51, v7, v35
v_mul_f32 v52, v7, v36
v_mul_f32 v53, v7, v37
v_mul_f32 v54, v7, v38
v_mul_f32 v55, v7, v39
v_exp_f32 v48, v48
v_exp_f32 v49, v49
v_exp_f32 v50, v50
v_exp_f32 v51, v51
v_exp_f32 v52, v52
v_exp_f32 v53, v53
v_exp_f32 v54, v54
v_exp_f32 v55, v55
v_mul_f32 v32, v32, v40
v_mul_f32 v33, v33, v41
v_mul_f32 v34, v34, v42
v_mul_f32 v35, v35, v43
v_mul_f32 v36, v36, v44
v_mul_f32 v37, v37, v45
v_mul_f32 v38, v38, v46
v_mul_f32 v39, v39, v47
v_fma_f32 v48, v48, v8, v8
v_fma_f32 v49, v49, v8, v8
v_fma_f32 v50, v50, v8, v8
v_fma_f32 v51, v51, v8, v8
v_fma_f32 v52, v52, v8, v8
v_fma_f32 v53, v53, v8, v8
v_fma_f32 v54, v54, v8, v8
v_fma_f32 v55, v55, v8, v8
v_rcp_f32 v48, v48
s_waitcnt vmcnt(10)
s_barrier
s_add_u32 s53, s7, 4
s_and_b32 s53, s53, 7
s_mul_i32 s53, s53, 196608
s_add_u32 m0, s36, 16384
s_add_u32 s53, s53, s34
buffer_load_dwordx4 v244, s[12:15], s53 offen offset:0 lds
v_rcp_f32 v49, v49
v_rcp_f32 v50, v50
v_rcp_f32 v51, v51
v_rcp_f32 v52, v52
v_rcp_f32 v53, v53
v_rcp_f32 v54, v54
buffer_load_dwordx4 v245, s[12:15], s53 offen offset:1024 lds
v_rcp_f32 v55, v55
v_mul_f32 v32, v32, v48
v_mul_f32 v33, v33, v49
v_mul_f32 v34, v34, v50
v_mul_f32 v35, v35, v51
v_mul_f32 v36, v36, v52
buffer_load_dwordx4 v246, s[12:15], s53 offen offset:2048 lds
v_mul_f32 v37, v37, v53
v_mul_f32 v38, v38, v54
v_mul_f32 v39, v39, v55
v_cvt_pk_bf16_f32 v196, v32, v33
v_cvt_pk_bf16_f32 v197, v34, v35
v_cvt_pk_bf16_f32 v198, v36, v37
buffer_load_dwordx4 v247, s[12:15], s53 offen offset:3072 lds
v_cvt_pk_bf16_f32 v199, v38, v39
s_add_u32 s44, s57, 3072
buffer_store_dwordx4 v[196:199], v3, s[20:23], s44 offen sc1
s_waitcnt vmcnt(11)
s_barrier
s_waitcnt vmcnt(0)
v_mov_b32 v11, 1
buffer_store_dword v11, v12, s[20:23], s47 offen sc1
s_barrier
s_add_u32 s53, s7, 6
s_and_b32 s53, s53, 7
s_mul_i32 s53, s53, 196608
s_add_u32 m0, s36, 32768
s_add_u32 s53, s53, s34
buffer_load_dwordx4 v244, s[12:15], s53 offen offset:0 lds
s_lshl_b32 s44, s4, 12
s_add_u32 s44, s44, 65536
v_lshl_add_u32 v6, v1, 2, s44
ds_read2st64_b32 v[16:17], v6 offset0:0 offset1:1
ds_read2st64_b32 v[18:19], v6 offset0:2 offset1:3
ds_read2st64_b32 v[20:21], v6 offset0:4 offset1:5
ds_read2st64_b32 v[22:23], v6 offset0:6 offset1:7
ds_read2st64_b32 v[24:25], v6 offset0:8 offset1:9
ds_read2st64_b32 v[26:27], v6 offset0:10 offset1:11
buffer_load_dwordx4 v245, s[12:15], s53 offen offset:1024 lds
ds_read2st64_b32 v[28:29], v6 offset0:12 offset1:13
ds_read2st64_b32 v[30:31], v6 offset0:14 offset1:15
s_waitcnt lgkmcnt(4)
v_lshlrev_b32 v32, 16, v16
v_and_b32 v33, v9, v16
v_lshlrev_b32 v34, 16, v17
v_and_b32 v35, v9, v17
v_lshlrev_b32 v36, 16, v18
v_and_b32 v37, v9, v18
buffer_load_dwordx4 v246, s[12:15], s53 offen offset:2048 lds
v_lshlrev_b32 v38, 16, v19
v_and_b32 v39, v9, v19
v_lshlrev_b32 v40, 16, v20
v_and_b32 v41, v9, v20
v_lshlrev_b32 v42, 16, v21
v_and_b32 v43, v9, v21
v_lshlrev_b32 v44, 16, v22
v_and_b32 v45, v9, v22
v_lshlrev_b32 v46, 16, v23
buffer_load_dwordx4 v247, s[12:15], s53 offen offset:3072 lds
v_and_b32 v47, v9, v23
v_mul_f32 v48, v7, v32
v_mul_f32 v49, v7, v33
v_mul_f32 v50, v7, v34
v_mul_f32 v51, v7, v35
v_mul_f32 v52, v7, v36
s_barrier
ds_write_b128 v220, v[216:219]
s_lshl_b32 s37, s4, 8
s_add_u32 s37, s37, 141312
v_lshl_add_u32 v10, v1, 2, s37
v_mov_b32 v11, 0
ds_write_b32 v10, v11
v_mul_f32 v53, v7, v37
v_mul_f32 v54, v7, v38
v_mul_f32 v55, v7, v39
v_exp_f32 v48, v48
v_exp_f32 v49, v49
v_exp_f32 v50, v50
v_exp_f32 v51, v51
v_exp_f32 v52, v52
v_exp_f32 v53, v53
v_exp_f32 v54, v54
v_exp_f32 v55, v55
v_mul_f32 v32, v32, v40
v_mul_f32 v33, v33, v41
v_mul_f32 v34, v34, v42
v_mul_f32 v35, v35, v43
v_mul_f32 v36, v36, v44
v_mul_f32 v37, v37, v45
v_mul_f32 v38, v38, v46
v_mul_f32 v39, v39, v47
v_fma_f32 v48, v48, v8, v8
v_fma_f32 v49, v49, v8, v8
v_fma_f32 v50, v50, v8, v8
v_fma_f32 v51, v51, v8, v8
v_fma_f32 v52, v52, v8, v8
v_fma_f32 v53, v53, v8, v8
v_fma_f32 v54, v54, v8, v8
v_fma_f32 v55, v55, v8, v8
v_rcp_f32 v48, v48
v_rcp_f32 v49, v49
v_rcp_f32 v50, v50
v_rcp_f32 v51, v51
v_rcp_f32 v52, v52
v_rcp_f32 v53, v53
v_rcp_f32 v54, v54
v_rcp_f32 v55, v55
v_mul_f32 v32, v32, v48
v_mul_f32 v33, v33, v49
v_mul_f32 v34, v34, v50
v_mul_f32 v35, v35, v51
v_mul_f32 v36, v36, v52
v_mul_f32 v37, v37, v53
v_mul_f32 v38, v38, v54
v_mul_f32 v39, v39, v55
v_cvt_pk_bf16_f32 v192, v32, v33
v_cvt_pk_bf16_f32 v193, v34, v35
v_cvt_pk_bf16_f32 v194, v36, v37
v_cvt_pk_bf16_f32 v195, v38, v39
s_add_u32 s44, s57, 4096
buffer_store_dwordx4 v[192:195], v3, s[20:23], s44 offen sc1
s_waitcnt lgkmcnt(2)
v_lshlrev_b32 v32, 16, v24
s_waitcnt vmcnt(1)
s_barrier
v_and_b32 v33, v9, v24
v_lshlrev_b32 v34, 16, v25
v_and_b32 v35, v9, v25
v_lshlrev_b32 v36, 16, v26
v_and_b32 v37, v9, v26
v_lshlrev_b32 v38, 16, v27
v_and_b32 v39, v9, v27
v_lshlrev_b32 v40, 16, v28
v_and_b32 v41, v9, v28
v_lshlrev_b32 v42, 16, v29
v_and_b32 v43, v9, v29
v_lshlrev_b32 v44, 16, v30
v_and_b32 v45, v9, v30
v_lshlrev_b32 v46, 16, v31
v_and_b32 v47, v9, v31
v_mul_f32 v48, v7, v32
v_mul_f32 v49, v7, v33
v_mul_f32 v50, v7, v34
v_mul_f32 v51, v7, v35
v_mul_f32 v52, v7, v36
v_mul_f32 v53, v7, v37
v_mul_f32 v54, v7, v38
v_mul_f32 v55, v7, v39
v_exp_f32 v48, v48
v_exp_f32 v49, v49
v_exp_f32 v50, v50
v_exp_f32 v51, v51
v_exp_f32 v52, v52
v_exp_f32 v53, v53
v_exp_f32 v54, v54
v_exp_f32 v55, v55
v_mul_f32 v32, v32, v40
v_mul_f32 v33, v33, v41
v_mul_f32 v34, v34, v42
v_mul_f32 v35, v35, v43
v_mul_f32 v36, v36, v44
v_mul_f32 v37, v37, v45
v_mul_f32 v38, v38, v46
v_mul_f32 v39, v39, v47
v_fma_f32 v48, v48, v8, v8
v_fma_f32 v49, v49, v8, v8
v_fma_f32 v50, v50, v8, v8
v_fma_f32 v51, v51, v8, v8
v_fma_f32 v52, v52, v8, v8
v_fma_f32 v53, v53, v8, v8
v_fma_f32 v54, v54, v8, v8
v_fma_f32 v55, v55, v8, v8
v_rcp_f32 v48, v48
v_rcp_f32 v49, v49
v_rcp_f32 v50, v50
v_rcp_f32 v51, v51
v_rcp_f32 v52, v52
v_rcp_f32 v53, v53
v_rcp_f32 v54, v54
v_rcp_f32 v55, v55
v_mul_f32 v32, v32, v48
v_mul_f32 v33, v33, v49
v_mul_f32 v34, v34, v50
v_mul_f32 v35, v35, v51
v_mul_f32 v36, v36, v52
v_mul_f32 v37, v37, v53
v_mul_f32 v38, v38, v54
v_mul_f32 v39, v39, v55
v_cvt_pk_bf16_f32 v196, v32, v33
v_cvt_pk_bf16_f32 v197, v34, v35
v_cvt_pk_bf16_f32 v198, v36, v37
s_waitcnt lgkmcnt(0)
s_barrier
s_load_dwordx16 s[28:43], s[50:51], 0 glc
v_cvt_pk_bf16_f32 v199, v38, v39
s_add_u32 s44, s57, 5120
buffer_store_dwordx4 v[196:199], v3, s[20:23], s44 offen sc1
s_waitcnt lgkmcnt(0)
s_min_u32 s12, s32, s33
s_min_u32 s12, s12, s40
s_min_u32 s12, s12, s41
s_sub_u32 s13, s12, 1
s_cmp_ge_i32 s13, 0
s_cbranch_scc1 L_pf_hQ_0_ok
s_mov_b32 s58, 0
L_pf_hQ_0:
s_load_dwordx16 s[28:43], s[50:51], 0 glc
s_waitcnt lgkmcnt(0)
s_min_u32 s12, s32, s33
s_min_u32 s12, s12, s40
s_min_u32 s12, s12, s41
s_sub_u32 s13, s12, 1
s_cmp_ge_i32 s13, 0
s_cbranch_scc1 L_pf_hQ_0_ok
s_sleep 1
s_add_u32 s58, s58, 1
s_cmp_lt_u32 s58, 0x20000
s_cbranch_scc1 L_pf_hQ_0
L_pf_hQ_0_ok:
s_add_u32 s62, s0, 0
s_add_u32 s63, s0, 147456
buffer_load_dwordx4 v[64:67], v3, s[20:23], s62 offen sc1
buffer_load_dwordx4 v[68:71], v3, s[20:23], s63 offen sc1
s_add_u32 s62, s0, 1024
s_add_u32 s63, s0, 148480
buffer_load_dwordx4 v[72:75], v3, s[20:23], s62 offen sc1
buffer_load_dwordx4 v[76:79], v3, s[20:23], s63 offen sc1
s_add_u32 s62, s0, 2048
s_add_u32 s63, s0, 149504
buffer_load_dwordx4 v[80:83], v3, s[20:23], s62 offen sc1
buffer_load_dwordx4 v[84:87], v3, s[20:23], s63 offen sc1
s_add_u32 s62, s0, 3072
s_add_u32 s63, s0, 150528
buffer_load_dwordx4 v[88:91], v3, s[20:23], s62 offen sc1
buffer_load_dwordx4 v[92:95], v3, s[20:23], s63 offen sc1
ds_read_b64_tr_b16 v[16:17], v4 offset:0
ds_read_b64_tr_b16 v[18:19], v4 offset:1024
ds_read_b64_tr_b16 v[20:21], v5 offset:0
ds_read_b64_tr_b16 v[22:23], v5 offset:1024
s_waitcnt vmcnt(8)
v_mov_b32 v11, 2
buffer_store_dword v11, v12, s[20:23], s47 offen sc1
s_add_u32 s62, s0, 8192
s_add_u32 s63, s0, 155648
buffer_load_dwordx4 v[96:99], v3, s[20:23], s62 offen sc1
buffer_load_dwordx4 v[100:103], v3, s[20:23], s63 offen sc1
ds_read_b64_tr_b16 v[24:25], v4 offset:2048
ds_read_b64_tr_b16 v[26:27], v4 offset:3072
ds_read_b64_tr_b16 v[28:29], v5 offset:2048
ds_read_b64_tr_b16 v[30:31], v5 offset:3072
s_waitcnt lgkmcnt(4)
s_waitcnt vmcnt(9)
v_mfma_f32_32x32x16_bf16 v[192:207], v[16:19], v[64:67], 0
v_mfma_f32_32x32x16_bf16 v[224:239], v[16:19], v[68:71], 0
v_mfma_f32_32x32x16_bf16 v[208:223], v[20:23], v[64:67], 0
v_mfma_f32_32x32x16_bf16 v[240:255], v[20:23], v[68:71], 0
s_add_u32 s62, s0, 9216
s_add_u32 s63, s0, 156672
buffer_load_dwordx4 v[104:107], v3, s[20:23], s62 offen sc1
buffer_load_dwordx4 v[108:111], v3, s[20:23], s63 offen sc1
ds_read_b64_tr_b16 v[16:17], v4 offset:4096
ds_read_b64_tr_b16 v[18:19], v4 offset:5120
ds_read_b64_tr_b16 v[20:21], v5 offset:4096
ds_read_b64_tr_b16 v[22:23], v5 offset:5120
s_waitcnt lgkmcnt(4)
s_waitcnt vmcnt(9)
v_mfma_f32_32x32x16_bf16 v[192:207], v[24:27], v[72:75], v[192:207]
v_mfma_f32_32x32x16_bf16 v[224:239], v[24:27], v[76:79], v[224:239]
v_mfma_f32_32x32x16_bf16 v[208:223], v[28:31], v[72:75], v[208:223]
v_mfma_f32_32x32x16_bf16 v[240:255], v[28:31], v[76:79], v[240:255]
s_add_u32 s62, s0, 10240
s_add_u32 s63, s0, 157696
buffer_load_dwordx4 v[112:115], v3, s[20:23], s62 offen sc1
buffer_load_dwordx4 v[116:119], v3, s[20:23], s63 offen sc1
ds_read_b64_tr_b16 v[24:25], v4 offset:6144
ds_read_b64_tr_b16 v[26:27], v4 offset:7168
ds_read_b64_tr_b16 v[28:29], v5 offset:6144
ds_read_b64_tr_b16 v[30:31], v5 offset:7168
s_waitcnt lgkmcnt(4)
s_add_u32 s62, s54, 65536
s_add_u32 m0, s52, 0
s_add_u32 s63, s62, 7168
buffer_load_dwordx4 v2, s[64:67], s62 offen lds
buffer_load_dwordx4 v2, s[64:67], s63 offen offset:1024 lds
s_waitcnt vmcnt(11)
v_mfma_f32_32x32x16_bf16 v[192:207], v[16:19], v[80:83], v[192:207]
v_mfma_f32_32x32x16_bf16 v[224:239], v[16:19], v[84:87], v[224:239]
v_mfma_f32_32x32x16_bf16 v[208:223], v[20:23], v[80:83], v[208:223]
v_mfma_f32_32x32x16_bf16 v[240:255], v[20:23], v[84:87], v[240:255]
s_add_u32 s62, s0, 11264
s_add_u32 s63, s0, 158720
buffer_load_dwordx4 v[120:123], v3, s[20:23], s62 offen sc1
buffer_load_dwordx4 v[124:127], v3, s[20:23], s63 offen sc1
ds_read_b64_tr_b16 v[16:17], v4 offset:8192
ds_read_b64_tr_b16 v[18:19], v4 offset:9216
ds_read_b64_tr_b16 v[20:21], v5 offset:8192
ds_read_b64_tr_b16 v[22:23], v5 offset:9216
s_waitcnt lgkmcnt(4)
s_load_dwordx16 s[28:43], s[50:51], 0 glc
s_add_u32 s62, s54, 81920
s_add_u32 m0, s52, 2048
s_add_u32 s63, s62, 7168
buffer_load_dwordx4 v2, s[64:67], s62 offen lds
buffer_load_dwordx4 v2, s[64:67], s63 offen offset:1024 lds
s_waitcnt vmcnt(13)
v_mfma_f32_32x32x16_bf16 v[192:207], v[24:27], v[88:91], v[192:207]
v_mfma_f32_32x32x16_bf16 v[224:239], v[24:27], v[92:95], v[224:239]
v_mfma_f32_32x32x16_bf16 v[208:223], v[28:31], v[88:91], v[208:223]
v_mfma_f32_32x32x16_bf16 v[240:255], v[28:31], v[92:95], v[240:255]
s_waitcnt lgkmcnt(0)
s_min_u32 s12, s32, s33
s_min_u32 s12, s12, s40
s_min_u32 s12, s12, s41
s_sub_u32 s13, s12, 2
s_min_u32 s12, s34, s35
s_min_u32 s12, s12, s42
s_min_u32 s12, s12, s43
s_sub_u32 s12, s12, 1
s_or_b32 s13, s13, s12
s_cmp_ge_i32 s13, 0
s_cbranch_scc1 L_pf_hQ_1_ok
s_mov_b32 s58, 0
L_pf_hQ_1:
s_load_dwordx16 s[28:43], s[50:51], 0 glc
s_waitcnt lgkmcnt(0)
s_min_u32 s12, s32, s33
s_min_u32 s12, s12, s40
s_min_u32 s12, s12, s41
s_sub_u32 s13, s12, 2
s_min_u32 s12, s34, s35
s_min_u32 s12, s12, s42
s_min_u32 s12, s12, s43
s_sub_u32 s12, s12, 1
s_or_b32 s13, s13, s12
s_cmp_ge_i32 s13, 0
s_cbranch_scc1 L_pf_hQ_1_ok
s_sleep 1
s_add_u32 s58, s58, 1
s_cmp_lt_u32 s58, 0x20000
s_cbranch_scc1 L_pf_hQ_1
L_pf_hQ_1_ok:
s_add_u32 s62, s0, 4096
s_add_u32 s63, s0, 151552
buffer_load_dwordx4 v[128:131], v3, s[20:23], s62 offen sc1
buffer_load_dwordx4 v[132:135], v3, s[20:23], s63 offen sc1
ds_read_b64_tr_b16 v[24:25], v4 offset:10240
ds_read_b64_tr_b16 v[26:27], v4 offset:11264
ds_read_b64_tr_b16 v[28:29], v5 offset:10240
ds_read_b64_tr_b16 v[30:31], v5 offset:11264
s_add_u32 s62, s54, 98304
s_add_u32 m0, s52, 4096
s_add_u32 s63, s62, 7168
buffer_load_dwordx4 v2, s[64:67], s62 offen lds
buffer_load_dwordx4 v2, s[64:67], s63 offen offset:1024 lds
s_waitcnt vmcnt(14)
v_mfma_f32_32x32x16_bf16 v[192:207], v[16:19], v[96:99], v[192:207]
v_mfma_f32_32x32x16_bf16 v[224:239], v[16:19], v[100:103], v[224:239]
v_mfma_f32_32x32x16_bf16 v[208:223], v[20:23], v[96:99], v[208:223]
v_mfma_f32_32x32x16_bf16 v[240:255], v[20:23], v[100:103], v[240:255]
s_add_u32 s62, s0, 5120
s_add_u32 s63, s0, 152576
buffer_load_dwordx4 v[136:139], v3, s[20:23], s62 offen sc1
buffer_load_dwordx4 v[140:143], v3, s[20:23], s63 offen sc1
ds_read_b64_tr_b16 v[16:17], v4 offset:12288
ds_read_b64_tr_b16 v[18:19], v4 offset:13312
ds_read_b64_tr_b16 v[20:21], v5 offset:12288
ds_read_b64_tr_b16 v[22:23], v5 offset:13312
s_waitcnt lgkmcnt(4)
s_add_u32 s62, s54, 114688
s_add_u32 m0, s52, 6144
s_add_u32 s63, s62, 7168
buffer_load_dwordx4 v2, s[64:67], s62 offen lds
buffer_load_dwordx4 v2, s[64:67], s63 offen offset:1024 lds
s_waitcnt vmcnt(16)
v_mfma_f32_32x32x16_bf16 v[192:207], v[24:27], v[104:107], v[192:207]
v_mfma_f32_32x32x16_bf16 v[224:239], v[24:27], v[108:111], v[224:239]
v_mfma_f32_32x32x16_bf16 v[208:223], v[28:31], v[104:107], v[208:223]
v_mfma_f32_32x32x16_bf16 v[240:255], v[28:31], v[108:111], v[240:255]
s_add_u32 s62, s0, 6144
s_add_u32 s63, s0, 153600
buffer_load_dwordx4 v[144:147], v3, s[20:23], s62 offen sc1
buffer_load_dwordx4 v[148:151], v3, s[20:23], s63 offen sc1
ds_read_b64_tr_b16 v[24:25], v4 offset:14336
ds_read_b64_tr_b16 v[26:27], v4 offset:15360
ds_read_b64_tr_b16 v[28:29], v5 offset:14336
ds_read_b64_tr_b16 v[30:31], v5 offset:15360
s_waitcnt lgkmcnt(4)
s_add_u32 s62, s54, 196608
s_add_u32 m0, s52, 8192
s_add_u32 s63, s62, 7168
buffer_load_dwordx4 v2, s[64:67], s62 offen lds
buffer_load_dwordx4 v2, s[64:67], s63 offen offset:1024 lds
s_waitcnt vmcnt(18)
v_mfma_f32_32x32x16_bf16 v[192:207], v[16:19], v[112:115], v[192:207]
v_mfma_f32_32x32x16_bf16 v[224:239], v[16:19], v[116:119], v[224:239]
v_mfma_f32_32x32x16_bf16 v[208:223], v[20:23], v[112:115], v[208:223]
v_mfma_f32_32x32x16_bf16 v[240:255], v[20:23], v[116:119], v[240:255]
s_add_u32 s62, s0, 7168
s_add_u32 s63, s0, 154624
buffer_load_dwordx4 v[152:155], v3, s[20:23], s62 offen sc1
buffer_load_dwordx4 v[156:159], v3, s[20:23], s63 offen sc1
s_waitcnt vmcnt(18)
ds_read_b64_tr_b16 v[16:17], v4 offset:0
ds_read_b64_tr_b16 v[18:19], v4 offset:1024
ds_read_b64_tr_b16 v[20:21], v5 offset:0
ds_read_b64_tr_b16 v[22:23], v5 offset:1024
s_waitcnt lgkmcnt(4)
s_add_u32 s62, s54, 212992
s_add_u32 m0, s52, 10240
s_add_u32 s63, s62, 7168
buffer_load_dwordx4 v2, s[64:67], s62 offen lds
buffer_load_dwordx4 v2, s[64:67], s63 offen offset:1024 lds
s_waitcnt vmcnt(18)
v_mfma_f32_32x32x16_bf16 v[192:207], v[24:27], v[120:123], v[192:207]
v_mfma_f32_32x32x16_bf16 v[224:239], v[24:27], v[124:127], v[224:239]
v_mfma_f32_32x32x16_bf16 v[208:223], v[28:31], v[120:123], v[208:223]
v_mfma_f32_32x32x16_bf16 v[240:255], v[28:31], v[124:127], v[240:255]
s_add_u32 s62, s0, 12288
s_add_u32 s63, s0, 159744
buffer_load_dwordx4 v[160:163], v3, s[20:23], s62 offen sc1
buffer_load_dwordx4 v[164:167], v3, s[20:23], s63 offen sc1
s_waitcnt vmcnt(18)
ds_read_b64_tr_b16 v[24:25], v4 offset:2048
ds_read_b64_tr_b16 v[26:27], v4 offset:3072
ds_read_b64_tr_b16 v[28:29], v5 offset:2048
ds_read_b64_tr_b16 v[30:31], v5 offset:3072
s_waitcnt lgkmcnt(4)
s_add_u32 s62, s54, 229376
s_add_u32 m0, s52, 12288
s_add_u32 s63, s62, 7168
buffer_load_dwordx4 v2, s[64:67], s62 offen lds
buffer_load_dwordx4 v2, s[64:67], s63 offen offset:1024 lds
s_waitcnt vmcnt(18)
v_mfma_f32_32x32x16_bf16 v[192:207], v[16:19], v[128:131], v[192:207]
v_mfma_f32_32x32x16_bf16 v[224:239], v[16:19], v[132:135], v[224:239]
v_mfma_f32_32x32x16_bf16 v[208:223], v[20:23], v[128:131], v[208:223]
v_mfma_f32_32x32x16_bf16 v[240:255], v[20:23], v[132:135], v[240:255]
s_add_u32 s62, s0, 13312
s_add_u32 s63, s0, 160768
buffer_load_dwordx4 v[168:171], v3, s[20:23], s62 offen sc1
buffer_load_dwordx4 v[172:175], v3, s[20:23], s63 offen sc1
s_waitcnt vmcnt(18)
ds_read_b64_tr_b16 v[16:17], v4 offset:4096
ds_read_b64_tr_b16 v[18:19], v4 offset:5120
ds_read_b64_tr_b16 v[20:21], v5 offset:4096
ds_read_b64_tr_b16 v[22:23], v5 offset:5120
s_waitcnt lgkmcnt(4)
s_add_u32 s62, s54, 245760
s_add_u32 m0, s52, 14336
s_add_u32 s63, s62, 7168
buffer_load_dwordx4 v2, s[64:67], s62 offen lds
buffer_load_dwordx4 v2, s[64:67], s63 offen offset:1024 lds
s_waitcnt vmcnt(18)
v_mfma_f32_32x32x16_bf16 v[192:207], v[24:27], v[136:139], v[192:207]
v_mfma_f32_32x32x16_bf16 v[224:239], v[24:27], v[140:143], v[224:239]
v_mfma_f32_32x32x16_bf16 v[208:223], v[28:31], v[136:139], v[208:223]
v_mfma_f32_32x32x16_bf16 v[240:255], v[28:31], v[140:143], v[240:255]
s_add_u32 s62, s0, 14336
s_add_u32 s63, s0, 161792
buffer_load_dwordx4 v[176:179], v3, s[20:23], s62 offen sc1
buffer_load_dwordx4 v[180:183], v3, s[20:23], s63 offen sc1
s_waitcnt vmcnt(18)
ds_read_b64_tr_b16 v[24:25], v4 offset:6144
ds_read_b64_tr_b16 v[26:27], v4 offset:7168
ds_read_b64_tr_b16 v[28:29], v5 offset:6144
ds_read_b64_tr_b16 v[30:31], v5 offset:7168
s_waitcnt lgkmcnt(4)
s_add_u32 s62, s60, 1048576
s_add_u32 m0, s52, 0
s_add_u32 s63, s62, 7168
buffer_load_dwordx4 v2, s[64:67], s62 offen lds
buffer_load_dwordx4 v2, s[64:67], s63 offen offset:1024 lds
s_waitcnt vmcnt(18)
v_mfma_f32_32x32x16_bf16 v[192:207], v[16:19], v[144:147], v[192:207]
v_mfma_f32_32x32x16_bf16 v[224:239], v[16:19], v[148:151], v[224:239]
v_mfma_f32_32x32x16_bf16 v[208:223], v[20:23], v[144:147], v[208:223]
v_mfma_f32_32x32x16_bf16 v[240:255], v[20:23], v[148:151], v[240:255]
s_add_u32 s62, s0, 15360
s_add_u32 s63, s0, 162816
buffer_load_dwordx4 v[184:187], v3, s[20:23], s62 offen sc1
buffer_load_dwordx4 v[188:191], v3, s[20:23], s63 offen sc1
s_waitcnt vmcnt(18)
ds_read_b64_tr_b16 v[16:17], v4 offset:8192
ds_read_b64_tr_b16 v[18:19], v4 offset:9216
ds_read_b64_tr_b16 v[20:21], v5 offset:8192
ds_read_b64_tr_b16 v[22:23], v5 offset:9216
s_waitcnt lgkmcnt(4)
s_load_dwordx16 s[28:43], s[50:51], 0 glc
s_add_u32 s62, s60, 1064960
s_add_u32 m0, s52, 2048
s_add_u32 s63, s62, 7168
buffer_load_dwordx4 v2, s[64:67], s62 offen lds
buffer_load_dwordx4 v2, s[64:67], s63 offen offset:1024 lds
s_waitcnt vmcnt(18)
v_mfma_f32_32x32x16_bf16 v[192:207], v[24:27], v[152:155], v[192:207]
v_mfma_f32_32x32x16_bf16 v[224:239], v[24:27], v[156:159], v[224:239]
v_mfma_f32_32x32x16_bf16 v[208:223], v[28:31], v[152:155], v[208:223]
v_mfma_f32_32x32x16_bf16 v[240:255], v[28:31], v[156:159], v[240:255]
s_waitcnt lgkmcnt(0)
s_min_u32 s12, s28, s29
s_min_u32 s12, s12, s36
s_min_u32 s12, s12, s37
s_sub_u32 s13, s12, 1
s_min_u32 s12, s30, s31
s_min_u32 s12, s12, s38
s_min_u32 s12, s12, s39
s_sub_u32 s12, s12, 1
s_or_b32 s13, s13, s12
s_cmp_ge_i32 s13, 0
s_cbranch_scc1 L_pf_hQ_2_ok
s_mov_b32 s58, 0
L_pf_hQ_2:
s_load_dwordx16 s[28:43], s[50:51], 0 glc
s_waitcnt lgkmcnt(0)
s_min_u32 s12, s28, s29
s_min_u32 s12, s12, s36
s_min_u32 s12, s12, s37
s_sub_u32 s13, s12, 1
s_min_u32 s12, s30, s31
s_min_u32 s12, s12, s38
s_min_u32 s12, s12, s39
s_sub_u32 s12, s12, 1
s_or_b32 s13, s13, s12
s_cmp_ge_i32 s13, 0
s_cbranch_scc1 L_pf_hQ_2_ok
s_sleep 1
s_add_u32 s58, s58, 1
s_cmp_lt_u32 s58, 0x20000
s_cbranch_scc1 L_pf_hQ_2
L_pf_hQ_2_ok:
s_add_u32 s62, s1, 65536
s_add_u32 s63, s1, 212992
buffer_load_dwordx4 v[64:67], v3, s[20:23], s62 offen sc1
buffer_load_dwordx4 v[68:71], v3, s[20:23], s63 offen sc1
s_waitcnt vmcnt(18)
ds_read_b64_tr_b16 v[24:25], v4 offset:10240
ds_read_b64_tr_b16 v[26:27], v4 offset:11264
ds_read_b64_tr_b16 v[28:29], v5 offset:10240
ds_read_b64_tr_b16 v[30:31], v5 offset:11264
s_add_u32 s62, s60, 1081344
s_add_u32 m0, s52, 4096
s_add_u32 s63, s62, 7168
buffer_load_dwordx4 v2, s[64:67], s62 offen lds
buffer_load_dwordx4 v2, s[64:67], s63 offen offset:1024 lds
s_waitcnt vmcnt(18)
v_mfma_f32_32x32x16_bf16 v[192:207], v[16:19], v[160:163], v[192:207]
v_mfma_f32_32x32x16_bf16 v[224:239], v[16:19], v[164:167], v[224:239]
v_mfma_f32_32x32x16_bf16 v[208:223], v[20:23], v[160:163], v[208:223]
v_mfma_f32_32x32x16_bf16 v[240:255], v[20:23], v[164:167], v[240:255]
s_add_u32 s62, s1, 66560
s_add_u32 s63, s1, 214016
buffer_load_dwordx4 v[72:75], v3, s[20:23], s62 offen sc1
buffer_load_dwordx4 v[76:79], v3, s[20:23], s63 offen sc1
s_waitcnt vmcnt(18)
ds_read_b64_tr_b16 v[16:17], v4 offset:12288
ds_read_b64_tr_b16 v[18:19], v4 offset:13312
ds_read_b64_tr_b16 v[20:21], v5 offset:12288
ds_read_b64_tr_b16 v[22:23], v5 offset:13312
s_waitcnt lgkmcnt(4)
s_add_u32 s62, s60, 1097728
s_add_u32 m0, s52, 6144
s_add_u32 s63, s62, 7168
buffer_load_dwordx4 v2, s[64:67], s62 offen lds
buffer_load_dwordx4 v2, s[64:67], s63 offen offset:1024 lds
s_waitcnt vmcnt(18)
v_mfma_f32_32x32x16_bf16 v[192:207], v[24:27], v[168:171], v[192:207]
v_mfma_f32_32x32x16_bf16 v[224:239], v[24:27], v[172:175], v[224:239]
v_mfma_f32_32x32x16_bf16 v[208:223], v[28:31], v[168:171], v[208:223]
v_mfma_f32_32x32x16_bf16 v[240:255], v[28:31], v[172:175], v[240:255]
s_add_u32 s62, s1, 67584
s_add_u32 s63, s1, 215040
buffer_load_dwordx4 v[80:83], v3, s[20:23], s62 offen sc1
buffer_load_dwordx4 v[84:87], v3, s[20:23], s63 offen sc1
s_waitcnt vmcnt(18)
ds_read_b64_tr_b16 v[24:25], v4 offset:14336
ds_read_b64_tr_b16 v[26:27], v4 offset:15360
ds_read_b64_tr_b16 v[28:29], v5 offset:14336
ds_read_b64_tr_b16 v[30:31], v5 offset:15360
s_waitcnt lgkmcnt(4)
s_add_u32 s62, s60, 1114112
s_add_u32 m0, s52, 8192
s_add_u32 s63, s62, 7168
buffer_load_dwordx4 v2, s[64:67], s62 offen lds
buffer_load_dwordx4 v2, s[64:67], s63 offen offset:1024 lds
s_waitcnt vmcnt(18)
v_mfma_f32_32x32x16_bf16 v[192:207], v[16:19], v[176:179], v[192:207]
v_mfma_f32_32x32x16_bf16 v[224:239], v[16:19], v[180:183], v[224:239]
v_mfma_f32_32x32x16_bf16 v[208:223], v[20:23], v[176:179], v[208:223]
v_mfma_f32_32x32x16_bf16 v[240:255], v[20:23], v[180:183], v[240:255]
s_add_u32 s62, s1, 68608
s_add_u32 s63, s1, 216064
buffer_load_dwordx4 v[88:91], v3, s[20:23], s62 offen sc1
buffer_load_dwordx4 v[92:95], v3, s[20:23], s63 offen sc1
s_waitcnt vmcnt(18)
ds_read_b64_tr_b16 v[16:17], v4 offset:0
ds_read_b64_tr_b16 v[18:19], v4 offset:1024
ds_read_b64_tr_b16 v[20:21], v5 offset:0
ds_read_b64_tr_b16 v[22:23], v5 offset:1024
s_waitcnt lgkmcnt(4)
s_add_u32 s62, s60, 1130496
s_add_u32 m0, s52, 10240
s_add_u32 s63, s62, 7168
buffer_load_dwordx4 v2, s[64:67], s62 offen lds
buffer_load_dwordx4 v2, s[64:67], s63 offen offset:1024 lds
s_waitcnt vmcnt(18)
v_mfma_f32_32x32x16_bf16 v[192:207], v[24:27], v[184:187], v[192:207]
v_mfma_f32_32x32x16_bf16 v[224:239], v[24:27], v[188:191], v[224:239]
v_mfma_f32_32x32x16_bf16 v[208:223], v[28:31], v[184:187], v[208:223]
v_mfma_f32_32x32x16_bf16 v[240:255], v[28:31], v[188:191], v[240:255]
s_add_u32 s62, s1, 69632
s_add_u32 s63, s1, 217088
buffer_load_dwordx4 v[96:99], v3, s[20:23], s62 offen sc1
buffer_load_dwordx4 v[100:103], v3, s[20:23], s63 offen sc1
s_waitcnt vmcnt(18)
ds_read_b64_tr_b16 v[24:25], v4 offset:2048
ds_read_b64_tr_b16 v[26:27], v4 offset:3072
ds_read_b64_tr_b16 v[28:29], v5 offset:2048
ds_read_b64_tr_b16 v[30:31], v5 offset:3072
s_waitcnt lgkmcnt(4)
s_waitcnt vmcnt(16)
v_mfma_f32_32x32x16_bf16 v[192:207], v[16:19], v[64:67], v[192:207]
v_mfma_f32_32x32x16_bf16 v[224:239], v[16:19], v[68:71], v[224:239]
v_mfma_f32_32x32x16_bf16 v[208:223], v[20:23], v[64:67], v[208:223]
v_mfma_f32_32x32x16_bf16 v[240:255], v[20:23], v[68:71], v[240:255]
s_mov_b32 s24, s100
s_mov_b32 s25, s101
s_mov_b32 s26, 0x200000
s_mov_b32 s27, 0x20000
s_lshl_b32 s44, s48, 1
s_lshr_b32 s45, s3, 2
s_add_u32 s44, s44, s45
s_lshl_b32 s44, s44, 15
s_lshl_b32 s45, s49, 7
s_add_u32 s44, s44, s45
s_lshl_b32 s45, s4, 5
s_add_u32 s44, s44, s45
v_and_b32 v6, 31, v1
v_lshlrev_b32 v6, 10, v6
v_lshrrev_b32 v7, 5, v1
v_lshl_add_u32 v6, v7, 4, v6
v_add_u32 v6, s44, v6
buffer_load_dwordx4 v[32:35], v6, s[8:11], 0 offen
s_add_u32 s62, s1, 70656
s_add_u32 s63, s1, 218112
buffer_load_dwordx4 v[104:107], v3, s[20:23], s62 offen sc1
buffer_load_dwordx4 v[108:111], v3, s[20:23], s63 offen sc1
s_waitcnt vmcnt(17)
ds_read_b64_tr_b16 v[16:17], v4 offset:4096
ds_read_b64_tr_b16 v[18:19], v4 offset:5120
ds_read_b64_tr_b16 v[20:21], v5 offset:4096
ds_read_b64_tr_b16 v[22:23], v5 offset:5120
s_waitcnt lgkmcnt(4)
s_waitcnt vmcnt(15)
v_mfma_f32_32x32x16_bf16 v[192:207], v[24:27], v[72:75], v[192:207]
v_mfma_f32_32x32x16_bf16 v[224:239], v[24:27], v[76:79], v[224:239]
v_mfma_f32_32x32x16_bf16 v[208:223], v[28:31], v[72:75], v[208:223]
v_mfma_f32_32x32x16_bf16 v[240:255], v[28:31], v[76:79], v[240:255]
s_waitcnt vmcnt(13)
ds_read_b64_tr_b16 v[24:25], v4 offset:6144
ds_read_b64_tr_b16 v[26:27], v4 offset:7168
ds_read_b64_tr_b16 v[28:29], v5 offset:6144
ds_read_b64_tr_b16 v[30:31], v5 offset:7168
s_waitcnt lgkmcnt(4)
s_waitcnt vmcnt(11)
v_mfma_f32_32x32x16_bf16 v[192:207], v[16:19], v[80:83], v[192:207]
v_mfma_f32_32x32x16_bf16 v[224:239], v[16:19], v[84:87], v[224:239]
v_mfma_f32_32x32x16_bf16 v[208:223], v[20:23], v[80:83], v[208:223]
v_mfma_f32_32x32x16_bf16 v[240:255], v[20:23], v[84:87], v[240:255]
s_waitcnt vmcnt(9)
ds_read_b64_tr_b16 v[16:17], v4 offset:8192
ds_read_b64_tr_b16 v[18:19], v4 offset:9216
ds_read_b64_tr_b16 v[20:21], v5 offset:8192
ds_read_b64_tr_b16 v[22:23], v5 offset:9216
s_waitcnt lgkmcnt(4)
s_waitcnt vmcnt(7)
v_mfma_f32_32x32x16_bf16 v[192:207], v[24:27], v[88:91], v[192:207]
v_mfma_f32_32x32x16_bf16 v[224:239], v[24:27], v[92:95], v[224:239]
v_mfma_f32_32x32x16_bf16 v[208:223], v[28:31], v[88:91], v[208:223]
v_mfma_f32_32x32x16_bf16 v[240:255], v[28:31], v[92:95], v[240:255]
s_waitcnt vmcnt(5)
ds_read_b64_tr_b16 v[24:25], v4 offset:10240
ds_read_b64_tr_b16 v[26:27], v4 offset:11264
ds_read_b64_tr_b16 v[28:29], v5 offset:10240
ds_read_b64_tr_b16 v[30:31], v5 offset:11264
s_waitcnt lgkmcnt(4)
s_waitcnt vmcnt(3)
v_mfma_f32_32x32x16_bf16 v[192:207], v[16:19], v[96:99], v[192:207]
v_mfma_f32_32x32x16_bf16 v[224:239], v[16:19], v[100:103], v[224:239]
v_mfma_f32_32x32x16_bf16 v[208:223], v[20:23], v[96:99], v[208:223]
v_mfma_f32_32x32x16_bf16 v[240:255], v[20:23], v[100:103], v[240:255]
s_waitcnt lgkmcnt(0)
s_waitcnt vmcnt(0)
v_mfma_f32_32x32x16_bf16 v[192:207], v[24:27], v[104:107], v[192:207]
v_mfma_f32_32x32x16_bf16 v[224:239], v[24:27], v[108:111], v[224:239]
v_mfma_f32_32x32x16_bf16 v[208:223], v[28:31], v[104:107], v[208:223]
v_mfma_f32_32x32x16_bf16 v[240:255], v[28:31], v[108:111], v[240:255]
s_lshl_b32 s40, s3, 11
v_lshl_add_u32 v12, v1, 2, s40
v_add_u32 v13, 0x10000, v12
v_lshl_add_u32 v7, v1, 2, s52
s_nop 4
ds_write2st64_b32 v7, v192, v193 offset0:0 offset1:1
ds_write2st64_b32 v7, v194, v195 offset0:2 offset1:3
ds_write2st64_b32 v7, v196, v197 offset0:4 offset1:5
ds_write2st64_b32 v7, v198, v199 offset0:6 offset1:7
ds_write2st64_b32 v7, v200, v201 offset0:8 offset1:9
ds_write2st64_b32 v7, v202, v203 offset0:10 offset1:11
ds_write2st64_b32 v7, v204, v205 offset0:12 offset1:13
ds_write2st64_b32 v7, v206, v207 offset0:14 offset1:15
ds_write2st64_b32 v7, v208, v209 offset0:16 offset1:17
ds_write2st64_b32 v7, v210, v211 offset0:18 offset1:19
ds_write2st64_b32 v7, v212, v213 offset0:20 offset1:21
ds_write2st64_b32 v7, v214, v215 offset0:22 offset1:23
ds_write2st64_b32 v7, v216, v217 offset0:24 offset1:25
ds_write2st64_b32 v7, v218, v219 offset0:26 offset1:27
ds_write2st64_b32 v7, v220, v221 offset0:28 offset1:29
ds_write2st64_b32 v7, v222, v223 offset0:30 offset1:31
ds_write2st64_b32 v7, v224, v225 offset0:32 offset1:33
ds_write2st64_b32 v7, v226, v227 offset0:34 offset1:35
ds_write2st64_b32 v7, v228, v229 offset0:36 offset1:37
ds_write2st64_b32 v7, v230, v231 offset0:38 offset1:39
ds_write2st64_b32 v7, v232, v233 offset0:40 offset1:41
ds_write2st64_b32 v7, v234, v235 offset0:42 offset1:43
ds_write2st64_b32 v7, v236, v237 offset0:44 offset1:45
ds_write2st64_b32 v7, v238, v239 offset0:46 offset1:47
ds_write2st64_b32 v7, v240, v241 offset0:48 offset1:49
ds_write2st64_b32 v7, v242, v243 offset0:50 offset1:51
ds_write2st64_b32 v7, v244, v245 offset0:52 offset1:53
ds_write2st64_b32 v7, v246, v247 offset0:54 offset1:55
ds_write2st64_b32 v7, v248, v249 offset0:56 offset1:57
ds_write2st64_b32 v7, v250, v251 offset0:58 offset1:59
ds_write2st64_b32 v7, v252, v253 offset0:60 offset1:61
ds_write2st64_b32 v7, v254, v255 offset0:62 offset1:63
v_mov_b32 v9, 0xffff0000
v_permlane32_swap_b32 v32, v34
v_permlane32_swap_b32 v33, v35
v_lshlrev_b32 v36, 16, v32
v_and_b32 v37, v9, v32
v_lshlrev_b32 v38, 16, v33
v_and_b32 v39, v9, v33
v_lshlrev_b32 v40, 16, v34
v_and_b32 v41, v9, v34
v_lshlrev_b32 v42, 16, v35
v_and_b32 v43, v9, v35
s_waitcnt lgkmcnt(0)
s_barrier
ds_read2st64_b32 v[64:65], v12 offset0:0 offset1:1
ds_read2st64_b32 v[66:67], v12 offset0:2 offset1:3
ds_read2st64_b32 v[68:69], v12 offset0:4 offset1:5
ds_read2st64_b32 v[70:71], v12 offset0:6 offset1:7
ds_read2st64_b32 v[72:73], v12 offset0:64 offset1:65
ds_read2st64_b32 v[74:75], v12 offset0:66 offset1:67
ds_read2st64_b32 v[76:77], v12 offset0:68 offset1:69
ds_read2st64_b32 v[78:79], v12 offset0:70 offset1:71
ds_read2st64_b32 v[80:81], v12 offset0:128 offset1:129
ds_read2st64_b32 v[82:83], v12 offset0:130 offset1:131
ds_read2st64_b32 v[84:85], v12 offset0:132 offset1:133
ds_read2st64_b32 v[86:87], v12 offset0:134 offset1:135
ds_read2st64_b32 v[88:89], v12 offset0:192 offset1:193
ds_read2st64_b32 v[90:91], v12 offset0:194 offset1:195
ds_read2st64_b32 v[92:93], v12 offset0:196 offset1:197
ds_read2st64_b32 v[94:95], v12 offset0:198 offset1:199
ds_read2st64_b32 v[96:97], v13 offset0:0 offset1:1
ds_read2st64_b32 v[98:99], v13 offset0:2 offset1:3
ds_read2st64_b32 v[100:101], v13 offset0:4 offset1:5
ds_read2st64_b32 v[102:103], v13 offset0:6 offset1:7
ds_read2st64_b32 v[104:105], v13 offset0:64 offset1:65
ds_read2st64_b32 v[106:107], v13 offset0:66 offset1:67
ds_read2st64_b32 v[108:109], v13 offset0:68 offset1:69
ds_read2st64_b32 v[110:111], v13 offset0:70 offset1:71
ds_read2st64_b32 v[112:113], v13 offset0:128 offset1:129
ds_read2st64_b32 v[114:115], v13 offset0:130 offset1:131
ds_read2st64_b32 v[116:117], v13 offset0:132 offset1:133
ds_read2st64_b32 v[118:119], v13 offset0:134 offset1:135
ds_read2st64_b32 v[120:121], v13 offset0:192 offset1:193
ds_read2st64_b32 v[122:123], v13 offset0:194 offset1:195
ds_read2st64_b32 v[124:125], v13 offset0:196 offset1:197
ds_read2st64_b32 v[126:127], v13 offset0:198 offset1:199
s_waitcnt lgkmcnt(15)
v_add_f32 v36, v36, v64
v_add_f32 v37, v37, v65
v_add_f32 v38, v38, v66
v_add_f32 v39, v39, v67
v_add_f32 v40, v40, v68
v_add_f32 v41, v41, v69
v_add_f32 v42, v42, v70
v_add_f32 v43, v43, v71
v_add_f32 v36, v36, v72
v_add_f32 v37, v37, v73
v_add_f32 v38, v38, v74
v_add_f32 v39, v39, v75
v_add_f32 v40, v40, v76
v_add_f32 v41, v41, v77
v_add_f32 v42, v42, v78
v_add_f32 v43, v43, v79
v_add_f32 v36, v36, v80
v_add_f32 v37, v37, v81
v_add_f32 v38, v38, v82
v_add_f32 v39, v39, v83
v_add_f32 v40, v40, v84
v_add_f32 v41, v41, v85
v_add_f32 v42, v42, v86
v_add_f32 v43, v43, v87
v_add_f32 v36, v36, v88
v_add_f32 v37, v37, v89
v_add_f32 v38, v38, v90
v_add_f32 v39, v39, v91
v_add_f32 v40, v40, v92
v_add_f32 v41, v41, v93
v_add_f32 v42, v42, v94
v_add_f32 v43, v43, v95
s_waitcnt lgkmcnt(12)
v_add_f32 v36, v36, v96
v_add_f32 v37, v37, v97
v_add_f32 v38, v38, v98
v_add_f32 v39, v39, v99
v_add_f32 v40, v40, v100
v_add_f32 v41, v41, v101
v_add_f32 v42, v42, v102
v_add_f32 v43, v43, v103
s_waitcnt lgkmcnt(8)
v_add_f32 v36, v36, v104
v_add_f32 v37, v37, v105
v_add_f32 v38, v38, v106
v_add_f32 v39, v39, v107
v_add_f32 v40, v40, v108
v_add_f32 v41, v41, v109
v_add_f32 v42, v42, v110
v_add_f32 v43, v43, v111
s_waitcnt lgkmcnt(4)
v_add_f32 v36, v36, v112
v_add_f32 v37, v37, v113
v_add_f32 v38, v38, v114
v_add_f32 v39, v39, v115
v_add_f32 v40, v40, v116
v_add_f32 v41, v41, v117
v_add_f32 v42, v42, v118
v_add_f32 v43, v43, v119
s_waitcnt lgkmcnt(0)
v_add_f32 v36, v36, v120
v_add_f32 v37, v37, v121
v_add_f32 v38, v38, v122
v_add_f32 v39, v39, v123
v_add_f32 v40, v40, v124
v_add_f32 v41, v41, v125
v_add_f32 v42, v42, v126
v_add_f32 v43, v43, v127
v_cvt_pk_bf16_f32 v32, v36, v37
v_cvt_pk_bf16_f32 v33, v38, v39
v_cvt_pk_bf16_f32 v34, v40, v41
v_cvt_pk_bf16_f32 v35, v42, v43
s_nop 0
v_permlane32_swap_b32 v32, v34
v_permlane32_swap_b32 v33, v35
buffer_store_dwordx4 v[32:35], v6, s[24:27], 0 offen
s_endpgm
L_code_end:
.section .rodata,"a"
.p2align 6
.amdhsa_kernel parallel_sum__linear_kernel_hedgehog__swiglu_ffn__prompt_kernel
  .amdhsa_next_free_vgpr 256
  .amdhsa_next_free_sgpr 102
  .amdhsa_accum_offset 256
  .amdhsa_group_segment_fixed_size 0
  .amdhsa_kernarg_size 88
  .amdhsa_user_sgpr_count 2
  .amdhsa_user_sgpr_kernarg_segment_ptr 1
  .amdhsa_system_sgpr_workgroup_id_x 1
.end_amdhsa_kernel
```
